```python
import torch

def _softmax(x, axis=-1):
    return torch.softmax(x, dim=axis)

def _gelu(x):
    return torch.nn.functional.gelu(x, approximate='tanh')

def _silu(x):
    return torch.nn.functional.silu(x)

def _sigmoid(x):
    return torch.sigmoid(x)

def _layernorm(x, axis=-1, eps=1e-05):
    m = x.mean(dim=axis, keepdim=True)
    v = x.var(dim=axis, keepdim=True, unbiased=False)
    return (x - m) / torch.sqrt(v + eps)

def _scatter_add(tgt, idx, src, axis=0):
    return tgt.clone().index_add_(axis, idx, src)

def _segment_sum(src, seg, n):
    out = torch.zeros((n,) + src.shape[1:], dtype=src.dtype)
    return out.index_add_(0, seg, src)

def _pad(x, pw):
    flat = tuple((v for pair in reversed(pw) for v in pair))
    return torch.nn.functional.pad(x, flat)
kernel_name = 'parallel_sum__sliding_local_dilated__mixer_gmlp__prompt'

def setup_inputs():

    _w = lambda a: (lambda t: t.to(torch.bfloat16) if t.is_floating_point() else t)(torch.as_tensor(a))

    def _A_setup():
        B, S, D = (1, 2048, 576)
        return {'x': _w((lambda *s: torch.randn(*s, dtype=torch.bfloat16) * 0.05)(B, S, D)), 'wqkv': _w((lambda *s: torch.randn(*s, dtype=torch.bfloat16) * 0.2)(D, 3 * D)), 'wo': _w((lambda *s: torch.randn(*s, dtype=torch.bfloat16) * 0.1)(D, D))}
    _A_in = _A_setup()

    def _B_setup():
        B, S, D, F = (1, 2048, 576, 4608)
        Fh = F // 2
        return {'x': _w((lambda *s: torch.randn(*s, dtype=torch.bfloat16) * 0.05)(B, S, D)), 'w_in': _w((lambda *s: torch.randn(*s, dtype=torch.bfloat16) * 0.8)(D, 2 * Fh)), 'w_sp': _w(0.01 * (lambda *s: torch.randn(*s, dtype=torch.bfloat16) * 0.8)(S, S)), 'b_sp': _w(1.0 + 0.01 * (lambda *s: torch.randn(*s, dtype=torch.bfloat16) * 0.05)(S)), 'w_out': _w((lambda *s: torch.randn(*s, dtype=torch.bfloat16) * 0.05)(Fh, D))}
    _B_in = _B_setup()
    return {'A_x': _A_in['x'], 'A_wqkv': _A_in['wqkv'], 'A_wo': _A_in['wo'], 'B_x': _B_in['x'], 'B_w_in': _B_in['w_in'], 'B_w_sp': _B_in['w_sp'], 'B_b_sp': _B_in['b_sp'], 'B_w_out': _B_in['w_out']}

def reference(A_x, A_wqkv, A_wo, B_x, B_w_in, B_w_sp, B_b_sp, B_w_out):

    def _A_ref(x, wqkv, wo):
        B, S, D = x.shape
        H = 32
        Dh = D // H
        W, dil = (8, 2)
        qkv = (lambda x, *d: x.permute(*d))((x @ wqkv).reshape(B, S, 3, H, Dh), 2, 0, 3, 1, 4)
        q, k, v = (qkv[0], qkv[1], qkv[2])
        scale = Dh ** (-0.5)
        pos = torch.arange(S)
        off = torch.arange(W) * dil
        idx = pos[:, None] - off[None, :]
        mask = idx >= 0
        idx_c = torch.where(mask, idx, 0).reshape(-1)
        kg = k[:, :, idx_c, :].reshape(B, H, S, W, Dh)
        vg = v[:, :, idx_c, :].reshape(B, H, S, W, Dh)
        logits = torch.einsum('bhsd,bhswd->bhsw', q, kg) * scale
        logits = torch.where(mask[None, None, :, :], logits, -1000000000.0)
        attn = _softmax(logits, axis=-1)
        o = torch.einsum('bhsw,bhswd->bhsd', attn, vg)
        return (lambda x, *d: x.permute(*d))(o, 0, 2, 1, 3).reshape(B, S, D) @ wo

    def _B_ref(x, w_in, w_sp, b_sp, w_out):
        B, S, D = x.shape
        F = w_in.shape[-1]
        Fh = F // 2
        z = _gelu(torch.einsum('bsd,df->bsf', x, w_in))
        z1 = z[..., :Fh].clone()
        z2 = _layernorm(z[..., Fh:], axis=-1)
        g = torch.einsum('ts,bsf->btf', w_sp, z2) + b_sp[None, :, None]
        return torch.einsum('bsf,fd->bsd', z1 * g, w_out)
    x = A_x
    xn = _layernorm(x, axis=-1)
    return x + _A_ref(xn, A_wqkv, A_wo) + _B_ref(xn, B_w_in, B_w_sp, B_b_sp, B_w_out)
```

```asm
; @launch grid=(256,1,1) block=(512,1,1) lds=163840
.amdgcn_target "amdgcn-amd-amdhsa--gfx950"
.text
.globl parallel_sum__sliding_local_dilated__mixer_gmlp__prompt_kernel
.p2align 8
.type parallel_sum__sliding_local_dilated__mixer_gmlp__prompt_kernel,@function
parallel_sum__sliding_local_dilated__mixer_gmlp__prompt_kernel:
    s_cmp_ge_u32 s2, 256
    s_cbranch_scc1 parallel_sum__sliding_local_dilated__mixer_gmlp__prompt_kernel_end1
    s_load_dwordx2 s[4:5], s[0:1], 80
    s_load_dwordx2 s[6:7], s[0:1], 32
    s_load_dwordx2 s[64:65], s[0:1], 8
    s_load_dwordx2 s[66:67], s[0:1], 40
    s_load_dwordx2 s[68:69], s[0:1], 0
    s_load_dwordx2 s[74:75], s[0:1], 72
    v_lshrrev_b32 v1, 6, v0
    v_and_b32 v0, 63, v0
    v_readfirstlane_b32 s33, v1
    s_and_b32 s34, s2, 7
    s_lshr_b32 s35, s2, 3
    v_lshlrev_b32 v1, 4, v0
    s_mov_b32 s101, 1
    s_mov_b32 s100, 0
    v_mov_b32 v244, 0
    v_mov_b32 v245, 0
    v_mov_b32 v246, 0
    v_mov_b32 v247, 0
    v_mov_b32 v248, 0
    s_and_b32 s36, s34, 1
    s_lshl_b32 s36, s36, 3
    s_and_b32 s37, s35, 7
    s_add_u32 s36, s36, s37
    s_lshr_b32 s37, s34, 1
    s_lshl_b32 s37, s37, 2
    s_lshr_b32 s38, s35, 3
    s_add_u32 s37, s37, s38
    s_lshr_b32 s32, s35, 4
    s_and_b32 s38, s34, 1
    s_lshl_b32 s38, s38, 2
    s_and_b32 s39, s35, 3
    s_add_u32 s38, s38, s39
    s_lshr_b32 s39, s34, 1
    s_lshl_b32 s50, s39, 1
    s_lshl_b32 s39, s39, 2
    s_lshr_b32 s51, s35, 2
    s_add_u32 s39, s39, s51
    s_bfe_u32 s51, s35, 0x10003
    s_add_u32 s50, s50, s51
    s_cmp_eq_u32 s32, 0
    s_cselect_b32 s38, s38, s36
    s_cselect_b32 s39, s39, s50
    s_lshl_b32 s44, s34, 4
    s_and_b32 s50, s35, 15
    s_add_u32 s44, s44, s50
    s_mov_b32 s3, s44
    v_and_b32 v2, 15, v0
    v_lshrrev_b32 v3, 4, v0
    s_mul_i32 s45, s44, 18432
    s_mul_i32 s46, s33, 5
    s_lshr_b32 s50, s33, 1
    s_and_b32 s50, s50, s33
    s_sub_u32 s46, s46, s50
    s_lshl_b32 s51, s46, 6
    s_add_u32 s45, s45, s51
    s_add_u32 s52, s45, 256
    s_cmp_lt_u32 s33, 2
    s_cselect_b32 s52, s52, 0x7fffffff
    s_cmp_lt_u32 s33, 4
    s_cselect_b32 s50, s32, 0
    v_mul_u32_u24 v4, 1152, v2
    v_lshl_add_u32 v7, v3, 4, v4
    s_mov_b32 s26, 2359296
    s_mov_b32 s27, 0x20000
    s_waitcnt lgkmcnt(0)
    s_mov_b32 s24, s68
    s_mov_b32 s25, s69
    s_cmp_eq_u32 s50, 0
    s_cbranch_scc1 parallel_sum__sliding_local_dilated__mixer_gmlp__prompt_kernel_nx9
    buffer_load_dwordx4 v[8:11], v7, s[24:27], s45 offen
    buffer_load_dwordx4 v[12:15], v7, s[24:27], s45 offen offset:64
    buffer_load_dwordx4 v[16:19], v7, s[24:27], s45 offen offset:128
    buffer_load_dwordx4 v[20:23], v7, s[24:27], s45 offen offset:192
    buffer_load_dwordx4 v[24:27], v7, s[24:27], s52 offen
    s_mul_i32 s52, s44, 18432
    buffer_load_ushort v94, v4, s[24:27], s52 offen
parallel_sum__sliding_local_dilated__mixer_gmlp__prompt_kernel_nx9:
    s_mov_b32 s8, s4
    s_mov_b32 s9, s5
    s_mov_b32 s10, 0x240000
    s_mov_b32 s11, 0x20000
    s_mov_b32 s12, s6
    s_mov_b32 s13, s7
    s_mov_b32 s14, 0x510000
    s_mov_b32 s15, 0x20000
    s_mov_b32 s76, s68
    s_mov_b32 s77, s69
    s_mov_b32 s78, 0x240000
    s_mov_b32 s79, 0x20000
    v_mov_b32 v100, 0
    v_mov_b32 v101, 0
    v_mov_b32 v102, 0
    v_mov_b32 v103, 0
    v_mov_b32 v104, 0
    v_mov_b32 v105, 0
    v_mov_b32 v106, 0
    s_cmp_lt_u32 s33, 4
    s_cbranch_scc1 parallel_sum__sliding_local_dilated__mixer_gmlp__prompt_kernel_ne10
    s_mov_b32 s28, s74
    s_mov_b32 s29, s75
    s_mov_b32 s30, 0x100
    s_mov_b32 s31, 0x20000
    s_xor_b32 s50, s33, 6
    s_or_b32 s50, s50, s2
    s_cmp_lg_u32 s50, 0
    s_cbranch_scc1 parallel_sum__sliding_local_dilated__mixer_gmlp__prompt_kernel_npub11
    s_memrealtime s[50:51]
    v_mov_b32 v4, 0
    s_waitcnt lgkmcnt(0)
    s_or_b32 s50, s50, 1
    v_mov_b32 v5, s50
    s_mov_b64 exec, 1
    buffer_store_dword v5, v4, s[28:31], 0 offen sc1
    s_mov_b64 exec, -1
parallel_sum__sliding_local_dilated__mixer_gmlp__prompt_kernel_npub11:
    s_sub_u32 s40, s33, 4
    s_lshl_b32 s41, s40, 12
    s_mul_i32 s42, s36, 147456
    s_mul_i32 s50, s40, 36864
    s_add_u32 s42, s42, s50
    s_mul_i32 s43, s37, 288
    s_add_u32 s43, s43, 4608
    s_add_u32 s47, s41, 16384
    s_lshl_b32 s48, s40, 9
    s_add_u32 s48, s48, 32768
    s_mov_b32 s49, 0
    v_lshrrev_b32 v106, 4, v0
    v_and_b32 v105, 7, v0
    v_xor_b32 v105, v105, v106
    v_lshrrev_b32 v106, 3, v0
    v_mul_u32_u24 v106, 1152, v106
    v_lshl_add_u32 v105, v105, 4, v106
    v_and_b32 v107, 64, v105
    v_lshlrev_b32 v107, 1, v107
    v_add_u32 v106, 64, v105
    v_sub_u32 v106, v106, v107
    s_lshl_b32 s51, s40, 8
    s_add_u32 m0, s41, s49
    s_nop 0
    buffer_load_dwordx4 v105, s[76:79], s42 offen lds
    s_add_u32 m0, m0, 1024
    s_add_u32 s50, s42, 9216
    buffer_load_dwordx4 v106, s[76:79], s50 offen lds
    s_add_u32 m0, m0, 1024
    s_add_u32 s50, s42, 18432
    buffer_load_dwordx4 v105, s[76:79], s50 offen lds
    s_add_u32 m0, m0, 1024
    s_add_u32 s50, s42, 27648
    buffer_load_dwordx4 v106, s[76:79], s50 offen lds
    s_add_u32 s42, s42, 128
    s_mov_b32 m0, s47
    v_add_u32 v2, s51, v0
    v_mul_u32_u24 v3, 3641, v2
    v_lshrrev_b32 v3, 16, v3
    v_mul_u32_u24 v4, 18, v3
    v_sub_u32 v2, v2, v4
    v_and_b32 v4, 4, v3
    v_and_b32 v5, 8, v3
    v_lshlrev_b32 v4, 1, v4
    v_lshrrev_b32 v5, 1, v5
    v_and_b32 v3, 0x33, v3
    v_or3_b32 v3, v3, v4, v5
    v_mul_u32_u24 v3, 9216, v3
    v_lshl_add_u32 v100, v2, 4, v3
    s_add_u32 s51, s51, 64
    buffer_load_dwordx4 v100, s[12:15], s43 offen lds
    s_add_u32 m0, m0, 1024
    v_add_u32 v2, s51, v0
    v_mul_u32_u24 v3, 3641, v2
    v_lshrrev_b32 v3, 16, v3
    v_mul_u32_u24 v4, 18, v3
    v_sub_u32 v2, v2, v4
    v_and_b32 v4, 4, v3
    v_and_b32 v5, 8, v3
    v_lshlrev_b32 v4, 1, v4
    v_lshrrev_b32 v5, 1, v5
    v_and_b32 v3, 0x33, v3
    v_or3_b32 v3, v3, v4, v5
    v_mul_u32_u24 v3, 9216, v3
    v_lshl_add_u32 v101, v2, 4, v3
    s_add_u32 s51, s51, 64
    buffer_load_dwordx4 v101, s[12:15], s43 offen lds
    s_add_u32 m0, m0, 1024
    v_add_u32 v2, s51, v0
    v_mul_u32_u24 v3, 3641, v2
    v_lshrrev_b32 v3, 16, v3
    v_mul_u32_u24 v4, 18, v3
    v_sub_u32 v2, v2, v4
    v_and_b32 v4, 4, v3
    v_and_b32 v5, 8, v3
    v_lshlrev_b32 v4, 1, v4
    v_lshrrev_b32 v5, 1, v5
    v_and_b32 v3, 0x33, v3
    v_or3_b32 v3, v3, v4, v5
    v_mul_u32_u24 v3, 9216, v3
    v_lshl_add_u32 v102, v2, 4, v3
    s_add_u32 s51, s51, 64
    buffer_load_dwordx4 v102, s[12:15], s43 offen lds
    s_add_u32 m0, m0, 1024
    v_add_u32 v2, s51, v0
    v_mul_u32_u24 v3, 3641, v2
    v_lshrrev_b32 v3, 16, v3
    v_mul_u32_u24 v4, 18, v3
    v_sub_u32 v2, v2, v4
    v_and_b32 v4, 4, v3
    v_and_b32 v5, 8, v3
    v_lshlrev_b32 v4, 1, v4
    v_lshrrev_b32 v5, 1, v5
    v_and_b32 v3, 0x33, v3
    v_or3_b32 v3, v3, v4, v5
    v_mul_u32_u24 v3, 9216, v3
    v_lshl_add_u32 v103, v2, 4, v3
    s_add_u32 s51, s51, 64
    buffer_load_dwordx4 v103, s[12:15], s43 offen lds
    s_add_u32 m0, m0, 1024
    s_lshl_b32 s51, s40, 5
    s_add_u32 s51, s51, 1024
    v_add_u32 v2, s51, v0
    v_mul_u32_u24 v3, 3641, v2
    v_lshrrev_b32 v3, 16, v3
    v_mul_u32_u24 v4, 18, v3
    v_sub_u32 v2, v2, v4
    v_and_b32 v4, 4, v3
    v_and_b32 v5, 8, v3
    v_lshlrev_b32 v4, 1, v4
    v_lshrrev_b32 v5, 1, v5
    v_and_b32 v3, 0x33, v3
    v_or3_b32 v3, v3, v4, v5
    v_mul_u32_u24 v3, 9216, v3
    v_lshl_add_u32 v104, v2, 4, v3
    s_add_u32 m0, s48, s49
    s_mov_b32 exec_hi, 0
    buffer_load_dwordx4 v104, s[12:15], s43 offen lds
    s_mov_b32 exec_hi, -1
    s_add_u32 s43, s43, 589824
    s_mov_b32 s49, 51200
    s_add_u32 m0, s41, s49
    s_nop 0
    buffer_load_dwordx4 v105, s[76:79], s42 offen lds
    s_add_u32 m0, m0, 1024
    s_add_u32 s50, s42, 9216
    buffer_load_dwordx4 v106, s[76:79], s50 offen lds
    s_add_u32 m0, m0, 1024
    s_add_u32 s50, s42, 18432
    buffer_load_dwordx4 v105, s[76:79], s50 offen lds
    s_add_u32 m0, m0, 1024
    s_add_u32 s50, s42, 27648
    buffer_load_dwordx4 v106, s[76:79], s50 offen lds
    s_add_u32 s42, s42, 128
    s_add_u32 m0, s47, s49
    s_nop 0
    buffer_load_dwordx4 v100, s[12:15], s43 offen lds
    s_add_u32 m0, m0, 1024
    s_nop 0
    buffer_load_dwordx4 v101, s[12:15], s43 offen lds
    s_add_u32 m0, m0, 1024
    s_nop 0
    buffer_load_dwordx4 v102, s[12:15], s43 offen lds
    s_add_u32 m0, m0, 1024
    s_nop 0
    buffer_load_dwordx4 v103, s[12:15], s43 offen lds
    s_add_u32 m0, s48, s49
    s_mov_b32 exec_hi, 0
    buffer_load_dwordx4 v104, s[12:15], s43 offen lds
    s_mov_b32 exec_hi, -1
    s_add_u32 s43, s43, 589824
parallel_sum__sliding_local_dilated__mixer_gmlp__prompt_kernel_ne10:
    s_add_u32 s84, s4, 0x3450000
    s_addc_u32 s85, s5, 0
    s_mov_b32 s86, 0x24000
    s_mov_b32 s87, 0x20000
    s_cmp_lg_u32 s33, 7
    s_cbranch_scc1 parallel_sum__sliding_local_dilated__mixer_gmlp__prompt_kernel_nz15
    s_lshl_b32 s50, s36, 11
    s_lshl_b32 s51, s37, 7
    s_add_u32 s50, s50, s51
    s_lshl_b32 s51, s37, 11
    s_lshl_b32 s52, s36, 7
    s_add_u32 s51, s51, s52
    s_add_u32 s51, s51, 65536
    s_add_u32 s52, s50, 98304
    s_add_u32 s50, s50, 32768
    s_lshl_b32 s53, s2, 2
    s_add_u32 s53, s53, 12288
    v_mov_b32 v4, s50
    v_writelane_b32 v4, s51, 1
    v_writelane_b32 v4, s52, 2
    v_writelane_b32 v4, s53, 3
    s_mov_b64 exec, 15
    buffer_load_dword v252, v4, s[84:87], 0 offen
    s_mov_b64 exec, -1
parallel_sum__sliding_local_dilated__mixer_gmlp__prompt_kernel_nz15:
    s_cmp_eq_u32 s32, 0
    s_cbranch_scc1 parallel_sum__sliding_local_dilated__mixer_gmlp__prompt_kernel_w312
    s_cmp_ge_u32 s33, 4
    s_cbranch_scc1 parallel_sum__sliding_local_dilated__mixer_gmlp__prompt_kernel_n614
    v_mul_u32_u24 v5, 144, v2
    v_add_u32 v5, 102400, v5
    s_lshl_b32 s47, s33, 5
    v_lshl_add_u32 v6, v3, 3, v5
    v_add_u32 v6, s47, v6
    s_lshl_b32 s47, s44, 11
    s_add_u32 s50, s46, 0
    s_lshr_b32 s51, s50, 1
    s_lshl_b32 s51, s51, 18
    s_and_b32 s50, s50, 1
    s_lshl_b32 s50, s50, 10
    s_add_u32 s51, s51, s50
    s_add_u32 s53, s51, s47
    s_add_u32 s50, s46, 1
    s_lshr_b32 s51, s50, 1
    s_lshl_b32 s51, s51, 18
    s_and_b32 s50, s50, 1
    s_lshl_b32 s50, s50, 10
    s_add_u32 s51, s51, s50
    s_add_u32 s54, s51, s47
    s_add_u32 s50, s46, 2
    s_lshr_b32 s51, s50, 1
    s_lshl_b32 s51, s51, 18
    s_and_b32 s50, s50, 1
    s_lshl_b32 s50, s50, 10
    s_add_u32 s51, s51, s50
    s_add_u32 s55, s51, s47
    s_add_u32 s50, s46, 3
    s_lshr_b32 s51, s50, 1
    s_lshl_b32 s51, s51, 18
    s_and_b32 s50, s50, 1
    s_lshl_b32 s50, s50, 10
    s_add_u32 s51, s51, s50
    s_add_u32 s56, s51, s47
    s_add_u32 s50, s46, 4
    s_lshr_b32 s51, s50, 1
    s_lshl_b32 s51, s51, 18
    s_and_b32 s50, s50, 1
    s_lshl_b32 s50, s50, 10
    s_add_u32 s51, s51, s50
    s_add_u32 s57, s51, s47
    s_cmp_lt_u32 s33, 2
    s_cselect_b32 s57, s57, 0x7fffffff
    s_waitcnt vmcnt(0)
    v_lshlrev_b32 v28, 16, v8
    v_and_b32 v29, 0xffff0000, v8
    v_lshlrev_b32 v30, 16, v9
    v_and_b32 v31, 0xffff0000, v9
    v_lshlrev_b32 v32, 16, v10
    v_and_b32 v33, 0xffff0000, v10
    v_lshlrev_b32 v34, 16, v11
    v_and_b32 v35, 0xffff0000, v11
    v_lshlrev_b32 v36, 16, v12
    v_and_b32 v37, 0xffff0000, v12
    v_lshlrev_b32 v38, 16, v13
    v_and_b32 v39, 0xffff0000, v13
    v_lshlrev_b32 v40, 16, v14
    v_and_b32 v41, 0xffff0000, v14
    v_lshlrev_b32 v42, 16, v15
    v_and_b32 v43, 0xffff0000, v15
    v_lshlrev_b32 v44, 16, v16
    v_and_b32 v45, 0xffff0000, v16
    v_lshlrev_b32 v46, 16, v17
    v_and_b32 v47, 0xffff0000, v17
    v_lshlrev_b32 v48, 16, v18
    v_and_b32 v49, 0xffff0000, v18
    v_lshlrev_b32 v50, 16, v19
    v_and_b32 v51, 0xffff0000, v19
    v_lshlrev_b32 v52, 16, v20
    v_and_b32 v53, 0xffff0000, v20
    v_lshlrev_b32 v54, 16, v21
    v_and_b32 v55, 0xffff0000, v21
    v_lshlrev_b32 v56, 16, v22
    v_and_b32 v57, 0xffff0000, v22
    v_lshlrev_b32 v58, 16, v23
    v_and_b32 v59, 0xffff0000, v23
    v_lshlrev_b32 v60, 16, v24
    v_and_b32 v61, 0xffff0000, v24
    v_lshlrev_b32 v62, 16, v25
    v_and_b32 v63, 0xffff0000, v25
    v_lshlrev_b32 v64, 16, v26
    v_and_b32 v65, 0xffff0000, v26
    v_lshlrev_b32 v66, 16, v27
    v_and_b32 v67, 0xffff0000, v27
    v_lshlrev_b32 v94, 16, v94
    v_mov_b32 v95, v94
    v_pk_add_f32 v[74:75], v[28:29], v[94:95] neg_lo:[0,1] neg_hi:[0,1]
    v_pk_add_f32 v[76:77], v[30:31], v[94:95] neg_lo:[0,1] neg_hi:[0,1]
    v_pk_mul_f32 v[70:71], v[74:75], v[74:75]
    v_pk_add_f32 v[68:69], v[74:75], v[76:77]
    v_pk_mul_f32 v[72:73], v[76:77], v[76:77]
    v_pk_add_f32 v[78:79], v[32:33], v[94:95] neg_lo:[0,1] neg_hi:[0,1]
    v_pk_add_f32 v[68:69], v[68:69], v[78:79]
    v_pk_fma_f32 v[70:71], v[78:79], v[78:79], v[70:71]
    v_pk_add_f32 v[80:81], v[34:35], v[94:95] neg_lo:[0,1] neg_hi:[0,1]
    v_pk_add_f32 v[68:69], v[68:69], v[80:81]
    v_pk_fma_f32 v[72:73], v[80:81], v[80:81], v[72:73]
    v_pk_add_f32 v[74:75], v[36:37], v[94:95] neg_lo:[0,1] neg_hi:[0,1]
    v_pk_add_f32 v[68:69], v[68:69], v[74:75]
    v_pk_fma_f32 v[70:71], v[74:75], v[74:75], v[70:71]
    v_pk_add_f32 v[76:77], v[38:39], v[94:95] neg_lo:[0,1] neg_hi:[0,1]
    v_pk_add_f32 v[68:69], v[68:69], v[76:77]
    v_pk_fma_f32 v[72:73], v[76:77], v[76:77], v[72:73]
    v_pk_add_f32 v[78:79], v[40:41], v[94:95] neg_lo:[0,1] neg_hi:[0,1]
    v_pk_add_f32 v[68:69], v[68:69], v[78:79]
    v_pk_fma_f32 v[70:71], v[78:79], v[78:79], v[70:71]
    v_pk_add_f32 v[80:81], v[42:43], v[94:95] neg_lo:[0,1] neg_hi:[0,1]
    v_pk_add_f32 v[68:69], v[68:69], v[80:81]
    v_pk_fma_f32 v[72:73], v[80:81], v[80:81], v[72:73]
    v_pk_add_f32 v[74:75], v[44:45], v[94:95] neg_lo:[0,1] neg_hi:[0,1]
    v_pk_add_f32 v[68:69], v[68:69], v[74:75]
    v_pk_fma_f32 v[70:71], v[74:75], v[74:75], v[70:71]
    v_pk_add_f32 v[76:77], v[46:47], v[94:95] neg_lo:[0,1] neg_hi:[0,1]
    v_pk_add_f32 v[68:69], v[68:69], v[76:77]
    v_pk_fma_f32 v[72:73], v[76:77], v[76:77], v[72:73]
    v_pk_add_f32 v[78:79], v[48:49], v[94:95] neg_lo:[0,1] neg_hi:[0,1]
    v_pk_add_f32 v[68:69], v[68:69], v[78:79]
    v_pk_fma_f32 v[70:71], v[78:79], v[78:79], v[70:71]
    v_pk_add_f32 v[80:81], v[50:51], v[94:95] neg_lo:[0,1] neg_hi:[0,1]
    v_pk_add_f32 v[68:69], v[68:69], v[80:81]
    v_pk_fma_f32 v[72:73], v[80:81], v[80:81], v[72:73]
    v_pk_add_f32 v[74:75], v[52:53], v[94:95] neg_lo:[0,1] neg_hi:[0,1]
    v_pk_add_f32 v[68:69], v[68:69], v[74:75]
    v_pk_fma_f32 v[70:71], v[74:75], v[74:75], v[70:71]
    v_pk_add_f32 v[76:77], v[54:55], v[94:95] neg_lo:[0,1] neg_hi:[0,1]
    v_pk_add_f32 v[68:69], v[68:69], v[76:77]
    v_pk_fma_f32 v[72:73], v[76:77], v[76:77], v[72:73]
    v_pk_add_f32 v[78:79], v[56:57], v[94:95] neg_lo:[0,1] neg_hi:[0,1]
    v_pk_add_f32 v[68:69], v[68:69], v[78:79]
    v_pk_fma_f32 v[70:71], v[78:79], v[78:79], v[70:71]
    v_pk_add_f32 v[80:81], v[58:59], v[94:95] neg_lo:[0,1] neg_hi:[0,1]
    v_pk_add_f32 v[68:69], v[68:69], v[80:81]
    v_pk_fma_f32 v[72:73], v[80:81], v[80:81], v[72:73]
    s_cmp_ge_u32 s33, 2
    s_cbranch_scc1 parallel_sum__sliding_local_dilated__mixer_gmlp__prompt_kernel_l417
    v_pk_add_f32 v[74:75], v[60:61], v[94:95] neg_lo:[0,1] neg_hi:[0,1]
    v_pk_add_f32 v[68:69], v[68:69], v[74:75]
    v_pk_fma_f32 v[70:71], v[74:75], v[74:75], v[70:71]
    v_pk_add_f32 v[76:77], v[62:63], v[94:95] neg_lo:[0,1] neg_hi:[0,1]
    v_pk_add_f32 v[68:69], v[68:69], v[76:77]
    v_pk_fma_f32 v[72:73], v[76:77], v[76:77], v[72:73]
    v_pk_add_f32 v[78:79], v[64:65], v[94:95] neg_lo:[0,1] neg_hi:[0,1]
    v_pk_add_f32 v[68:69], v[68:69], v[78:79]
    v_pk_fma_f32 v[70:71], v[78:79], v[78:79], v[70:71]
    v_pk_add_f32 v[80:81], v[66:67], v[94:95] neg_lo:[0,1] neg_hi:[0,1]
    v_pk_add_f32 v[68:69], v[68:69], v[80:81]
    v_pk_fma_f32 v[72:73], v[80:81], v[80:81], v[72:73]
parallel_sum__sliding_local_dilated__mixer_gmlp__prompt_kernel_l417:
    v_pk_add_f32 v[70:71], v[70:71], v[72:73]
    v_add_f32 v68, v68, v69
    v_add_f32 v69, v70, v71
    ds_write_b64 v6, v[68:69]
    v_mov_b32 v100, v94
    s_waitcnt lgkmcnt(0)
    s_barrier
    ds_read_b128 v[68:71], v5 offset:0
    ds_read_b128 v[72:75], v5 offset:16
    ds_read_b128 v[76:79], v5 offset:32
    ds_read_b128 v[80:83], v5 offset:48
    ds_read_b128 v[84:87], v5 offset:64
    ds_read_b128 v[88:91], v5 offset:80
    ds_read_b128 v[92:95], v5 offset:96
    ds_read_b128 v[96:99], v5 offset:112
    s_waitcnt lgkmcnt(0)
    v_pk_add_f32 v[68:69], v[68:69], v[84:85]
    v_pk_add_f32 v[70:71], v[70:71], v[86:87]
    v_pk_add_f32 v[72:73], v[72:73], v[88:89]
    v_pk_add_f32 v[74:75], v[74:75], v[90:91]
    v_pk_add_f32 v[76:77], v[76:77], v[92:93]
    v_pk_add_f32 v[78:79], v[78:79], v[94:95]
    v_pk_add_f32 v[80:81], v[80:81], v[96:97]
    v_pk_add_f32 v[82:83], v[82:83], v[98:99]
    v_pk_add_f32 v[68:69], v[68:69], v[76:77]
    v_pk_add_f32 v[70:71], v[70:71], v[78:79]
    v_pk_add_f32 v[72:73], v[72:73], v[80:81]
    v_pk_add_f32 v[74:75], v[74:75], v[82:83]
    v_pk_add_f32 v[68:69], v[68:69], v[72:73]
    v_pk_add_f32 v[70:71], v[70:71], v[74:75]
    v_pk_add_f32 v[68:69], v[68:69], v[70:71]
    v_mul_f32 v96, 0x3ae38e39, v68
    v_mul_f32 v98, 0x3ae38e39, v69
    v_fma_f32 v98, -v96, v96, v98
    v_max_f32 v98, 0, v98
    v_add_f32 v96, v96, v100
    v_cvt_pk_bf16_f32 v96, v96, v96
    v_lshlrev_b32 v96, 16, v96
    v_cvt_pk_bf16_f32 v98, v98, v98
    v_lshlrev_b32 v98, 16, v98
    v_mov_b32 v97, v96
    v_add_f32 v98, 0x3727c5ac, v98
    v_cvt_pk_bf16_f32 v98, v98, v98
    v_lshlrev_b32 v98, 16, v98
    v_sqrt_f32 v98, v98
    v_pk_add_f32 v[28:29], v[28:29], v[96:97] neg_lo:[0,1] neg_hi:[0,1]
    v_pk_add_f32 v[30:31], v[30:31], v[96:97] neg_lo:[0,1] neg_hi:[0,1]
    v_pk_add_f32 v[32:33], v[32:33], v[96:97] neg_lo:[0,1] neg_hi:[0,1]
    v_pk_add_f32 v[34:35], v[34:35], v[96:97] neg_lo:[0,1] neg_hi:[0,1]
    v_pk_add_f32 v[36:37], v[36:37], v[96:97] neg_lo:[0,1] neg_hi:[0,1]
    v_pk_add_f32 v[38:39], v[38:39], v[96:97] neg_lo:[0,1] neg_hi:[0,1]
    v_pk_add_f32 v[40:41], v[40:41], v[96:97] neg_lo:[0,1] neg_hi:[0,1]
    v_pk_add_f32 v[42:43], v[42:43], v[96:97] neg_lo:[0,1] neg_hi:[0,1]
    v_pk_add_f32 v[44:45], v[44:45], v[96:97] neg_lo:[0,1] neg_hi:[0,1]
    v_pk_add_f32 v[46:47], v[46:47], v[96:97] neg_lo:[0,1] neg_hi:[0,1]
    v_pk_add_f32 v[48:49], v[48:49], v[96:97] neg_lo:[0,1] neg_hi:[0,1]
    v_pk_add_f32 v[50:51], v[50:51], v[96:97] neg_lo:[0,1] neg_hi:[0,1]
    v_pk_add_f32 v[52:53], v[52:53], v[96:97] neg_lo:[0,1] neg_hi:[0,1]
    v_pk_add_f32 v[54:55], v[54:55], v[96:97] neg_lo:[0,1] neg_hi:[0,1]
    v_pk_add_f32 v[56:57], v[56:57], v[96:97] neg_lo:[0,1] neg_hi:[0,1]
    v_pk_add_f32 v[58:59], v[58:59], v[96:97] neg_lo:[0,1] neg_hi:[0,1]
    v_pk_add_f32 v[60:61], v[60:61], v[96:97] neg_lo:[0,1] neg_hi:[0,1]
    v_pk_add_f32 v[62:63], v[62:63], v[96:97] neg_lo:[0,1] neg_hi:[0,1]
    v_pk_add_f32 v[64:65], v[64:65], v[96:97] neg_lo:[0,1] neg_hi:[0,1]
    v_pk_add_f32 v[66:67], v[66:67], v[96:97] neg_lo:[0,1] neg_hi:[0,1]
    v_cvt_pk_bf16_f32 v98, v98, v98
    v_lshlrev_b32 v98, 16, v98
    v_rcp_f32 v98, v98
    v_cvt_pk_bf16_f32 v8, v28, v29
    v_cvt_pk_bf16_f32 v9, v30, v31
    v_cvt_pk_bf16_f32 v10, v32, v33
    v_cvt_pk_bf16_f32 v11, v34, v35
    v_cvt_pk_bf16_f32 v12, v36, v37
    v_cvt_pk_bf16_f32 v13, v38, v39
    v_cvt_pk_bf16_f32 v14, v40, v41
    v_cvt_pk_bf16_f32 v15, v42, v43
    v_cvt_pk_bf16_f32 v16, v44, v45
    v_cvt_pk_bf16_f32 v17, v46, v47
    v_cvt_pk_bf16_f32 v18, v48, v49
    v_cvt_pk_bf16_f32 v19, v50, v51
    v_cvt_pk_bf16_f32 v20, v52, v53
    v_cvt_pk_bf16_f32 v21, v54, v55
    v_cvt_pk_bf16_f32 v22, v56, v57
    v_cvt_pk_bf16_f32 v23, v58, v59
    v_cvt_pk_bf16_f32 v24, v60, v61
    v_cvt_pk_bf16_f32 v25, v62, v63
    v_cvt_pk_bf16_f32 v26, v64, v65
    v_cvt_pk_bf16_f32 v27, v66, v67
    v_mov_b32 v99, v98
    v_lshlrev_b32 v28, 16, v8
    v_and_b32 v29, 0xffff0000, v8
    v_lshlrev_b32 v30, 16, v9
    v_and_b32 v31, 0xffff0000, v9
    v_lshlrev_b32 v32, 16, v10
    v_and_b32 v33, 0xffff0000, v10
    v_lshlrev_b32 v34, 16, v11
    v_and_b32 v35, 0xffff0000, v11
    v_lshlrev_b32 v36, 16, v12
    v_and_b32 v37, 0xffff0000, v12
    v_lshlrev_b32 v38, 16, v13
    v_and_b32 v39, 0xffff0000, v13
    v_lshlrev_b32 v40, 16, v14
    v_and_b32 v41, 0xffff0000, v14
    v_lshlrev_b32 v42, 16, v15
    v_and_b32 v43, 0xffff0000, v15
    v_lshlrev_b32 v44, 16, v16
    v_and_b32 v45, 0xffff0000, v16
    v_lshlrev_b32 v46, 16, v17
    v_and_b32 v47, 0xffff0000, v17
    v_lshlrev_b32 v48, 16, v18
    v_and_b32 v49, 0xffff0000, v18
    v_lshlrev_b32 v50, 16, v19
    v_and_b32 v51, 0xffff0000, v19
    v_lshlrev_b32 v52, 16, v20
    v_and_b32 v53, 0xffff0000, v20
    v_lshlrev_b32 v54, 16, v21
    v_and_b32 v55, 0xffff0000, v21
    v_lshlrev_b32 v56, 16, v22
    v_and_b32 v57, 0xffff0000, v22
    v_lshlrev_b32 v58, 16, v23
    v_and_b32 v59, 0xffff0000, v23
    v_lshlrev_b32 v60, 16, v24
    v_and_b32 v61, 0xffff0000, v24
    v_lshlrev_b32 v62, 16, v25
    v_and_b32 v63, 0xffff0000, v25
    v_lshlrev_b32 v64, 16, v26
    v_and_b32 v65, 0xffff0000, v26
    v_lshlrev_b32 v66, 16, v27
    v_and_b32 v67, 0xffff0000, v27
    v_pk_mul_f32 v[28:29], v[28:29], v[98:99]
    v_pk_mul_f32 v[30:31], v[30:31], v[98:99]
    v_pk_mul_f32 v[32:33], v[32:33], v[98:99]
    v_pk_mul_f32 v[34:35], v[34:35], v[98:99]
    v_pk_mul_f32 v[36:37], v[36:37], v[98:99]
    v_pk_mul_f32 v[38:39], v[38:39], v[98:99]
    v_pk_mul_f32 v[40:41], v[40:41], v[98:99]
    v_pk_mul_f32 v[42:43], v[42:43], v[98:99]
    v_pk_mul_f32 v[44:45], v[44:45], v[98:99]
    v_pk_mul_f32 v[46:47], v[46:47], v[98:99]
    v_pk_mul_f32 v[48:49], v[48:49], v[98:99]
    v_pk_mul_f32 v[50:51], v[50:51], v[98:99]
    v_pk_mul_f32 v[52:53], v[52:53], v[98:99]
    v_pk_mul_f32 v[54:55], v[54:55], v[98:99]
    v_pk_mul_f32 v[56:57], v[56:57], v[98:99]
    v_pk_mul_f32 v[58:59], v[58:59], v[98:99]
    v_pk_mul_f32 v[60:61], v[60:61], v[98:99]
    v_pk_mul_f32 v[62:63], v[62:63], v[98:99]
    v_pk_mul_f32 v[64:65], v[64:65], v[98:99]
    v_pk_mul_f32 v[66:67], v[66:67], v[98:99]
    v_cvt_pk_bf16_f32 v8, v28, v29
    v_cvt_pk_bf16_f32 v9, v30, v31
    v_cvt_pk_bf16_f32 v10, v32, v33
    v_cvt_pk_bf16_f32 v11, v34, v35
    v_cvt_pk_bf16_f32 v12, v36, v37
    v_cvt_pk_bf16_f32 v13, v38, v39
    v_cvt_pk_bf16_f32 v14, v40, v41
    v_cvt_pk_bf16_f32 v15, v42, v43
    v_cvt_pk_bf16_f32 v16, v44, v45
    v_cvt_pk_bf16_f32 v17, v46, v47
    v_cvt_pk_bf16_f32 v18, v48, v49
    v_cvt_pk_bf16_f32 v19, v50, v51
    v_cvt_pk_bf16_f32 v20, v52, v53
    v_cvt_pk_bf16_f32 v21, v54, v55
    v_cvt_pk_bf16_f32 v22, v56, v57
    v_cvt_pk_bf16_f32 v23, v58, v59
    v_cvt_pk_bf16_f32 v24, v60, v61
    v_cvt_pk_bf16_f32 v25, v62, v63
    v_cvt_pk_bf16_f32 v26, v64, v65
    v_cvt_pk_bf16_f32 v27, v66, v67
    buffer_store_dwordx4 v[8:11], v1, s[8:11], s53 offen sc1
    buffer_store_dwordx4 v[12:15], v1, s[8:11], s54 offen sc1
    buffer_store_dwordx4 v[16:19], v1, s[8:11], s55 offen sc1
    buffer_store_dwordx4 v[20:23], v1, s[8:11], s56 offen sc1
    buffer_store_dwordx4 v[24:27], v1, s[8:11], s57 offen sc1
    s_cmp_lg_u32 s33, 0
    s_cbranch_scc1 parallel_sum__sliding_local_dilated__mixer_gmlp__prompt_kernel_p0d13
    s_add_u32 s20, s4, 0x3440000
    s_addc_u32 s21, s5, 0
    s_mov_b32 s22, 0x4000
    s_mov_b32 s23, 0x20000
    v_sub_f32 v96, 0, v96
    v_cmp_gt_u32 vcc, 16, v0
    v_lshlrev_b32 v97, 2, v0
    s_lshl_b32 s45, s44, 7
    v_cndmask_b32 v96, v98, v96, vcc
    s_mov_b32 exec_hi, 0
    buffer_store_dword v96, v97, s[20:23], s45 offen sc1
    s_mov_b32 exec_hi, -1
    s_branch parallel_sum__sliding_local_dilated__mixer_gmlp__prompt_kernel_p0d13
parallel_sum__sliding_local_dilated__mixer_gmlp__prompt_kernel_n614:
    s_add_u32 s20, s4, 0x3400000
    s_addc_u32 s21, s5, 0
    s_mov_b32 s22, 0x4000
    s_mov_b32 s23, 0x20000
    v_mov_b32 v4, 0
    v_lshlrev_b32 v5, 2, v0
    s_lshl_b32 s45, s44, 7
    s_cmp_lg_u32 s33, 7
    s_cbranch_scc1 parallel_sum__sliding_local_dilated__mixer_gmlp__prompt_kernel_z718
    s_mov_b32 exec_hi, 0
    buffer_store_dword v4, v5, s[20:23], s45 offen sc1
    s_mov_b32 exec_hi, -1
parallel_sum__sliding_local_dilated__mixer_gmlp__prompt_kernel_z718:
    s_barrier
    s_branch parallel_sum__sliding_local_dilated__mixer_gmlp__prompt_kernel_p0d13
parallel_sum__sliding_local_dilated__mixer_gmlp__prompt_kernel_w312:
    s_cmp_ge_u32 s33, 4
    s_cbranch_scc1 parallel_sum__sliding_local_dilated__mixer_gmlp__prompt_kernel_nw19
    s_lshl_b32 s45, s33, 7
    s_add_u32 s45, s45, s44
    s_lshl_b32 s51, s45, 6
    v_add_u32 v243, s51, v0
    s_mov_b32 s52, 116509
    v_mul_lo_u32 v242, s52, v243
    v_lshrrev_b32 v242, 22, v242
    v_lshlrev_b32 v243, 7, v243
    v_mul_u32_u24 v242, 4608, v242
    v_add_u32 v242, v243, v242
    s_mov_b32 s51, 0x7fffffff
    s_cmp_lt_u32 s45, 324
    s_cselect_b32 s50, 4608, s51
    s_cselect_b32 s51, 0, s51
    buffer_load_dword v252, v242, s[12:15], s50 offen
    buffer_load_dword v252, v242, s[12:15], s51 offen
    s_sub_u32 s45, 511, s45
    s_cmp_ge_u32 s45, 288
    s_cbranch_scc1 parallel_sum__sliding_local_dilated__mixer_gmlp__prompt_kernel_nw19
    s_mov_b32 s24, s64
    s_mov_b32 s25, s65
    s_mov_b32 s26, 1990656
    s_mov_b32 s27, 0x20000
    s_lshr_b32 s46, s45, 4
    s_bfe_u32 s47, s45, 0x30001
    s_mul_i32 s48, s46, 110592
    s_mul_i32 s50, s47, 144
    s_add_u32 s48, s48, s50
    s_mul_i32 s49, s47, 9
    s_lshr_b32 s50, s46, 1
    s_add_u32 s49, s49, s50
    s_mul_i32 s49, s49, 28672
    s_and_b32 s56, s45, 1
    s_mul_i32 s50, s56, 14336
    s_add_u32 s49, s49, s50
    s_mul_i32 s56, s56, 14
    s_movk_i32 s52, 14
    s_movk_i32 s53, 4682
    s_movk_i32 s54, 3456
    s_movk_i32 s55, 1008
    s_and_b32 s50, s46, 1
    s_lshl_b32 s50, s50, 10
    s_add_u32 s49, s49, s50
    s_mul_i32 s57, s33, 7168
    s_add_u32 s57, s57, 86016
    s_mov_b32 m0, s57
    s_add_u32 s20, s4, 0x1000000
    s_addc_u32 s21, s5, 0
    s_mov_b32 s22, 0x1f8000
    s_mov_b32 s23, 0x20000
    v_add_u32 v2, 0, v0
    v_mul_u32_u24 v3, s53, v2
    v_lshrrev_b32 v3, 16, v3
    v_mul_u32_u24 v4, s52, v3
    v_sub_u32 v2, v2, v4
    v_add_u32 v2, s56, v2
    v_mul_u32_u24 v4, 57, v2
    v_lshrrev_b32 v4, 9, v4
    v_mul_u32_u24 v5, s54, v3
    v_lshl_add_u32 v5, v2, 4, v5
    v_mad_u32_u24 v5, v4, s55, v5
    v_lshrrev_b32 v3, 5, v3
    v_add_u32 v2, 5, v2
    v_lshrrev_b32 v2, 5, v2
    v_or_b32 v3, v3, v2
    v_lshl_or_b32 v5, v3, 30, v5
    buffer_load_dwordx4 v5, s[24:27], s48 offen lds
    s_add_u32 m0, m0, 1024
    v_add_u32 v2, 64, v0
    v_mul_u32_u24 v3, s53, v2
    v_lshrrev_b32 v3, 16, v3
    v_mul_u32_u24 v4, s52, v3
    v_sub_u32 v2, v2, v4
    v_add_u32 v2, s56, v2
    v_mul_u32_u24 v4, 57, v2
    v_lshrrev_b32 v4, 9, v4
    v_mul_u32_u24 v5, s54, v3
    v_lshl_add_u32 v5, v2, 4, v5
    v_mad_u32_u24 v5, v4, s55, v5
    v_lshrrev_b32 v3, 5, v3
    v_add_u32 v2, 5, v2
    v_lshrrev_b32 v2, 5, v2
    v_or_b32 v3, v3, v2
    v_lshl_or_b32 v5, v3, 30, v5
    buffer_load_dwordx4 v5, s[24:27], s48 offen lds
    s_add_u32 m0, m0, 1024
    v_add_u32 v2, 128, v0
    v_mul_u32_u24 v3, s53, v2
    v_lshrrev_b32 v3, 16, v3
    v_mul_u32_u24 v4, s52, v3
    v_sub_u32 v2, v2, v4
    v_add_u32 v2, s56, v2
    v_mul_u32_u24 v4, 57, v2
    v_lshrrev_b32 v4, 9, v4
    v_mul_u32_u24 v5, s54, v3
    v_lshl_add_u32 v5, v2, 4, v5
    v_mad_u32_u24 v5, v4, s55, v5
    v_lshrrev_b32 v3, 5, v3
    v_add_u32 v2, 5, v2
    v_lshrrev_b32 v2, 5, v2
    v_or_b32 v3, v3, v2
    v_lshl_or_b32 v5, v3, 30, v5
    buffer_load_dwordx4 v5, s[24:27], s48 offen lds
    s_add_u32 m0, m0, 1024
    v_add_u32 v2, 192, v0
    v_mul_u32_u24 v3, s53, v2
    v_lshrrev_b32 v3, 16, v3
    v_mul_u32_u24 v4, s52, v3
    v_sub_u32 v2, v2, v4
    v_add_u32 v2, s56, v2
    v_mul_u32_u24 v4, 57, v2
    v_lshrrev_b32 v4, 9, v4
    v_mul_u32_u24 v5, s54, v3
    v_lshl_add_u32 v5, v2, 4, v5
    v_mad_u32_u24 v5, v4, s55, v5
    v_lshrrev_b32 v3, 5, v3
    v_add_u32 v2, 5, v2
    v_lshrrev_b32 v2, 5, v2
    v_or_b32 v3, v3, v2
    v_lshl_or_b32 v5, v3, 30, v5
    buffer_load_dwordx4 v5, s[24:27], s48 offen lds
    s_add_u32 m0, m0, 1024
    v_add_u32 v2, 256, v0
    v_mul_u32_u24 v3, s53, v2
    v_lshrrev_b32 v3, 16, v3
    v_mul_u32_u24 v4, s52, v3
    v_sub_u32 v2, v2, v4
    v_add_u32 v2, s56, v2
    v_mul_u32_u24 v4, 57, v2
    v_lshrrev_b32 v4, 9, v4
    v_mul_u32_u24 v5, s54, v3
    v_lshl_add_u32 v5, v2, 4, v5
    v_mad_u32_u24 v5, v4, s55, v5
    v_lshrrev_b32 v3, 5, v3
    v_add_u32 v2, 5, v2
    v_lshrrev_b32 v2, 5, v2
    v_or_b32 v3, v3, v2
    v_lshl_or_b32 v5, v3, 30, v5
    buffer_load_dwordx4 v5, s[24:27], s48 offen lds
    s_add_u32 m0, m0, 1024
    v_add_u32 v2, 320, v0
    v_mul_u32_u24 v3, s53, v2
    v_lshrrev_b32 v3, 16, v3
    v_mul_u32_u24 v4, s52, v3
    v_sub_u32 v2, v2, v4
    v_add_u32 v2, s56, v2
    v_mul_u32_u24 v4, 57, v2
    v_lshrrev_b32 v4, 9, v4
    v_mul_u32_u24 v5, s54, v3
    v_lshl_add_u32 v5, v2, 4, v5
    v_mad_u32_u24 v5, v4, s55, v5
    v_lshrrev_b32 v3, 5, v3
    v_add_u32 v2, 5, v2
    v_lshrrev_b32 v2, 5, v2
    v_or_b32 v3, v3, v2
    v_lshl_or_b32 v5, v3, 30, v5
    buffer_load_dwordx4 v5, s[24:27], s48 offen lds
    s_add_u32 m0, m0, 1024
    v_add_u32 v2, 384, v0
    v_mul_u32_u24 v3, s53, v2
    v_lshrrev_b32 v3, 16, v3
    v_mul_u32_u24 v4, s52, v3
    v_sub_u32 v2, v2, v4
    v_add_u32 v2, s56, v2
    v_mul_u32_u24 v4, 57, v2
    v_lshrrev_b32 v4, 9, v4
    v_mul_u32_u24 v5, s54, v3
    v_lshl_add_u32 v5, v2, 4, v5
    v_mad_u32_u24 v5, v4, s55, v5
    v_lshrrev_b32 v3, 5, v3
    v_add_u32 v2, 5, v2
    v_lshrrev_b32 v2, 5, v2
    v_or_b32 v3, v3, v2
    v_lshl_or_b32 v5, v3, 30, v5
    buffer_load_dwordx4 v5, s[24:27], s48 offen lds
    s_add_u32 m0, m0, 1024
    v_lshrrev_b32 v2, 4, v0
    v_bfe_u32 v3, v0, 2, 2
    v_lshl_add_u32 v2, v2, 3, v3
    s_lshl_b32 s50, s52, 4
    v_mul_u32_u24 v2, s50, v2
    v_and_b32 v3, 3, v0
    v_lshl_add_u32 v2, v3, 3, v2
    v_add_u32 v2, s57, v2
    s_lshl_b32 s50, s52, 6
    v_add_u32 v3, s50, v2
    s_waitcnt vmcnt(0)
    ds_read_b64_tr_b16 v[8:9], v2 offset:0
    ds_read_b64_tr_b16 v[10:11], v3 offset:0
    ds_read_b64_tr_b16 v[12:13], v2 offset:32
    ds_read_b64_tr_b16 v[14:15], v3 offset:32
    ds_read_b64_tr_b16 v[16:17], v2 offset:64
    ds_read_b64_tr_b16 v[18:19], v3 offset:64
    ds_read_b64_tr_b16 v[20:21], v2 offset:96
    ds_read_b64_tr_b16 v[22:23], v3 offset:96
    ds_read_b64_tr_b16 v[24:25], v2 offset:128
    ds_read_b64_tr_b16 v[26:27], v3 offset:128
    ds_read_b64_tr_b16 v[28:29], v2 offset:160
    ds_read_b64_tr_b16 v[30:31], v3 offset:160
    ds_read_b64_tr_b16 v[32:33], v2 offset:192
    ds_read_b64_tr_b16 v[34:35], v3 offset:192
    s_waitcnt lgkmcnt(12)
    buffer_store_dwordx4 v[8:11], v1, s[20:23], s49 offen offset:0 sc1
    s_waitcnt lgkmcnt(10)
    buffer_store_dwordx4 v[12:15], v1, s[20:23], s49 offen offset:2048 sc1
    s_add_u32 s49, s49, 4096
    s_waitcnt lgkmcnt(8)
    buffer_store_dwordx4 v[16:19], v1, s[20:23], s49 offen offset:0 sc1
    s_waitcnt lgkmcnt(6)
    buffer_store_dwordx4 v[20:23], v1, s[20:23], s49 offen offset:2048 sc1
    s_add_u32 s49, s49, 4096
    s_waitcnt lgkmcnt(4)
    buffer_store_dwordx4 v[24:27], v1, s[20:23], s49 offen offset:0 sc1
    s_waitcnt lgkmcnt(2)
    buffer_store_dwordx4 v[28:31], v1, s[20:23], s49 offen offset:2048 sc1
    s_add_u32 s49, s49, 4096
    s_waitcnt lgkmcnt(0)
    buffer_store_dwordx4 v[32:35], v1, s[20:23], s49 offen offset:0 sc1
parallel_sum__sliding_local_dilated__mixer_gmlp__prompt_kernel_nw19:
    s_cmp_lg_u32 s35, 0
    s_cbranch_scc1 parallel_sum__sliding_local_dilated__mixer_gmlp__prompt_kernel_nc20
    s_getpc_b64 s[28:29]
parallel_sum__sliding_local_dilated__mixer_gmlp__prompt_kernel_pc21:
    s_mov_b32 s30, parallel_sum__sliding_local_dilated__mixer_gmlp__prompt_kernel_end1-parallel_sum__sliding_local_dilated__mixer_gmlp__prompt_kernel_pc21
    s_mov_b32 s31, 0x20000
    s_lshl_b32 s50, s33, 13
    v_lshlrev_b32 v242, 7, v0
    buffer_load_dword v252, v242, s[28:31], s50 offen
parallel_sum__sliding_local_dilated__mixer_gmlp__prompt_kernel_nc20:
parallel_sum__sliding_local_dilated__mixer_gmlp__prompt_kernel_p0d13:
    s_cmp_ge_u32 s33, 4
    s_cbranch_scc1 parallel_sum__sliding_local_dilated__mixer_gmlp__prompt_kernel_D2
    s_add_u32 s16, s4, 0x2300000
    s_addc_u32 s17, s5, 0
    s_mov_b32 s18, 0xb40000
    s_mov_b32 s19, 0x20000
    s_mov_b32 s40, s33
    s_and_b32 s41, s40, 1
    s_lshr_b32 s42, s40, 1
    v_and_b32 v2, 15, v0
    v_lshrrev_b32 v3, 4, v0
    v_lshrrev_b32 v248, 1, v2
    v_xor_b32 v248, v3, v248
    v_lshlrev_b32 v248, 4, v248
    v_lshl_add_u32 v248, v2, 7, v248
    s_lshl_b32 s43, s41, 13
    v_add_u32 v248, s43, v248
    v_xor_b32 v249, 64, v248
    v_mov_b32 v244, 0x3f803f80
    v_mov_b32 v245, 0x3f803f80
    v_mov_b32 v246, 0x3f803f80
    v_mov_b32 v247, 0x3f803f80
    v_lshrrev_b32 v250, 5, v0
    v_lshlrev_b32 v250, 4, v250
    v_bfe_u32 v2, v0, 4, 1
    v_lshl_add_u32 v250, v2, 2, v250
    v_bfe_u32 v3, v0, 2, 2
    v_add_u32 v250, v250, v3
    v_mul_u32_u24 v250, 288, v250
    v_and_b32 v3, 3, v0
    v_lshl_add_u32 v250, v3, 3, v250
    s_mul_i32 s43, s42, 160
    s_add_u32 s43, s43, 16384
    v_add_u32 v250, s43, v250
    s_cmp_eq_u32 s42, 0
    s_cselect_b64 vcc, -1, 0
    s_cselect_b32 s54, -1, 0
    s_mul_i32 s46, s41, 18432
    s_mul_i32 s47, s42, 5120
    s_add_u32 s46, s46, s47
    s_add_u32 s46, s46, 102400
    v_add_u32 v251, s46, v1
    s_mov_b32 s59, 0
    s_mov_b32 s57, 51200
    s_mov_b32 s56, 0xfffe7000
    s_barrier
    ds_read_b128 v[0:3], v248 offset:0
    ds_read_b128 v[4:7], v248 offset:2048
    ds_read_b128 v[8:11], v248 offset:4096
    ds_read_b128 v[12:15], v248 offset:6144
    ds_read_b64_tr_b16 v[16:17], v250 offset:0
    ds_read_b64_tr_b16 v[18:19], v250 offset:2304
    ds_read_b64_tr_b16 v[20:21], v250 offset:32
    ds_read_b64_tr_b16 v[22:23], v250 offset:2336
    ds_read_b64_tr_b16 v[24:25], v250 offset:64
    ds_read_b64_tr_b16 v[26:27], v250 offset:2368
    ds_read_b64_tr_b16 v[28:29], v250 offset:96
    ds_read_b64_tr_b16 v[30:31], v250 offset:2400
    ds_read_b64_tr_b16 v[32:33], v250 offset:128
    ds_read_b64_tr_b16 v[34:35], v250 offset:2432
    ds_read_b128 v[36:39], v249 offset:0
    ds_read_b128 v[40:43], v249 offset:2048
    ds_read_b128 v[44:47], v249 offset:4096
    ds_read_b128 v[48:51], v249 offset:6144
    ds_read_b64_tr_b16 v[52:53], v250 offset:9216
    ds_read_b64_tr_b16 v[54:55], v250 offset:11520
    ds_read_b64_tr_b16 v[56:57], v250 offset:9248
    ds_read_b64_tr_b16 v[58:59], v250 offset:11552
    ds_read_b64_tr_b16 v[60:61], v250 offset:9280
    ds_read_b64_tr_b16 v[62:63], v250 offset:11584
    ds_read_b64_tr_b16 v[64:65], v250 offset:9312
    ds_read_b64_tr_b16 v[66:67], v250 offset:11616
    ds_read_b64_tr_b16 v[68:69], v250 offset:9344
    ds_read_b64_tr_b16 v[70:71], v250 offset:11648
    s_add_u32 s59, s59, 1
    s_cmp_eq_u32 s59, 3
    s_cselect_b32 s59, 0, s59
    s_cselect_b32 s55, s56, s57
    v_add_u32 v248, s55, v248
    v_add_u32 v249, s55, v249
    v_add_u32 v250, s55, v250
    s_waitcnt lgkmcnt(0)
    s_barrier
    v_mfma_f32_16x16x32_bf16 v[144:147], v[0:3], v[16:19], 0
    ds_read_b128 v[72:75], v248 offset:0
    v_mfma_f32_16x16x32_bf16 v[164:167], v[4:7], v[16:19], 0
    ds_read_b128 v[76:79], v248 offset:2048
    v_mfma_f32_16x16x32_bf16 v[184:187], v[8:11], v[16:19], 0
    ds_read_b128 v[80:83], v248 offset:4096
    v_mfma_f32_16x16x32_bf16 v[204:207], v[12:15], v[16:19], 0
    ds_read_b128 v[84:87], v248 offset:6144
    v_mfma_f32_16x16x32_bf16 v[224:227], v[244:247], v[16:19], 0
    ds_read_b64_tr_b16 v[88:89], v250 offset:0
    v_mfma_f32_16x16x32_bf16 v[228:231], v[244:247], v[20:23], 0
    ds_read_b64_tr_b16 v[90:91], v250 offset:2304
    v_mfma_f32_16x16x32_bf16 v[208:211], v[12:15], v[20:23], 0
    ds_read_b64_tr_b16 v[92:93], v250 offset:32
    v_mfma_f32_16x16x32_bf16 v[188:191], v[8:11], v[20:23], 0
    ds_read_b64_tr_b16 v[94:95], v250 offset:2336
    v_mfma_f32_16x16x32_bf16 v[168:171], v[4:7], v[20:23], 0
    ds_read_b64_tr_b16 v[96:97], v250 offset:64
    v_mfma_f32_16x16x32_bf16 v[148:151], v[0:3], v[20:23], 0
    ds_read_b64_tr_b16 v[98:99], v250 offset:2368
    v_mfma_f32_16x16x32_bf16 v[152:155], v[0:3], v[24:27], 0
    ds_read_b64_tr_b16 v[100:101], v250 offset:96
    v_mfma_f32_16x16x32_bf16 v[172:175], v[4:7], v[24:27], 0
    ds_read_b64_tr_b16 v[102:103], v250 offset:2400
    v_mfma_f32_16x16x32_bf16 v[192:195], v[8:11], v[24:27], 0
    ds_read_b64_tr_b16 v[104:105], v250 offset:128
    v_mfma_f32_16x16x32_bf16 v[212:215], v[12:15], v[24:27], 0
    ds_read_b64_tr_b16 v[106:107], v250 offset:2432
    v_mfma_f32_16x16x32_bf16 v[232:235], v[244:247], v[24:27], 0
    ds_read_b128 v[108:111], v249 offset:0
    v_mfma_f32_16x16x32_bf16 v[236:239], v[244:247], v[28:31], 0
    ds_read_b128 v[112:115], v249 offset:2048
    v_mfma_f32_16x16x32_bf16 v[216:219], v[12:15], v[28:31], 0
    v_mfma_f32_16x16x32_bf16 v[196:199], v[8:11], v[28:31], 0
    v_mfma_f32_16x16x32_bf16 v[176:179], v[4:7], v[28:31], 0
    v_mfma_f32_16x16x32_bf16 v[156:159], v[0:3], v[28:31], 0
    s_cbranch_vccz parallel_sum__sliding_local_dilated__mixer_gmlp__prompt_kernel_sk22
    v_mfma_f32_16x16x32_bf16 v[160:163], v[0:3], v[32:35], 0
    v_mfma_f32_16x16x32_bf16 v[180:183], v[4:7], v[32:35], 0
    v_mfma_f32_16x16x32_bf16 v[200:203], v[8:11], v[32:35], 0
    v_mfma_f32_16x16x32_bf16 v[220:223], v[12:15], v[32:35], 0
    v_mfma_f32_16x16x32_bf16 v[240:243], v[244:247], v[32:35], 0
parallel_sum__sliding_local_dilated__mixer_gmlp__prompt_kernel_sk22:
    v_mfma_f32_16x16x32_bf16 v[144:147], v[36:39], v[52:55], v[144:147]
    ds_read_b128 v[116:119], v249 offset:4096
    v_mfma_f32_16x16x32_bf16 v[164:167], v[40:43], v[52:55], v[164:167]
    ds_read_b128 v[120:123], v249 offset:6144
    v_mfma_f32_16x16x32_bf16 v[184:187], v[44:47], v[52:55], v[184:187]
    ds_read_b64_tr_b16 v[124:125], v250 offset:9216
    v_mfma_f32_16x16x32_bf16 v[204:207], v[48:51], v[52:55], v[204:207]
    ds_read_b64_tr_b16 v[126:127], v250 offset:11520
    v_mfma_f32_16x16x32_bf16 v[224:227], v[244:247], v[52:55], v[224:227]
    ds_read_b64_tr_b16 v[128:129], v250 offset:9248
    v_mfma_f32_16x16x32_bf16 v[228:231], v[244:247], v[56:59], v[228:231]
    ds_read_b64_tr_b16 v[130:131], v250 offset:11552
    v_mfma_f32_16x16x32_bf16 v[208:211], v[48:51], v[56:59], v[208:211]
    ds_read_b64_tr_b16 v[132:133], v250 offset:9280
    v_mfma_f32_16x16x32_bf16 v[188:191], v[44:47], v[56:59], v[188:191]
    ds_read_b64_tr_b16 v[134:135], v250 offset:11584
    v_mfma_f32_16x16x32_bf16 v[168:171], v[40:43], v[56:59], v[168:171]
    ds_read_b64_tr_b16 v[136:137], v250 offset:9312
    v_mfma_f32_16x16x32_bf16 v[148:151], v[36:39], v[56:59], v[148:151]
    ds_read_b64_tr_b16 v[138:139], v250 offset:11616
    v_mfma_f32_16x16x32_bf16 v[152:155], v[36:39], v[60:63], v[152:155]
    ds_read_b64_tr_b16 v[140:141], v250 offset:9344
    v_mfma_f32_16x16x32_bf16 v[172:175], v[40:43], v[60:63], v[172:175]
    ds_read_b64_tr_b16 v[142:143], v250 offset:11648
    v_mfma_f32_16x16x32_bf16 v[192:195], v[44:47], v[60:63], v[192:195]
    s_add_u32 s59, s59, 1
    v_mfma_f32_16x16x32_bf16 v[212:215], v[48:51], v[60:63], v[212:215]
    s_cmp_eq_u32 s59, 3
    v_mfma_f32_16x16x32_bf16 v[232:235], v[244:247], v[60:63], v[232:235]
    s_cselect_b32 s59, 0, s59
    v_mfma_f32_16x16x32_bf16 v[236:239], v[244:247], v[64:67], v[236:239]
    s_cselect_b32 s55, s56, s57
    v_mfma_f32_16x16x32_bf16 v[216:219], v[48:51], v[64:67], v[216:219]
    v_add_u32 v248, s55, v248
    v_mfma_f32_16x16x32_bf16 v[196:199], v[44:47], v[64:67], v[196:199]
    v_add_u32 v249, s55, v249
    v_mfma_f32_16x16x32_bf16 v[176:179], v[40:43], v[64:67], v[176:179]
    v_add_u32 v250, s55, v250
    v_mfma_f32_16x16x32_bf16 v[156:159], v[36:39], v[64:67], v[156:159]
    s_cbranch_vccz parallel_sum__sliding_local_dilated__mixer_gmlp__prompt_kernel_sk23
    v_mfma_f32_16x16x32_bf16 v[160:163], v[36:39], v[68:71], v[160:163]
    v_mfma_f32_16x16x32_bf16 v[180:183], v[40:43], v[68:71], v[180:183]
    v_mfma_f32_16x16x32_bf16 v[200:203], v[44:47], v[68:71], v[200:203]
    v_mfma_f32_16x16x32_bf16 v[220:223], v[48:51], v[68:71], v[220:223]
    v_mfma_f32_16x16x32_bf16 v[240:243], v[244:247], v[68:71], v[240:243]
parallel_sum__sliding_local_dilated__mixer_gmlp__prompt_kernel_sk23:
    s_mov_b32 s58, 4
    s_waitcnt vmcnt(0) lgkmcnt(0)
parallel_sum__sliding_local_dilated__mixer_gmlp__prompt_kernel_top24:
    s_barrier
    v_mfma_f32_16x16x32_bf16 v[144:147], v[72:75], v[88:91], v[144:147]
    ds_read_b128 v[0:3], v248 offset:0
    v_mfma_f32_16x16x32_bf16 v[164:167], v[76:79], v[88:91], v[164:167]
    ds_read_b128 v[4:7], v248 offset:2048
    v_mfma_f32_16x16x32_bf16 v[184:187], v[80:83], v[88:91], v[184:187]
    ds_read_b128 v[8:11], v248 offset:4096
    v_mfma_f32_16x16x32_bf16 v[204:207], v[84:87], v[88:91], v[204:207]
    ds_read_b128 v[12:15], v248 offset:6144
    v_mfma_f32_16x16x32_bf16 v[224:227], v[244:247], v[88:91], v[224:227]
    ds_read_b64_tr_b16 v[16:17], v250 offset:0
    v_mfma_f32_16x16x32_bf16 v[228:231], v[244:247], v[92:95], v[228:231]
    ds_read_b64_tr_b16 v[18:19], v250 offset:2304
    v_mfma_f32_16x16x32_bf16 v[208:211], v[84:87], v[92:95], v[208:211]
    ds_read_b64_tr_b16 v[20:21], v250 offset:32
    v_mfma_f32_16x16x32_bf16 v[188:191], v[80:83], v[92:95], v[188:191]
    ds_read_b64_tr_b16 v[22:23], v250 offset:2336
    v_mfma_f32_16x16x32_bf16 v[168:171], v[76:79], v[92:95], v[168:171]
    ds_read_b64_tr_b16 v[24:25], v250 offset:64
    v_mfma_f32_16x16x32_bf16 v[148:151], v[72:75], v[92:95], v[148:151]
    ds_read_b64_tr_b16 v[26:27], v250 offset:2368
    v_mfma_f32_16x16x32_bf16 v[152:155], v[72:75], v[96:99], v[152:155]
    ds_read_b64_tr_b16 v[28:29], v250 offset:96
    v_mfma_f32_16x16x32_bf16 v[172:175], v[76:79], v[96:99], v[172:175]
    ds_read_b64_tr_b16 v[30:31], v250 offset:2400
    v_mfma_f32_16x16x32_bf16 v[192:195], v[80:83], v[96:99], v[192:195]
    ds_read_b64_tr_b16 v[32:33], v250 offset:128
    v_mfma_f32_16x16x32_bf16 v[212:215], v[84:87], v[96:99], v[212:215]
    ds_read_b64_tr_b16 v[34:35], v250 offset:2432
    v_mfma_f32_16x16x32_bf16 v[232:235], v[244:247], v[96:99], v[232:235]
    ds_read_b128 v[36:39], v249 offset:0
    v_mfma_f32_16x16x32_bf16 v[236:239], v[244:247], v[100:103], v[236:239]
    ds_read_b128 v[40:43], v249 offset:2048
    v_mfma_f32_16x16x32_bf16 v[216:219], v[84:87], v[100:103], v[216:219]
    v_mfma_f32_16x16x32_bf16 v[196:199], v[80:83], v[100:103], v[196:199]
    v_mfma_f32_16x16x32_bf16 v[176:179], v[76:79], v[100:103], v[176:179]
    v_mfma_f32_16x16x32_bf16 v[156:159], v[72:75], v[100:103], v[156:159]
    s_cbranch_vccz parallel_sum__sliding_local_dilated__mixer_gmlp__prompt_kernel_sk26
    v_mfma_f32_16x16x32_bf16 v[160:163], v[72:75], v[104:107], v[160:163]
    v_mfma_f32_16x16x32_bf16 v[180:183], v[76:79], v[104:107], v[180:183]
    v_mfma_f32_16x16x32_bf16 v[200:203], v[80:83], v[104:107], v[200:203]
    v_mfma_f32_16x16x32_bf16 v[220:223], v[84:87], v[104:107], v[220:223]
    v_mfma_f32_16x16x32_bf16 v[240:243], v[244:247], v[104:107], v[240:243]
parallel_sum__sliding_local_dilated__mixer_gmlp__prompt_kernel_sk26:
    v_mfma_f32_16x16x32_bf16 v[144:147], v[108:111], v[124:127], v[144:147]
    ds_read_b128 v[44:47], v249 offset:4096
    v_mfma_f32_16x16x32_bf16 v[164:167], v[112:115], v[124:127], v[164:167]
    ds_read_b128 v[48:51], v249 offset:6144
    v_mfma_f32_16x16x32_bf16 v[184:187], v[116:119], v[124:127], v[184:187]
    ds_read_b64_tr_b16 v[52:53], v250 offset:9216
    v_mfma_f32_16x16x32_bf16 v[204:207], v[120:123], v[124:127], v[204:207]
    ds_read_b64_tr_b16 v[54:55], v250 offset:11520
    v_mfma_f32_16x16x32_bf16 v[224:227], v[244:247], v[124:127], v[224:227]
    ds_read_b64_tr_b16 v[56:57], v250 offset:9248
    v_mfma_f32_16x16x32_bf16 v[228:231], v[244:247], v[128:131], v[228:231]
    ds_read_b64_tr_b16 v[58:59], v250 offset:11552
    v_mfma_f32_16x16x32_bf16 v[208:211], v[120:123], v[128:131], v[208:211]
    ds_read_b64_tr_b16 v[60:61], v250 offset:9280
    v_mfma_f32_16x16x32_bf16 v[188:191], v[116:119], v[128:131], v[188:191]
    ds_read_b64_tr_b16 v[62:63], v250 offset:11584
    v_mfma_f32_16x16x32_bf16 v[168:171], v[112:115], v[128:131], v[168:171]
    ds_read_b64_tr_b16 v[64:65], v250 offset:9312
    v_mfma_f32_16x16x32_bf16 v[148:151], v[108:111], v[128:131], v[148:151]
    ds_read_b64_tr_b16 v[66:67], v250 offset:11616
    v_mfma_f32_16x16x32_bf16 v[152:155], v[108:111], v[132:135], v[152:155]
    ds_read_b64_tr_b16 v[68:69], v250 offset:9344
    v_mfma_f32_16x16x32_bf16 v[172:175], v[112:115], v[132:135], v[172:175]
    ds_read_b64_tr_b16 v[70:71], v250 offset:11648
    v_mfma_f32_16x16x32_bf16 v[192:195], v[116:119], v[132:135], v[192:195]
    s_add_u32 s59, s59, 1
    v_mfma_f32_16x16x32_bf16 v[212:215], v[120:123], v[132:135], v[212:215]
    s_cmp_eq_u32 s59, 3
    v_mfma_f32_16x16x32_bf16 v[232:235], v[244:247], v[132:135], v[232:235]
    s_cselect_b32 s59, 0, s59
    v_mfma_f32_16x16x32_bf16 v[236:239], v[244:247], v[136:139], v[236:239]
    s_cselect_b32 s55, s56, s57
    v_mfma_f32_16x16x32_bf16 v[216:219], v[120:123], v[136:139], v[216:219]
    v_add_u32 v248, s55, v248
    v_mfma_f32_16x16x32_bf16 v[196:199], v[116:119], v[136:139], v[196:199]
    v_add_u32 v249, s55, v249
    v_mfma_f32_16x16x32_bf16 v[176:179], v[112:115], v[136:139], v[176:179]
    v_add_u32 v250, s55, v250
    v_mfma_f32_16x16x32_bf16 v[156:159], v[108:111], v[136:139], v[156:159]
    s_sub_u32 s58, s58, 1
    s_cmp_lg_u32 s58, 0
    s_cbranch_vccz parallel_sum__sliding_local_dilated__mixer_gmlp__prompt_kernel_sk27
    v_mfma_f32_16x16x32_bf16 v[160:163], v[108:111], v[140:143], v[160:163]
    v_mfma_f32_16x16x32_bf16 v[180:183], v[112:115], v[140:143], v[180:183]
    v_mfma_f32_16x16x32_bf16 v[200:203], v[116:119], v[140:143], v[200:203]
    v_mfma_f32_16x16x32_bf16 v[220:223], v[120:123], v[140:143], v[220:223]
    v_mfma_f32_16x16x32_bf16 v[240:243], v[244:247], v[140:143], v[240:243]
parallel_sum__sliding_local_dilated__mixer_gmlp__prompt_kernel_sk27:
    s_waitcnt lgkmcnt(0)
    s_cbranch_scc0 parallel_sum__sliding_local_dilated__mixer_gmlp__prompt_kernel_ex25
    s_barrier
    v_mfma_f32_16x16x32_bf16 v[144:147], v[0:3], v[16:19], v[144:147]
    ds_read_b128 v[72:75], v248 offset:0
    v_mfma_f32_16x16x32_bf16 v[164:167], v[4:7], v[16:19], v[164:167]
    ds_read_b128 v[76:79], v248 offset:2048
    v_mfma_f32_16x16x32_bf16 v[184:187], v[8:11], v[16:19], v[184:187]
    ds_read_b128 v[80:83], v248 offset:4096
    v_mfma_f32_16x16x32_bf16 v[204:207], v[12:15], v[16:19], v[204:207]
    ds_read_b128 v[84:87], v248 offset:6144
    v_mfma_f32_16x16x32_bf16 v[224:227], v[244:247], v[16:19], v[224:227]
    ds_read_b64_tr_b16 v[88:89], v250 offset:0
    v_mfma_f32_16x16x32_bf16 v[228:231], v[244:247], v[20:23], v[228:231]
    ds_read_b64_tr_b16 v[90:91], v250 offset:2304
    v_mfma_f32_16x16x32_bf16 v[208:211], v[12:15], v[20:23], v[208:211]
    ds_read_b64_tr_b16 v[92:93], v250 offset:32
    v_mfma_f32_16x16x32_bf16 v[188:191], v[8:11], v[20:23], v[188:191]
    ds_read_b64_tr_b16 v[94:95], v250 offset:2336
    v_mfma_f32_16x16x32_bf16 v[168:171], v[4:7], v[20:23], v[168:171]
    ds_read_b64_tr_b16 v[96:97], v250 offset:64
    v_mfma_f32_16x16x32_bf16 v[148:151], v[0:3], v[20:23], v[148:151]
    ds_read_b64_tr_b16 v[98:99], v250 offset:2368
    v_mfma_f32_16x16x32_bf16 v[152:155], v[0:3], v[24:27], v[152:155]
    ds_read_b64_tr_b16 v[100:101], v250 offset:96
    v_mfma_f32_16x16x32_bf16 v[172:175], v[4:7], v[24:27], v[172:175]
    ds_read_b64_tr_b16 v[102:103], v250 offset:2400
    v_mfma_f32_16x16x32_bf16 v[192:195], v[8:11], v[24:27], v[192:195]
    ds_read_b64_tr_b16 v[104:105], v250 offset:128
    v_mfma_f32_16x16x32_bf16 v[212:215], v[12:15], v[24:27], v[212:215]
    ds_read_b64_tr_b16 v[106:107], v250 offset:2432
    v_mfma_f32_16x16x32_bf16 v[232:235], v[244:247], v[24:27], v[232:235]
    ds_read_b128 v[108:111], v249 offset:0
    v_mfma_f32_16x16x32_bf16 v[236:239], v[244:247], v[28:31], v[236:239]
    ds_read_b128 v[112:115], v249 offset:2048
    v_mfma_f32_16x16x32_bf16 v[216:219], v[12:15], v[28:31], v[216:219]
    v_mfma_f32_16x16x32_bf16 v[196:199], v[8:11], v[28:31], v[196:199]
    v_mfma_f32_16x16x32_bf16 v[176:179], v[4:7], v[28:31], v[176:179]
    v_mfma_f32_16x16x32_bf16 v[156:159], v[0:3], v[28:31], v[156:159]
    s_cbranch_vccz parallel_sum__sliding_local_dilated__mixer_gmlp__prompt_kernel_sk28
    v_mfma_f32_16x16x32_bf16 v[160:163], v[0:3], v[32:35], v[160:163]
    v_mfma_f32_16x16x32_bf16 v[180:183], v[4:7], v[32:35], v[180:183]
    v_mfma_f32_16x16x32_bf16 v[200:203], v[8:11], v[32:35], v[200:203]
    v_mfma_f32_16x16x32_bf16 v[220:223], v[12:15], v[32:35], v[220:223]
    v_mfma_f32_16x16x32_bf16 v[240:243], v[244:247], v[32:35], v[240:243]
parallel_sum__sliding_local_dilated__mixer_gmlp__prompt_kernel_sk28:
    v_mfma_f32_16x16x32_bf16 v[144:147], v[36:39], v[52:55], v[144:147]
    ds_read_b128 v[116:119], v249 offset:4096
    v_mfma_f32_16x16x32_bf16 v[164:167], v[40:43], v[52:55], v[164:167]
    ds_read_b128 v[120:123], v249 offset:6144
    v_mfma_f32_16x16x32_bf16 v[184:187], v[44:47], v[52:55], v[184:187]
    ds_read_b64_tr_b16 v[124:125], v250 offset:9216
    v_mfma_f32_16x16x32_bf16 v[204:207], v[48:51], v[52:55], v[204:207]
    ds_read_b64_tr_b16 v[126:127], v250 offset:11520
    v_mfma_f32_16x16x32_bf16 v[224:227], v[244:247], v[52:55], v[224:227]
    ds_read_b64_tr_b16 v[128:129], v250 offset:9248
    v_mfma_f32_16x16x32_bf16 v[228:231], v[244:247], v[56:59], v[228:231]
    ds_read_b64_tr_b16 v[130:131], v250 offset:11552
    v_mfma_f32_16x16x32_bf16 v[208:211], v[48:51], v[56:59], v[208:211]
    ds_read_b64_tr_b16 v[132:133], v250 offset:9280
    v_mfma_f32_16x16x32_bf16 v[188:191], v[44:47], v[56:59], v[188:191]
    ds_read_b64_tr_b16 v[134:135], v250 offset:11584
    v_mfma_f32_16x16x32_bf16 v[168:171], v[40:43], v[56:59], v[168:171]
    ds_read_b64_tr_b16 v[136:137], v250 offset:9312
    v_mfma_f32_16x16x32_bf16 v[148:151], v[36:39], v[56:59], v[148:151]
    ds_read_b64_tr_b16 v[138:139], v250 offset:11616
    v_mfma_f32_16x16x32_bf16 v[152:155], v[36:39], v[60:63], v[152:155]
    ds_read_b64_tr_b16 v[140:141], v250 offset:9344
    v_mfma_f32_16x16x32_bf16 v[172:175], v[40:43], v[60:63], v[172:175]
    ds_read_b64_tr_b16 v[142:143], v250 offset:11648
    v_mfma_f32_16x16x32_bf16 v[192:195], v[44:47], v[60:63], v[192:195]
    s_add_u32 s59, s59, 1
    v_mfma_f32_16x16x32_bf16 v[212:215], v[48:51], v[60:63], v[212:215]
    s_cmp_eq_u32 s59, 3
    v_mfma_f32_16x16x32_bf16 v[232:235], v[244:247], v[60:63], v[232:235]
    s_cselect_b32 s59, 0, s59
    v_mfma_f32_16x16x32_bf16 v[236:239], v[244:247], v[64:67], v[236:239]
    s_cselect_b32 s55, s56, s57
    v_mfma_f32_16x16x32_bf16 v[216:219], v[48:51], v[64:67], v[216:219]
    v_add_u32 v248, s55, v248
    v_mfma_f32_16x16x32_bf16 v[196:199], v[44:47], v[64:67], v[196:199]
    v_add_u32 v249, s55, v249
    v_mfma_f32_16x16x32_bf16 v[176:179], v[40:43], v[64:67], v[176:179]
    v_add_u32 v250, s55, v250
    v_mfma_f32_16x16x32_bf16 v[156:159], v[36:39], v[64:67], v[156:159]
    s_cbranch_vccz parallel_sum__sliding_local_dilated__mixer_gmlp__prompt_kernel_sk29
    v_mfma_f32_16x16x32_bf16 v[160:163], v[36:39], v[68:71], v[160:163]
    v_mfma_f32_16x16x32_bf16 v[180:183], v[40:43], v[68:71], v[180:183]
    v_mfma_f32_16x16x32_bf16 v[200:203], v[44:47], v[68:71], v[200:203]
    v_mfma_f32_16x16x32_bf16 v[220:223], v[48:51], v[68:71], v[220:223]
    v_mfma_f32_16x16x32_bf16 v[240:243], v[244:247], v[68:71], v[240:243]
parallel_sum__sliding_local_dilated__mixer_gmlp__prompt_kernel_sk29:
    s_waitcnt lgkmcnt(0)
    s_branch parallel_sum__sliding_local_dilated__mixer_gmlp__prompt_kernel_top24
parallel_sum__sliding_local_dilated__mixer_gmlp__prompt_kernel_ex25:
    s_barrier
    v_mbcnt_lo_u32_b32 v250, -1, 0
    v_mbcnt_hi_u32_b32 v250, -1, v250
    v_and_b32 v248, 48, v250
    s_lshl_b32 s43, s41, 9
    s_add_u32 s43, s43, 143360
    v_add_u32 v248, s43, v248
    v_mfma_f32_16x16x32_bf16 v[144:147], v[0:3], v[16:19], v[144:147]
    ds_read_b128 v[112:115], v248 offset:0
    v_mfma_f32_16x16x32_bf16 v[164:167], v[4:7], v[16:19], v[164:167]
    ds_read_b128 v[116:119], v248 offset:128
    v_mfma_f32_16x16x32_bf16 v[184:187], v[8:11], v[16:19], v[184:187]
    ds_read_b128 v[120:123], v248 offset:256
    v_mfma_f32_16x16x32_bf16 v[204:207], v[12:15], v[16:19], v[204:207]
    ds_read_b128 v[124:127], v248 offset:384
    v_mfma_f32_16x16x32_bf16 v[224:227], v[244:247], v[16:19], v[224:227]
    ds_read_b128 v[128:131], v248 offset:64
    v_mfma_f32_16x16x32_bf16 v[228:231], v[244:247], v[20:23], v[228:231]
    ds_read_b128 v[132:135], v248 offset:192
    v_mfma_f32_16x16x32_bf16 v[208:211], v[12:15], v[20:23], v[208:211]
    ds_read_b128 v[136:139], v248 offset:320
    v_mfma_f32_16x16x32_bf16 v[188:191], v[8:11], v[20:23], v[188:191]
    ds_read_b128 v[140:143], v248 offset:448
    v_mfma_f32_16x16x32_bf16 v[168:171], v[4:7], v[20:23], v[168:171]
    v_mov_b32 v80, 0
    v_mfma_f32_16x16x32_bf16 v[148:151], v[0:3], v[20:23], v[148:151]
    v_mov_b32 v81, 0
    v_mfma_f32_16x16x32_bf16 v[152:155], v[0:3], v[24:27], v[152:155]
    v_mov_b32 v82, 0
    v_mfma_f32_16x16x32_bf16 v[172:175], v[4:7], v[24:27], v[172:175]
    v_mov_b32 v83, 0
    v_mfma_f32_16x16x32_bf16 v[192:195], v[8:11], v[24:27], v[192:195]
    v_mov_b32 v84, 0
    v_mfma_f32_16x16x32_bf16 v[212:215], v[12:15], v[24:27], v[212:215]
    v_mov_b32 v85, 0
    v_mfma_f32_16x16x32_bf16 v[232:235], v[244:247], v[24:27], v[232:235]
    v_mov_b32 v86, 0
    v_mfma_f32_16x16x32_bf16 v[236:239], v[244:247], v[28:31], v[236:239]
    v_mov_b32 v87, 0
    v_mfma_f32_16x16x32_bf16 v[216:219], v[12:15], v[28:31], v[216:219]
    v_mov_b32 v88, 0
    v_mfma_f32_16x16x32_bf16 v[196:199], v[8:11], v[28:31], v[196:199]
    v_mov_b32 v89, 0
    v_mfma_f32_16x16x32_bf16 v[176:179], v[4:7], v[28:31], v[176:179]
    v_mov_b32 v90, 0
    v_mfma_f32_16x16x32_bf16 v[156:159], v[0:3], v[28:31], v[156:159]
    v_mov_b32 v91, 0
    s_cbranch_vccz parallel_sum__sliding_local_dilated__mixer_gmlp__prompt_kernel_sk30
    v_mfma_f32_16x16x32_bf16 v[160:163], v[0:3], v[32:35], v[160:163]
    v_mfma_f32_16x16x32_bf16 v[180:183], v[4:7], v[32:35], v[180:183]
    v_mfma_f32_16x16x32_bf16 v[200:203], v[8:11], v[32:35], v[200:203]
    v_mfma_f32_16x16x32_bf16 v[220:223], v[12:15], v[32:35], v[220:223]
    v_mfma_f32_16x16x32_bf16 v[240:243], v[244:247], v[32:35], v[240:243]
parallel_sum__sliding_local_dilated__mixer_gmlp__prompt_kernel_sk30:
    v_mfma_f32_16x16x32_bf16 v[144:147], v[36:39], v[52:55], v[144:147]
    v_mov_b32 v92, 0
    v_mfma_f32_16x16x32_bf16 v[164:167], v[40:43], v[52:55], v[164:167]
    v_mov_b32 v93, 0
    v_mfma_f32_16x16x32_bf16 v[184:187], v[44:47], v[52:55], v[184:187]
    v_mov_b32 v94, 0
    v_mfma_f32_16x16x32_bf16 v[204:207], v[48:51], v[52:55], v[204:207]
    v_mov_b32 v95, 0
    v_mfma_f32_16x16x32_bf16 v[224:227], v[244:247], v[52:55], v[224:227]
    v_mov_b32 v96, 0
    v_mfma_f32_16x16x32_bf16 v[228:231], v[244:247], v[56:59], v[228:231]
    v_mov_b32 v97, 0
    v_mfma_f32_16x16x32_bf16 v[208:211], v[48:51], v[56:59], v[208:211]
    v_mov_b32 v98, 0
    v_mfma_f32_16x16x32_bf16 v[188:191], v[44:47], v[56:59], v[188:191]
    v_mov_b32 v99, 0
    v_mfma_f32_16x16x32_bf16 v[168:171], v[40:43], v[56:59], v[168:171]
    v_mov_b32 v100, 0
    v_mfma_f32_16x16x32_bf16 v[148:151], v[36:39], v[56:59], v[148:151]
    v_mov_b32 v101, 0
    v_mfma_f32_16x16x32_bf16 v[152:155], v[36:39], v[60:63], v[152:155]
    v_mov_b32 v102, 0
    v_mfma_f32_16x16x32_bf16 v[172:175], v[40:43], v[60:63], v[172:175]
    v_mov_b32 v103, 0
    v_mfma_f32_16x16x32_bf16 v[192:195], v[44:47], v[60:63], v[192:195]
    v_mov_b32 v104, 0
    v_mfma_f32_16x16x32_bf16 v[212:215], v[48:51], v[60:63], v[212:215]
    v_mov_b32 v105, 0
    v_mfma_f32_16x16x32_bf16 v[232:235], v[244:247], v[60:63], v[232:235]
    v_mov_b32 v106, 0
    v_mfma_f32_16x16x32_bf16 v[236:239], v[244:247], v[64:67], v[236:239]
    v_mov_b32 v107, 0
    v_mfma_f32_16x16x32_bf16 v[216:219], v[48:51], v[64:67], v[216:219]
    v_mov_b32 v108, 0
    v_mfma_f32_16x16x32_bf16 v[196:199], v[44:47], v[64:67], v[196:199]
    v_mov_b32 v109, 0
    v_mfma_f32_16x16x32_bf16 v[176:179], v[40:43], v[64:67], v[176:179]
    v_mov_b32 v110, 0
    v_mfma_f32_16x16x32_bf16 v[156:159], v[36:39], v[64:67], v[156:159]
    v_mov_b32 v111, 0
    s_cbranch_vccz parallel_sum__sliding_local_dilated__mixer_gmlp__prompt_kernel_sk31
    v_mfma_f32_16x16x32_bf16 v[160:163], v[36:39], v[68:71], v[160:163]
    v_mfma_f32_16x16x32_bf16 v[180:183], v[40:43], v[68:71], v[180:183]
    v_mfma_f32_16x16x32_bf16 v[200:203], v[44:47], v[68:71], v[200:203]
    v_mfma_f32_16x16x32_bf16 v[220:223], v[48:51], v[68:71], v[220:223]
    v_mfma_f32_16x16x32_bf16 v[240:243], v[244:247], v[68:71], v[240:243]
parallel_sum__sliding_local_dilated__mixer_gmlp__prompt_kernel_sk31:
    v_mov_b32 v0, 0xc0135761
    v_mov_b32 v1, 0xc0135761
    v_mov_b32 v2, 0xbdd2d3e8
    v_mov_b32 v3, 0xbdd2d3e8
    v_mov_b32 v4, 1.0
    v_mov_b32 v5, 1.0
    v_mov_b32 v6, 163072
    ds_read_b32 v6, v6
    s_waitcnt lgkmcnt(0)
    v_readfirstlane_b32 s101, v6
    v_pk_fma_f32 v[144:145], v[112:113], v[224:225], v[144:145]
    v_pk_fma_f32 v[146:147], v[114:115], v[224:225], v[146:147]
    v_pk_fma_f32 v[164:165], v[116:117], v[224:225], v[164:165]
    v_pk_fma_f32 v[166:167], v[118:119], v[224:225], v[166:167]
    v_pk_mul_f32 v[144:145], v[144:145], v[128:129]
    v_pk_mul_f32 v[146:147], v[146:147], v[130:131]
    v_pk_mul_f32 v[164:165], v[164:165], v[132:133]
    v_pk_mul_f32 v[166:167], v[166:167], v[134:135]
    v_pk_mul_f32 v[8:9], v[144:145], v[144:145]
    v_pk_mul_f32 v[10:11], v[146:147], v[146:147]
    v_pk_mul_f32 v[12:13], v[164:165], v[164:165]
    v_pk_mul_f32 v[14:15], v[166:167], v[166:167]
    v_pk_fma_f32 v[8:9], v[8:9], v[2:3], v[0:1]
    v_pk_fma_f32 v[10:11], v[10:11], v[2:3], v[0:1]
    v_pk_fma_f32 v[12:13], v[12:13], v[2:3], v[0:1]
    v_pk_fma_f32 v[14:15], v[14:15], v[2:3], v[0:1]
    v_pk_mul_f32 v[8:9], v[8:9], v[144:145]
    v_pk_mul_f32 v[10:11], v[10:11], v[146:147]
    v_pk_mul_f32 v[12:13], v[12:13], v[164:165]
    v_pk_mul_f32 v[14:15], v[14:15], v[166:167]
    v_exp_f32 v8, v8
    v_exp_f32 v9, v9
    v_exp_f32 v10, v10
    v_exp_f32 v11, v11
    v_exp_f32 v12, v12
    v_exp_f32 v13, v13
    v_exp_f32 v14, v14
    v_exp_f32 v15, v15
    v_pk_add_f32 v[8:9], v[8:9], v[4:5]
    v_pk_add_f32 v[10:11], v[10:11], v[4:5]
    v_pk_add_f32 v[12:13], v[12:13], v[4:5]
    v_pk_add_f32 v[14:15], v[14:15], v[4:5]
    v_rcp_f32 v8, v8
    v_rcp_f32 v9, v9
    v_rcp_f32 v10, v10
    v_rcp_f32 v11, v11
    v_rcp_f32 v12, v12
    v_rcp_f32 v13, v13
    v_rcp_f32 v14, v14
    v_rcp_f32 v15, v15
    v_pk_mul_f32 v[144:145], v[144:145], v[8:9]
    v_pk_mul_f32 v[146:147], v[146:147], v[10:11]
    v_pk_mul_f32 v[164:165], v[164:165], v[12:13]
    v_pk_mul_f32 v[166:167], v[166:167], v[14:15]
    v_cvt_pk_bf16_f32 v72, v144, v145
    v_cvt_pk_bf16_f32 v73, v146, v147
    v_cvt_pk_bf16_f32 v74, v164, v165
    v_cvt_pk_bf16_f32 v75, v166, v167
    ds_write_b128 v251, v[72:75] offset:0
    v_pk_add_f32 v[80:81], v[80:81], v[144:145]
    v_pk_fma_f32 v[96:97], v[144:145], v[144:145], v[96:97]
    v_pk_add_f32 v[82:83], v[82:83], v[146:147]
    v_pk_fma_f32 v[98:99], v[146:147], v[146:147], v[98:99]
    v_pk_add_f32 v[84:85], v[84:85], v[164:165]
    v_pk_fma_f32 v[100:101], v[164:165], v[164:165], v[100:101]
    v_pk_add_f32 v[86:87], v[86:87], v[166:167]
    v_pk_fma_f32 v[102:103], v[166:167], v[166:167], v[102:103]
    v_pk_fma_f32 v[184:185], v[120:121], v[224:225], v[184:185]
    v_pk_fma_f32 v[186:187], v[122:123], v[224:225], v[186:187]
    v_pk_fma_f32 v[204:205], v[124:125], v[224:225], v[204:205]
    v_pk_fma_f32 v[206:207], v[126:127], v[224:225], v[206:207]
    v_pk_mul_f32 v[184:185], v[184:185], v[136:137]
    v_pk_mul_f32 v[186:187], v[186:187], v[138:139]
    v_pk_mul_f32 v[204:205], v[204:205], v[140:141]
    v_pk_mul_f32 v[206:207], v[206:207], v[142:143]
    v_pk_mul_f32 v[8:9], v[184:185], v[184:185]
    v_pk_mul_f32 v[10:11], v[186:187], v[186:187]
    v_pk_mul_f32 v[12:13], v[204:205], v[204:205]
    v_pk_mul_f32 v[14:15], v[206:207], v[206:207]
    v_pk_fma_f32 v[8:9], v[8:9], v[2:3], v[0:1]
    v_pk_fma_f32 v[10:11], v[10:11], v[2:3], v[0:1]
    v_pk_fma_f32 v[12:13], v[12:13], v[2:3], v[0:1]
    v_pk_fma_f32 v[14:15], v[14:15], v[2:3], v[0:1]
    v_pk_mul_f32 v[8:9], v[8:9], v[184:185]
    v_pk_mul_f32 v[10:11], v[10:11], v[186:187]
    v_pk_mul_f32 v[12:13], v[12:13], v[204:205]
    v_pk_mul_f32 v[14:15], v[14:15], v[206:207]
    v_exp_f32 v8, v8
    v_exp_f32 v9, v9
    v_exp_f32 v10, v10
    v_exp_f32 v11, v11
    v_exp_f32 v12, v12
    v_exp_f32 v13, v13
    v_exp_f32 v14, v14
    v_exp_f32 v15, v15
    v_pk_add_f32 v[8:9], v[8:9], v[4:5]
    v_pk_add_f32 v[10:11], v[10:11], v[4:5]
    v_pk_add_f32 v[12:13], v[12:13], v[4:5]
    v_pk_add_f32 v[14:15], v[14:15], v[4:5]
    v_rcp_f32 v8, v8
    v_rcp_f32 v9, v9
    v_rcp_f32 v10, v10
    v_rcp_f32 v11, v11
    v_rcp_f32 v12, v12
    v_rcp_f32 v13, v13
    v_rcp_f32 v14, v14
    v_rcp_f32 v15, v15
    v_pk_mul_f32 v[184:185], v[184:185], v[8:9]
    v_pk_mul_f32 v[186:187], v[186:187], v[10:11]
    v_pk_mul_f32 v[204:205], v[204:205], v[12:13]
    v_pk_mul_f32 v[206:207], v[206:207], v[14:15]
    v_cvt_pk_bf16_f32 v76, v184, v185
    v_cvt_pk_bf16_f32 v77, v186, v187
    v_cvt_pk_bf16_f32 v78, v204, v205
    v_cvt_pk_bf16_f32 v79, v206, v207
    ds_write_b128 v251, v[76:79] offset:9216
    v_pk_add_f32 v[88:89], v[88:89], v[184:185]
    v_pk_fma_f32 v[104:105], v[184:185], v[184:185], v[104:105]
    v_pk_add_f32 v[90:91], v[90:91], v[186:187]
    v_pk_fma_f32 v[106:107], v[186:187], v[186:187], v[106:107]
    v_pk_add_f32 v[92:93], v[92:93], v[204:205]
    v_pk_fma_f32 v[108:109], v[204:205], v[204:205], v[108:109]
    v_pk_add_f32 v[94:95], v[94:95], v[206:207]
    v_pk_fma_f32 v[110:111], v[206:207], v[206:207], v[110:111]
    v_pk_fma_f32 v[148:149], v[112:113], v[228:229], v[148:149]
    v_pk_fma_f32 v[150:151], v[114:115], v[228:229], v[150:151]
    v_pk_fma_f32 v[168:169], v[116:117], v[228:229], v[168:169]
    v_pk_fma_f32 v[170:171], v[118:119], v[228:229], v[170:171]
    v_pk_mul_f32 v[148:149], v[148:149], v[128:129]
    v_pk_mul_f32 v[150:151], v[150:151], v[130:131]
    v_pk_mul_f32 v[168:169], v[168:169], v[132:133]
    v_pk_mul_f32 v[170:171], v[170:171], v[134:135]
    v_pk_mul_f32 v[8:9], v[148:149], v[148:149]
    v_pk_mul_f32 v[10:11], v[150:151], v[150:151]
    v_pk_mul_f32 v[12:13], v[168:169], v[168:169]
    v_pk_mul_f32 v[14:15], v[170:171], v[170:171]
    v_pk_fma_f32 v[8:9], v[8:9], v[2:3], v[0:1]
    v_pk_fma_f32 v[10:11], v[10:11], v[2:3], v[0:1]
    v_pk_fma_f32 v[12:13], v[12:13], v[2:3], v[0:1]
    v_pk_fma_f32 v[14:15], v[14:15], v[2:3], v[0:1]
    v_pk_mul_f32 v[8:9], v[8:9], v[148:149]
    v_pk_mul_f32 v[10:11], v[10:11], v[150:151]
    v_pk_mul_f32 v[12:13], v[12:13], v[168:169]
    v_pk_mul_f32 v[14:15], v[14:15], v[170:171]
    v_exp_f32 v8, v8
    v_exp_f32 v9, v9
    v_exp_f32 v10, v10
    v_exp_f32 v11, v11
    v_exp_f32 v12, v12
    v_exp_f32 v13, v13
    v_exp_f32 v14, v14
    v_exp_f32 v15, v15
    v_pk_add_f32 v[8:9], v[8:9], v[4:5]
    v_pk_add_f32 v[10:11], v[10:11], v[4:5]
    v_pk_add_f32 v[12:13], v[12:13], v[4:5]
    v_pk_add_f32 v[14:15], v[14:15], v[4:5]
    v_rcp_f32 v8, v8
    v_rcp_f32 v9, v9
    v_rcp_f32 v10, v10
    v_rcp_f32 v11, v11
    v_rcp_f32 v12, v12
    v_rcp_f32 v13, v13
    v_rcp_f32 v14, v14
    v_rcp_f32 v15, v15
    v_pk_mul_f32 v[148:149], v[148:149], v[8:9]
    v_pk_mul_f32 v[150:151], v[150:151], v[10:11]
    v_pk_mul_f32 v[168:169], v[168:169], v[12:13]
    v_pk_mul_f32 v[170:171], v[170:171], v[14:15]
    v_cvt_pk_bf16_f32 v72, v148, v149
    v_cvt_pk_bf16_f32 v73, v150, v151
    v_cvt_pk_bf16_f32 v74, v168, v169
    v_cvt_pk_bf16_f32 v75, v170, v171
    ds_write_b128 v251, v[72:75] offset:1024
    v_pk_add_f32 v[80:81], v[80:81], v[148:149]
    v_pk_fma_f32 v[96:97], v[148:149], v[148:149], v[96:97]
    v_pk_add_f32 v[82:83], v[82:83], v[150:151]
    v_pk_fma_f32 v[98:99], v[150:151], v[150:151], v[98:99]
    v_pk_add_f32 v[84:85], v[84:85], v[168:169]
    v_pk_fma_f32 v[100:101], v[168:169], v[168:169], v[100:101]
    v_pk_add_f32 v[86:87], v[86:87], v[170:171]
    v_pk_fma_f32 v[102:103], v[170:171], v[170:171], v[102:103]
    v_pk_fma_f32 v[188:189], v[120:121], v[228:229], v[188:189]
    v_pk_fma_f32 v[190:191], v[122:123], v[228:229], v[190:191]
    v_pk_fma_f32 v[208:209], v[124:125], v[228:229], v[208:209]
    v_pk_fma_f32 v[210:211], v[126:127], v[228:229], v[210:211]
    v_pk_mul_f32 v[188:189], v[188:189], v[136:137]
    v_pk_mul_f32 v[190:191], v[190:191], v[138:139]
    v_pk_mul_f32 v[208:209], v[208:209], v[140:141]
    v_pk_mul_f32 v[210:211], v[210:211], v[142:143]
    v_pk_mul_f32 v[8:9], v[188:189], v[188:189]
    v_pk_mul_f32 v[10:11], v[190:191], v[190:191]
    v_pk_mul_f32 v[12:13], v[208:209], v[208:209]
    v_pk_mul_f32 v[14:15], v[210:211], v[210:211]
    v_pk_fma_f32 v[8:9], v[8:9], v[2:3], v[0:1]
    v_pk_fma_f32 v[10:11], v[10:11], v[2:3], v[0:1]
    v_pk_fma_f32 v[12:13], v[12:13], v[2:3], v[0:1]
    v_pk_fma_f32 v[14:15], v[14:15], v[2:3], v[0:1]
    v_pk_mul_f32 v[8:9], v[8:9], v[188:189]
    v_pk_mul_f32 v[10:11], v[10:11], v[190:191]
    v_pk_mul_f32 v[12:13], v[12:13], v[208:209]
    v_pk_mul_f32 v[14:15], v[14:15], v[210:211]
    v_exp_f32 v8, v8
    v_exp_f32 v9, v9
    v_exp_f32 v10, v10
    v_exp_f32 v11, v11
    v_exp_f32 v12, v12
    v_exp_f32 v13, v13
    v_exp_f32 v14, v14
    v_exp_f32 v15, v15
    v_pk_add_f32 v[8:9], v[8:9], v[4:5]
    v_pk_add_f32 v[10:11], v[10:11], v[4:5]
    v_pk_add_f32 v[12:13], v[12:13], v[4:5]
    v_pk_add_f32 v[14:15], v[14:15], v[4:5]
    v_rcp_f32 v8, v8
    v_rcp_f32 v9, v9
    v_rcp_f32 v10, v10
    v_rcp_f32 v11, v11
    v_rcp_f32 v12, v12
    v_rcp_f32 v13, v13
    v_rcp_f32 v14, v14
    v_rcp_f32 v15, v15
    v_pk_mul_f32 v[188:189], v[188:189], v[8:9]
    v_pk_mul_f32 v[190:191], v[190:191], v[10:11]
    v_pk_mul_f32 v[208:209], v[208:209], v[12:13]
    v_pk_mul_f32 v[210:211], v[210:211], v[14:15]
    v_cvt_pk_bf16_f32 v76, v188, v189
    v_cvt_pk_bf16_f32 v77, v190, v191
    v_cvt_pk_bf16_f32 v78, v208, v209
    v_cvt_pk_bf16_f32 v79, v210, v211
    ds_write_b128 v251, v[76:79] offset:10240
    v_pk_add_f32 v[88:89], v[88:89], v[188:189]
    v_pk_fma_f32 v[104:105], v[188:189], v[188:189], v[104:105]
    v_pk_add_f32 v[90:91], v[90:91], v[190:191]
    v_pk_fma_f32 v[106:107], v[190:191], v[190:191], v[106:107]
    v_pk_add_f32 v[92:93], v[92:93], v[208:209]
    v_pk_fma_f32 v[108:109], v[208:209], v[208:209], v[108:109]
    v_pk_add_f32 v[94:95], v[94:95], v[210:211]
    v_pk_fma_f32 v[110:111], v[210:211], v[210:211], v[110:111]
    v_pk_fma_f32 v[152:153], v[112:113], v[232:233], v[152:153]
    v_pk_fma_f32 v[154:155], v[114:115], v[232:233], v[154:155]
    v_pk_fma_f32 v[172:173], v[116:117], v[232:233], v[172:173]
    v_pk_fma_f32 v[174:175], v[118:119], v[232:233], v[174:175]
    v_pk_mul_f32 v[152:153], v[152:153], v[128:129]
    v_pk_mul_f32 v[154:155], v[154:155], v[130:131]
    v_pk_mul_f32 v[172:173], v[172:173], v[132:133]
    v_pk_mul_f32 v[174:175], v[174:175], v[134:135]
    v_pk_mul_f32 v[8:9], v[152:153], v[152:153]
    v_pk_mul_f32 v[10:11], v[154:155], v[154:155]
    v_pk_mul_f32 v[12:13], v[172:173], v[172:173]
    v_pk_mul_f32 v[14:15], v[174:175], v[174:175]
    v_pk_fma_f32 v[8:9], v[8:9], v[2:3], v[0:1]
    v_pk_fma_f32 v[10:11], v[10:11], v[2:3], v[0:1]
    v_pk_fma_f32 v[12:13], v[12:13], v[2:3], v[0:1]
    v_pk_fma_f32 v[14:15], v[14:15], v[2:3], v[0:1]
    v_pk_mul_f32 v[8:9], v[8:9], v[152:153]
    v_pk_mul_f32 v[10:11], v[10:11], v[154:155]
    v_pk_mul_f32 v[12:13], v[12:13], v[172:173]
    v_pk_mul_f32 v[14:15], v[14:15], v[174:175]
    v_exp_f32 v8, v8
    v_exp_f32 v9, v9
    v_exp_f32 v10, v10
    v_exp_f32 v11, v11
    v_exp_f32 v12, v12
    v_exp_f32 v13, v13
    v_exp_f32 v14, v14
    v_exp_f32 v15, v15
    v_pk_add_f32 v[8:9], v[8:9], v[4:5]
    v_pk_add_f32 v[10:11], v[10:11], v[4:5]
    v_pk_add_f32 v[12:13], v[12:13], v[4:5]
    v_pk_add_f32 v[14:15], v[14:15], v[4:5]
    v_rcp_f32 v8, v8
    v_rcp_f32 v9, v9
    v_rcp_f32 v10, v10
    v_rcp_f32 v11, v11
    v_rcp_f32 v12, v12
    v_rcp_f32 v13, v13
    v_rcp_f32 v14, v14
    v_rcp_f32 v15, v15
    v_pk_mul_f32 v[152:153], v[152:153], v[8:9]
    v_pk_mul_f32 v[154:155], v[154:155], v[10:11]
    v_pk_mul_f32 v[172:173], v[172:173], v[12:13]
    v_pk_mul_f32 v[174:175], v[174:175], v[14:15]
    v_cvt_pk_bf16_f32 v72, v152, v153
    v_cvt_pk_bf16_f32 v73, v154, v155
    v_cvt_pk_bf16_f32 v74, v172, v173
    v_cvt_pk_bf16_f32 v75, v174, v175
    ds_write_b128 v251, v[72:75] offset:2048
    v_pk_add_f32 v[80:81], v[80:81], v[152:153]
    v_pk_fma_f32 v[96:97], v[152:153], v[152:153], v[96:97]
    v_pk_add_f32 v[82:83], v[82:83], v[154:155]
    v_pk_fma_f32 v[98:99], v[154:155], v[154:155], v[98:99]
    v_pk_add_f32 v[84:85], v[84:85], v[172:173]
    v_pk_fma_f32 v[100:101], v[172:173], v[172:173], v[100:101]
    v_pk_add_f32 v[86:87], v[86:87], v[174:175]
    v_pk_fma_f32 v[102:103], v[174:175], v[174:175], v[102:103]
    v_pk_fma_f32 v[192:193], v[120:121], v[232:233], v[192:193]
    v_pk_fma_f32 v[194:195], v[122:123], v[232:233], v[194:195]
    v_pk_fma_f32 v[212:213], v[124:125], v[232:233], v[212:213]
    v_pk_fma_f32 v[214:215], v[126:127], v[232:233], v[214:215]
    v_pk_mul_f32 v[192:193], v[192:193], v[136:137]
    v_pk_mul_f32 v[194:195], v[194:195], v[138:139]
    v_pk_mul_f32 v[212:213], v[212:213], v[140:141]
    v_pk_mul_f32 v[214:215], v[214:215], v[142:143]
    v_pk_mul_f32 v[8:9], v[192:193], v[192:193]
    v_pk_mul_f32 v[10:11], v[194:195], v[194:195]
    v_pk_mul_f32 v[12:13], v[212:213], v[212:213]
    v_pk_mul_f32 v[14:15], v[214:215], v[214:215]
    v_pk_fma_f32 v[8:9], v[8:9], v[2:3], v[0:1]
    v_pk_fma_f32 v[10:11], v[10:11], v[2:3], v[0:1]
    v_pk_fma_f32 v[12:13], v[12:13], v[2:3], v[0:1]
    v_pk_fma_f32 v[14:15], v[14:15], v[2:3], v[0:1]
    v_pk_mul_f32 v[8:9], v[8:9], v[192:193]
    v_pk_mul_f32 v[10:11], v[10:11], v[194:195]
    v_pk_mul_f32 v[12:13], v[12:13], v[212:213]
    v_pk_mul_f32 v[14:15], v[14:15], v[214:215]
    v_exp_f32 v8, v8
    v_exp_f32 v9, v9
    v_exp_f32 v10, v10
    v_exp_f32 v11, v11
    v_exp_f32 v12, v12
    v_exp_f32 v13, v13
    v_exp_f32 v14, v14
    v_exp_f32 v15, v15
    v_pk_add_f32 v[8:9], v[8:9], v[4:5]
    v_pk_add_f32 v[10:11], v[10:11], v[4:5]
    v_pk_add_f32 v[12:13], v[12:13], v[4:5]
    v_pk_add_f32 v[14:15], v[14:15], v[4:5]
    v_rcp_f32 v8, v8
    v_rcp_f32 v9, v9
    v_rcp_f32 v10, v10
    v_rcp_f32 v11, v11
    v_rcp_f32 v12, v12
    v_rcp_f32 v13, v13
    v_rcp_f32 v14, v14
    v_rcp_f32 v15, v15
    v_pk_mul_f32 v[192:193], v[192:193], v[8:9]
    v_pk_mul_f32 v[194:195], v[194:195], v[10:11]
    v_pk_mul_f32 v[212:213], v[212:213], v[12:13]
    v_pk_mul_f32 v[214:215], v[214:215], v[14:15]
    v_cvt_pk_bf16_f32 v76, v192, v193
    v_cvt_pk_bf16_f32 v77, v194, v195
    v_cvt_pk_bf16_f32 v78, v212, v213
    v_cvt_pk_bf16_f32 v79, v214, v215
    ds_write_b128 v251, v[76:79] offset:11264
    v_pk_add_f32 v[88:89], v[88:89], v[192:193]
    v_pk_fma_f32 v[104:105], v[192:193], v[192:193], v[104:105]
    v_pk_add_f32 v[90:91], v[90:91], v[194:195]
    v_pk_fma_f32 v[106:107], v[194:195], v[194:195], v[106:107]
    v_pk_add_f32 v[92:93], v[92:93], v[212:213]
    v_pk_fma_f32 v[108:109], v[212:213], v[212:213], v[108:109]
    v_pk_add_f32 v[94:95], v[94:95], v[214:215]
    v_pk_fma_f32 v[110:111], v[214:215], v[214:215], v[110:111]
    v_pk_fma_f32 v[156:157], v[112:113], v[236:237], v[156:157]
    v_pk_fma_f32 v[158:159], v[114:115], v[236:237], v[158:159]
    v_pk_fma_f32 v[176:177], v[116:117], v[236:237], v[176:177]
    v_pk_fma_f32 v[178:179], v[118:119], v[236:237], v[178:179]
    v_pk_mul_f32 v[156:157], v[156:157], v[128:129]
    v_pk_mul_f32 v[158:159], v[158:159], v[130:131]
    v_pk_mul_f32 v[176:177], v[176:177], v[132:133]
    v_pk_mul_f32 v[178:179], v[178:179], v[134:135]
    v_pk_mul_f32 v[8:9], v[156:157], v[156:157]
    v_pk_mul_f32 v[10:11], v[158:159], v[158:159]
    v_pk_mul_f32 v[12:13], v[176:177], v[176:177]
    v_pk_mul_f32 v[14:15], v[178:179], v[178:179]
    v_pk_fma_f32 v[8:9], v[8:9], v[2:3], v[0:1]
    v_pk_fma_f32 v[10:11], v[10:11], v[2:3], v[0:1]
    v_pk_fma_f32 v[12:13], v[12:13], v[2:3], v[0:1]
    v_pk_fma_f32 v[14:15], v[14:15], v[2:3], v[0:1]
    v_pk_mul_f32 v[8:9], v[8:9], v[156:157]
    v_pk_mul_f32 v[10:11], v[10:11], v[158:159]
    v_pk_mul_f32 v[12:13], v[12:13], v[176:177]
    v_pk_mul_f32 v[14:15], v[14:15], v[178:179]
    v_exp_f32 v8, v8
    v_exp_f32 v9, v9
    v_exp_f32 v10, v10
    v_exp_f32 v11, v11
    v_exp_f32 v12, v12
    v_exp_f32 v13, v13
    v_exp_f32 v14, v14
    v_exp_f32 v15, v15
    v_pk_add_f32 v[8:9], v[8:9], v[4:5]
    v_pk_add_f32 v[10:11], v[10:11], v[4:5]
    v_pk_add_f32 v[12:13], v[12:13], v[4:5]
    v_pk_add_f32 v[14:15], v[14:15], v[4:5]
    v_rcp_f32 v8, v8
    v_rcp_f32 v9, v9
    v_rcp_f32 v10, v10
    v_rcp_f32 v11, v11
    v_rcp_f32 v12, v12
    v_rcp_f32 v13, v13
    v_rcp_f32 v14, v14
    v_rcp_f32 v15, v15
    v_pk_mul_f32 v[156:157], v[156:157], v[8:9]
    v_pk_mul_f32 v[158:159], v[158:159], v[10:11]
    v_pk_mul_f32 v[176:177], v[176:177], v[12:13]
    v_pk_mul_f32 v[178:179], v[178:179], v[14:15]
    v_cvt_pk_bf16_f32 v72, v156, v157
    v_cvt_pk_bf16_f32 v73, v158, v159
    v_cvt_pk_bf16_f32 v74, v176, v177
    v_cvt_pk_bf16_f32 v75, v178, v179
    ds_write_b128 v251, v[72:75] offset:3072
    v_pk_add_f32 v[80:81], v[80:81], v[156:157]
    v_pk_fma_f32 v[96:97], v[156:157], v[156:157], v[96:97]
    v_pk_add_f32 v[82:83], v[82:83], v[158:159]
    v_pk_fma_f32 v[98:99], v[158:159], v[158:159], v[98:99]
    v_pk_add_f32 v[84:85], v[84:85], v[176:177]
    v_pk_fma_f32 v[100:101], v[176:177], v[176:177], v[100:101]
    v_pk_add_f32 v[86:87], v[86:87], v[178:179]
    v_pk_fma_f32 v[102:103], v[178:179], v[178:179], v[102:103]
    v_pk_fma_f32 v[196:197], v[120:121], v[236:237], v[196:197]
    v_pk_fma_f32 v[198:199], v[122:123], v[236:237], v[198:199]
    v_pk_fma_f32 v[216:217], v[124:125], v[236:237], v[216:217]
    v_pk_fma_f32 v[218:219], v[126:127], v[236:237], v[218:219]
    v_pk_mul_f32 v[196:197], v[196:197], v[136:137]
    v_pk_mul_f32 v[198:199], v[198:199], v[138:139]
    v_pk_mul_f32 v[216:217], v[216:217], v[140:141]
    v_pk_mul_f32 v[218:219], v[218:219], v[142:143]
    v_pk_mul_f32 v[8:9], v[196:197], v[196:197]
    v_pk_mul_f32 v[10:11], v[198:199], v[198:199]
    v_pk_mul_f32 v[12:13], v[216:217], v[216:217]
    v_pk_mul_f32 v[14:15], v[218:219], v[218:219]
    v_pk_fma_f32 v[8:9], v[8:9], v[2:3], v[0:1]
    v_pk_fma_f32 v[10:11], v[10:11], v[2:3], v[0:1]
    v_pk_fma_f32 v[12:13], v[12:13], v[2:3], v[0:1]
    v_pk_fma_f32 v[14:15], v[14:15], v[2:3], v[0:1]
    v_pk_mul_f32 v[8:9], v[8:9], v[196:197]
    v_pk_mul_f32 v[10:11], v[10:11], v[198:199]
    v_pk_mul_f32 v[12:13], v[12:13], v[216:217]
    v_pk_mul_f32 v[14:15], v[14:15], v[218:219]
    v_exp_f32 v8, v8
    v_exp_f32 v9, v9
    v_exp_f32 v10, v10
    v_exp_f32 v11, v11
    v_exp_f32 v12, v12
    v_exp_f32 v13, v13
    v_exp_f32 v14, v14
    v_exp_f32 v15, v15
    v_pk_add_f32 v[8:9], v[8:9], v[4:5]
    v_pk_add_f32 v[10:11], v[10:11], v[4:5]
    v_pk_add_f32 v[12:13], v[12:13], v[4:5]
    v_pk_add_f32 v[14:15], v[14:15], v[4:5]
    v_rcp_f32 v8, v8
    v_rcp_f32 v9, v9
    v_rcp_f32 v10, v10
    v_rcp_f32 v11, v11
    v_rcp_f32 v12, v12
    v_rcp_f32 v13, v13
    v_rcp_f32 v14, v14
    v_rcp_f32 v15, v15
    v_pk_mul_f32 v[196:197], v[196:197], v[8:9]
    v_pk_mul_f32 v[198:199], v[198:199], v[10:11]
    v_pk_mul_f32 v[216:217], v[216:217], v[12:13]
    v_pk_mul_f32 v[218:219], v[218:219], v[14:15]
    v_cvt_pk_bf16_f32 v76, v196, v197
    v_cvt_pk_bf16_f32 v77, v198, v199
    v_cvt_pk_bf16_f32 v78, v216, v217
    v_cvt_pk_bf16_f32 v79, v218, v219
    ds_write_b128 v251, v[76:79] offset:12288
    v_pk_add_f32 v[88:89], v[88:89], v[196:197]
    v_pk_fma_f32 v[104:105], v[196:197], v[196:197], v[104:105]
    v_pk_add_f32 v[90:91], v[90:91], v[198:199]
    v_pk_fma_f32 v[106:107], v[198:199], v[198:199], v[106:107]
    v_pk_add_f32 v[92:93], v[92:93], v[216:217]
    v_pk_fma_f32 v[108:109], v[216:217], v[216:217], v[108:109]
    v_pk_add_f32 v[94:95], v[94:95], v[218:219]
    v_pk_fma_f32 v[110:111], v[218:219], v[218:219], v[110:111]
    s_cbranch_vccz parallel_sum__sliding_local_dilated__mixer_gmlp__prompt_kernel_us32
    v_pk_fma_f32 v[160:161], v[112:113], v[240:241], v[160:161]
    v_pk_fma_f32 v[162:163], v[114:115], v[240:241], v[162:163]
    v_pk_fma_f32 v[180:181], v[116:117], v[240:241], v[180:181]
    v_pk_fma_f32 v[182:183], v[118:119], v[240:241], v[182:183]
    v_pk_mul_f32 v[160:161], v[160:161], v[128:129]
    v_pk_mul_f32 v[162:163], v[162:163], v[130:131]
    v_pk_mul_f32 v[180:181], v[180:181], v[132:133]
    v_pk_mul_f32 v[182:183], v[182:183], v[134:135]
    v_pk_mul_f32 v[8:9], v[160:161], v[160:161]
    v_pk_mul_f32 v[10:11], v[162:163], v[162:163]
    v_pk_mul_f32 v[12:13], v[180:181], v[180:181]
    v_pk_mul_f32 v[14:15], v[182:183], v[182:183]
    v_pk_fma_f32 v[8:9], v[8:9], v[2:3], v[0:1]
    v_pk_fma_f32 v[10:11], v[10:11], v[2:3], v[0:1]
    v_pk_fma_f32 v[12:13], v[12:13], v[2:3], v[0:1]
    v_pk_fma_f32 v[14:15], v[14:15], v[2:3], v[0:1]
    v_pk_mul_f32 v[8:9], v[8:9], v[160:161]
    v_pk_mul_f32 v[10:11], v[10:11], v[162:163]
    v_pk_mul_f32 v[12:13], v[12:13], v[180:181]
    v_pk_mul_f32 v[14:15], v[14:15], v[182:183]
    v_exp_f32 v8, v8
    v_exp_f32 v9, v9
    v_exp_f32 v10, v10
    v_exp_f32 v11, v11
    v_exp_f32 v12, v12
    v_exp_f32 v13, v13
    v_exp_f32 v14, v14
    v_exp_f32 v15, v15
    v_pk_add_f32 v[8:9], v[8:9], v[4:5]
    v_pk_add_f32 v[10:11], v[10:11], v[4:5]
    v_pk_add_f32 v[12:13], v[12:13], v[4:5]
    v_pk_add_f32 v[14:15], v[14:15], v[4:5]
    v_rcp_f32 v8, v8
    v_rcp_f32 v9, v9
    v_rcp_f32 v10, v10
    v_rcp_f32 v11, v11
    v_rcp_f32 v12, v12
    v_rcp_f32 v13, v13
    v_rcp_f32 v14, v14
    v_rcp_f32 v15, v15
    v_pk_mul_f32 v[160:161], v[160:161], v[8:9]
    v_pk_mul_f32 v[162:163], v[162:163], v[10:11]
    v_pk_mul_f32 v[180:181], v[180:181], v[12:13]
    v_pk_mul_f32 v[182:183], v[182:183], v[14:15]
    v_cvt_pk_bf16_f32 v72, v160, v161
    v_cvt_pk_bf16_f32 v73, v162, v163
    v_cvt_pk_bf16_f32 v74, v180, v181
    v_cvt_pk_bf16_f32 v75, v182, v183
    ds_write_b128 v251, v[72:75] offset:4096
    v_pk_add_f32 v[80:81], v[80:81], v[160:161]
    v_pk_fma_f32 v[96:97], v[160:161], v[160:161], v[96:97]
    v_pk_add_f32 v[82:83], v[82:83], v[162:163]
    v_pk_fma_f32 v[98:99], v[162:163], v[162:163], v[98:99]
    v_pk_add_f32 v[84:85], v[84:85], v[180:181]
    v_pk_fma_f32 v[100:101], v[180:181], v[180:181], v[100:101]
    v_pk_add_f32 v[86:87], v[86:87], v[182:183]
    v_pk_fma_f32 v[102:103], v[182:183], v[182:183], v[102:103]
    v_pk_fma_f32 v[200:201], v[120:121], v[240:241], v[200:201]
    v_pk_fma_f32 v[202:203], v[122:123], v[240:241], v[202:203]
    v_pk_fma_f32 v[220:221], v[124:125], v[240:241], v[220:221]
    v_pk_fma_f32 v[222:223], v[126:127], v[240:241], v[222:223]
    v_pk_mul_f32 v[200:201], v[200:201], v[136:137]
    v_pk_mul_f32 v[202:203], v[202:203], v[138:139]
    v_pk_mul_f32 v[220:221], v[220:221], v[140:141]
    v_pk_mul_f32 v[222:223], v[222:223], v[142:143]
    v_pk_mul_f32 v[8:9], v[200:201], v[200:201]
    v_pk_mul_f32 v[10:11], v[202:203], v[202:203]
    v_pk_mul_f32 v[12:13], v[220:221], v[220:221]
    v_pk_mul_f32 v[14:15], v[222:223], v[222:223]
    v_pk_fma_f32 v[8:9], v[8:9], v[2:3], v[0:1]
    v_pk_fma_f32 v[10:11], v[10:11], v[2:3], v[0:1]
    v_pk_fma_f32 v[12:13], v[12:13], v[2:3], v[0:1]
    v_pk_fma_f32 v[14:15], v[14:15], v[2:3], v[0:1]
    v_pk_mul_f32 v[8:9], v[8:9], v[200:201]
    v_pk_mul_f32 v[10:11], v[10:11], v[202:203]
    v_pk_mul_f32 v[12:13], v[12:13], v[220:221]
    v_pk_mul_f32 v[14:15], v[14:15], v[222:223]
    v_exp_f32 v8, v8
    v_exp_f32 v9, v9
    v_exp_f32 v10, v10
    v_exp_f32 v11, v11
    v_exp_f32 v12, v12
    v_exp_f32 v13, v13
    v_exp_f32 v14, v14
    v_exp_f32 v15, v15
    v_pk_add_f32 v[8:9], v[8:9], v[4:5]
    v_pk_add_f32 v[10:11], v[10:11], v[4:5]
    v_pk_add_f32 v[12:13], v[12:13], v[4:5]
    v_pk_add_f32 v[14:15], v[14:15], v[4:5]
    v_rcp_f32 v8, v8
    v_rcp_f32 v9, v9
    v_rcp_f32 v10, v10
    v_rcp_f32 v11, v11
    v_rcp_f32 v12, v12
    v_rcp_f32 v13, v13
    v_rcp_f32 v14, v14
    v_rcp_f32 v15, v15
    v_pk_mul_f32 v[200:201], v[200:201], v[8:9]
    v_pk_mul_f32 v[202:203], v[202:203], v[10:11]
    v_pk_mul_f32 v[220:221], v[220:221], v[12:13]
    v_pk_mul_f32 v[222:223], v[222:223], v[14:15]
    v_cvt_pk_bf16_f32 v76, v200, v201
    v_cvt_pk_bf16_f32 v77, v202, v203
    v_cvt_pk_bf16_f32 v78, v220, v221
    v_cvt_pk_bf16_f32 v79, v222, v223
    ds_write_b128 v251, v[76:79] offset:13312
    v_pk_add_f32 v[88:89], v[88:89], v[200:201]
    v_pk_fma_f32 v[104:105], v[200:201], v[200:201], v[104:105]
    v_pk_add_f32 v[90:91], v[90:91], v[202:203]
    v_pk_fma_f32 v[106:107], v[202:203], v[202:203], v[106:107]
    v_pk_add_f32 v[92:93], v[92:93], v[220:221]
    v_pk_fma_f32 v[108:109], v[220:221], v[220:221], v[108:109]
    v_pk_add_f32 v[94:95], v[94:95], v[222:223]
    v_pk_fma_f32 v[110:111], v[222:223], v[222:223], v[110:111]
parallel_sum__sliding_local_dilated__mixer_gmlp__prompt_kernel_us32:
    s_mov_b32 s60, 0x22222222
    s_mov_b32 s61, 0x22222222
    s_mov_b32 s62, 0x44444444
    s_mov_b32 s63, 0x44444444
    s_mov_b32 s64, 0x88888888
    s_mov_b32 s65, 0x88888888
    v_add_f32_dpp v80, v80, v80 row_ror:8 row_mask:0xf bank_mask:0x3
    v_add_f32_dpp v88, v88, v88 row_ror:8 row_mask:0xf bank_mask:0x3
    v_add_f32_dpp v96, v96, v96 row_ror:8 row_mask:0xf bank_mask:0x3
    v_add_f32_dpp v104, v104, v104 row_ror:8 row_mask:0xf bank_mask:0x3
    v_add_f32_dpp v81, v81, v81 row_ror:8 row_mask:0xf bank_mask:0x3
    v_add_f32_dpp v89, v89, v89 row_ror:8 row_mask:0xf bank_mask:0x3
    v_add_f32_dpp v97, v97, v97 row_ror:8 row_mask:0xf bank_mask:0x3
    v_add_f32_dpp v105, v105, v105 row_ror:8 row_mask:0xf bank_mask:0x3
    v_add_f32_dpp v82, v82, v82 row_ror:8 row_mask:0xf bank_mask:0x3
    v_add_f32_dpp v90, v90, v90 row_ror:8 row_mask:0xf bank_mask:0x3
    v_add_f32_dpp v98, v98, v98 row_ror:8 row_mask:0xf bank_mask:0x3
    v_add_f32_dpp v106, v106, v106 row_ror:8 row_mask:0xf bank_mask:0x3
    v_add_f32_dpp v83, v83, v83 row_ror:8 row_mask:0xf bank_mask:0x3
    v_add_f32_dpp v91, v91, v91 row_ror:8 row_mask:0xf bank_mask:0x3
    v_add_f32_dpp v99, v99, v99 row_ror:8 row_mask:0xf bank_mask:0x3
    v_add_f32_dpp v107, v107, v107 row_ror:8 row_mask:0xf bank_mask:0x3
    v_add_f32_dpp v80, v84, v84 row_ror:8 row_mask:0xf bank_mask:0xc
    v_add_f32_dpp v88, v92, v92 row_ror:8 row_mask:0xf bank_mask:0xc
    v_add_f32_dpp v96, v100, v100 row_ror:8 row_mask:0xf bank_mask:0xc
    v_add_f32_dpp v104, v108, v108 row_ror:8 row_mask:0xf bank_mask:0xc
    v_add_f32_dpp v81, v85, v85 row_ror:8 row_mask:0xf bank_mask:0xc
    v_add_f32_dpp v89, v93, v93 row_ror:8 row_mask:0xf bank_mask:0xc
    v_add_f32_dpp v97, v101, v101 row_ror:8 row_mask:0xf bank_mask:0xc
    v_add_f32_dpp v105, v109, v109 row_ror:8 row_mask:0xf bank_mask:0xc
    v_add_f32_dpp v82, v86, v86 row_ror:8 row_mask:0xf bank_mask:0xc
    v_add_f32_dpp v90, v94, v94 row_ror:8 row_mask:0xf bank_mask:0xc
    v_add_f32_dpp v98, v102, v102 row_ror:8 row_mask:0xf bank_mask:0xc
    v_add_f32_dpp v106, v110, v110 row_ror:8 row_mask:0xf bank_mask:0xc
    v_add_f32_dpp v83, v87, v87 row_ror:8 row_mask:0xf bank_mask:0xc
    v_add_f32_dpp v91, v95, v95 row_ror:8 row_mask:0xf bank_mask:0xc
    v_add_f32_dpp v99, v103, v103 row_ror:8 row_mask:0xf bank_mask:0xc
    v_add_f32_dpp v107, v111, v111 row_ror:8 row_mask:0xf bank_mask:0xc
    v_add_f32_dpp v80, v80, v80 row_half_mirror row_mask:0xf bank_mask:0x5
    v_add_f32_dpp v88, v88, v88 row_half_mirror row_mask:0xf bank_mask:0x5
    v_add_f32_dpp v96, v96, v96 row_half_mirror row_mask:0xf bank_mask:0x5
    v_add_f32_dpp v104, v104, v104 row_half_mirror row_mask:0xf bank_mask:0x5
    v_add_f32_dpp v81, v81, v81 row_half_mirror row_mask:0xf bank_mask:0x5
    v_add_f32_dpp v89, v89, v89 row_half_mirror row_mask:0xf bank_mask:0x5
    v_add_f32_dpp v97, v97, v97 row_half_mirror row_mask:0xf bank_mask:0x5
    v_add_f32_dpp v105, v105, v105 row_half_mirror row_mask:0xf bank_mask:0x5
    v_add_f32_dpp v80, v82, v82 row_half_mirror row_mask:0xf bank_mask:0xa
    v_add_f32_dpp v88, v90, v90 row_half_mirror row_mask:0xf bank_mask:0xa
    v_add_f32_dpp v96, v98, v98 row_half_mirror row_mask:0xf bank_mask:0xa
    v_add_f32_dpp v104, v106, v106 row_half_mirror row_mask:0xf bank_mask:0xa
    v_add_f32_dpp v81, v83, v83 row_half_mirror row_mask:0xf bank_mask:0xa
    v_add_f32_dpp v89, v91, v91 row_half_mirror row_mask:0xf bank_mask:0xa
    v_add_f32_dpp v97, v99, v99 row_half_mirror row_mask:0xf bank_mask:0xa
    v_add_f32_dpp v105, v107, v107 row_half_mirror row_mask:0xf bank_mask:0xa
    v_add_f32_dpp v80, v80, v80 quad_perm:[1,0,3,2] row_mask:0xf bank_mask:0xf
    v_add_f32_dpp v88, v88, v88 quad_perm:[1,0,3,2] row_mask:0xf bank_mask:0xf
    v_add_f32_dpp v96, v96, v96 quad_perm:[1,0,3,2] row_mask:0xf bank_mask:0xf
    v_add_f32_dpp v104, v104, v104 quad_perm:[1,0,3,2] row_mask:0xf bank_mask:0xf
    v_add_f32_dpp v81, v81, v81 quad_perm:[1,0,3,2] row_mask:0xf bank_mask:0xf
    v_add_f32_dpp v89, v89, v89 quad_perm:[1,0,3,2] row_mask:0xf bank_mask:0xf
    v_add_f32_dpp v97, v97, v97 quad_perm:[1,0,3,2] row_mask:0xf bank_mask:0xf
    v_add_f32_dpp v105, v105, v105 quad_perm:[1,0,3,2] row_mask:0xf bank_mask:0xf
    v_add_f32_dpp v80, v80, v80 quad_perm:[2,3,0,1] row_mask:0xf bank_mask:0xf
    v_add_f32_dpp v88, v88, v88 quad_perm:[2,3,0,1] row_mask:0xf bank_mask:0xf
    v_add_f32_dpp v96, v96, v96 quad_perm:[2,3,0,1] row_mask:0xf bank_mask:0xf
    v_add_f32_dpp v104, v104, v104 quad_perm:[2,3,0,1] row_mask:0xf bank_mask:0xf
    v_add_f32_dpp v81, v81, v81 quad_perm:[2,3,0,1] row_mask:0xf bank_mask:0xf
    v_add_f32_dpp v89, v89, v89 quad_perm:[2,3,0,1] row_mask:0xf bank_mask:0xf
    v_add_f32_dpp v97, v97, v97 quad_perm:[2,3,0,1] row_mask:0xf bank_mask:0xf
    v_add_f32_dpp v105, v105, v105 quad_perm:[2,3,0,1] row_mask:0xf bank_mask:0xf
    v_cndmask_b32 v80, v80, v96, s[60:61]
    v_cndmask_b32 v88, v88, v104, s[60:61]
    v_cndmask_b32 v80, v80, v81, s[62:63]
    v_cndmask_b32 v88, v88, v89, s[62:63]
    v_cndmask_b32 v80, v80, v97, s[64:65]
    v_cndmask_b32 v88, v88, v105, s[64:65]
    s_lshl_b32 s46, s40, 9
    s_add_u32 s46, s46, 139264
    v_lshlrev_b32 v9, 2, v250
    v_add_u32 v9, s46, v9
    ds_write_b32 v9, v80
    ds_write_b32 v9, v88 offset:256
    v_mov_b32 v0, v250
    v_lshlrev_b32 v1, 4, v0
    s_cmp_lg_u32 s32, 0
    s_cbranch_scc1 parallel_sum__sliding_local_dilated__mixer_gmlp__prompt_kernel_cq33
    v_mov_b32 v250, v1
    v_lshrrev_b32 v2, 5, v0
    v_lshlrev_b32 v2, 8, v2
    v_and_b32 v3, 15, v0
    v_lshl_add_u32 v2, v3, 4, v2
    v_bfe_u32 v3, v0, 4, 1
    v_lshl_add_u32 v251, v3, 3, v2
    s_lshl_b32 s50, s40, 13
    v_add_u32 v248, s50, v1
    v_lshrrev_b32 v249, 5, v0
    v_lshlrev_b32 v249, 4, v249
    v_bfe_u32 v2, v0, 4, 1
    v_lshl_add_u32 v249, v2, 2, v249
    v_bfe_u32 v3, v0, 2, 2
    v_add_u32 v249, v249, v3
    v_mul_u32_u24 v249, 288, v249
    v_and_b32 v3, 3, v0
    v_lshl_add_u32 v249, v3, 3, v249
    v_add_u32 v249, 32768, v249
    s_branch parallel_sum__sliding_local_dilated__mixer_gmlp__prompt_kernel_cd34
parallel_sum__sliding_local_dilated__mixer_gmlp__prompt_kernel_cq33:
    s_mul_i32 s50, s41, 10240
    v_add_u32 v248, s50, v1
    s_mul_i32 s50, s42, 14336
    s_add_u32 s50, s50, 18432
    v_add_u32 v249, s50, v1
    v_and_b32 v2, 15, v0
    s_mul_i32 s50, s41, 80
    v_add_u32 v2, s50, v2
    v_mul_u32_u24 v251, 440, v2
    v_lshrrev_b32 v2, 4, v0
    v_lshl_add_u32 v251, v2, 3, v251
    s_mul_i32 s50, s42, 224
    s_add_u32 s50, s50, 69632
    v_add_u32 v251, s50, v251
parallel_sum__sliding_local_dilated__mixer_gmlp__prompt_kernel_cd34:
    s_waitcnt vmcnt(0) lgkmcnt(0)
    s_cmp_lg_u32 s32, 0
    s_cbranch_scc1 parallel_sum__sliding_local_dilated__mixer_gmlp__prompt_kernel_C2q3
    s_mov_b32 s58, 8
    s_barrier
    ds_read_b128 v[0:3], v248 offset:0
    ds_read_b128 v[4:7], v248 offset:2048
    ds_read_b128 v[8:11], v248 offset:4096
    ds_read_b128 v[12:15], v248 offset:6144
    ds_read_b64_tr_b16 v[16:17], v249 offset:0
    ds_read_b64_tr_b16 v[18:19], v249 offset:2304
    ds_read_b64_tr_b16 v[20:21], v249 offset:32
    ds_read_b64_tr_b16 v[22:23], v249 offset:2336
    ds_read_b64_tr_b16 v[24:25], v249 offset:64
    ds_read_b64_tr_b16 v[26:27], v249 offset:2368
    ds_read_b64_tr_b16 v[28:29], v249 offset:96
    ds_read_b64_tr_b16 v[30:31], v249 offset:2400
    ds_read_b64_tr_b16 v[32:33], v249 offset:128
    ds_read_b64_tr_b16 v[34:35], v249 offset:2432
    ds_read_b64_tr_b16 v[36:37], v249 offset:160
    ds_read_b64_tr_b16 v[38:39], v249 offset:2464
    ds_read_b64_tr_b16 v[40:41], v249 offset:192
    ds_read_b64_tr_b16 v[42:43], v249 offset:2496
    ds_read_b64_tr_b16 v[44:45], v249 offset:224
    ds_read_b64_tr_b16 v[46:47], v249 offset:2528
    ds_read_b64_tr_b16 v[48:49], v249 offset:256
    ds_read_b64_tr_b16 v[50:51], v249 offset:2560
    s_waitcnt lgkmcnt(0)
    s_barrier
    v_mfma_f32_16x16x32_bf16 v[104:107], v[16:19], v[0:3], 0
    ds_read_b128 v[52:55], v248 offset:1024
    v_mfma_f32_16x16x32_bf16 v[108:111], v[20:23], v[0:3], 0
    ds_read_b128 v[56:59], v248 offset:3072
    v_mfma_f32_16x16x32_bf16 v[112:115], v[24:27], v[0:3], 0
    ds_read_b128 v[60:63], v248 offset:5120
    v_mfma_f32_16x16x32_bf16 v[116:119], v[28:31], v[0:3], 0
    ds_read_b128 v[64:67], v248 offset:7168
    v_mfma_f32_16x16x32_bf16 v[120:123], v[32:35], v[0:3], 0
    ds_read_b64_tr_b16 v[68:69], v249 offset:9216
    v_mfma_f32_16x16x32_bf16 v[124:127], v[36:39], v[0:3], 0
    ds_read_b64_tr_b16 v[70:71], v249 offset:11520
    v_mfma_f32_16x16x32_bf16 v[128:131], v[40:43], v[0:3], 0
    ds_read_b64_tr_b16 v[72:73], v249 offset:9248
    v_mfma_f32_16x16x32_bf16 v[132:135], v[44:47], v[0:3], 0
    ds_read_b64_tr_b16 v[74:75], v249 offset:11552
    v_mfma_f32_16x16x32_bf16 v[136:139], v[48:51], v[0:3], 0
    ds_read_b64_tr_b16 v[76:77], v249 offset:9280
    v_mfma_f32_16x16x32_bf16 v[172:175], v[48:51], v[4:7], 0
    ds_read_b64_tr_b16 v[78:79], v249 offset:11584
    v_mfma_f32_16x16x32_bf16 v[168:171], v[44:47], v[4:7], 0
    ds_read_b64_tr_b16 v[80:81], v249 offset:9312
    v_mfma_f32_16x16x32_bf16 v[164:167], v[40:43], v[4:7], 0
    ds_read_b64_tr_b16 v[82:83], v249 offset:11616
    v_mfma_f32_16x16x32_bf16 v[160:163], v[36:39], v[4:7], 0
    ds_read_b64_tr_b16 v[84:85], v249 offset:9344
    v_mfma_f32_16x16x32_bf16 v[156:159], v[32:35], v[4:7], 0
    ds_read_b64_tr_b16 v[86:87], v249 offset:11648
    v_mfma_f32_16x16x32_bf16 v[152:155], v[28:31], v[4:7], 0
    ds_read_b64_tr_b16 v[88:89], v249 offset:9376
    v_mfma_f32_16x16x32_bf16 v[148:151], v[24:27], v[4:7], 0
    ds_read_b64_tr_b16 v[90:91], v249 offset:11680
    v_mfma_f32_16x16x32_bf16 v[144:147], v[20:23], v[4:7], 0
    ds_read_b64_tr_b16 v[92:93], v249 offset:9408
    v_mfma_f32_16x16x32_bf16 v[140:143], v[16:19], v[4:7], 0
    ds_read_b64_tr_b16 v[94:95], v249 offset:11712
    v_mfma_f32_16x16x32_bf16 v[176:179], v[16:19], v[8:11], 0
    ds_read_b64_tr_b16 v[96:97], v249 offset:9440
    v_mfma_f32_16x16x32_bf16 v[180:183], v[20:23], v[8:11], 0
    ds_read_b64_tr_b16 v[98:99], v249 offset:11744
    v_mfma_f32_16x16x32_bf16 v[184:187], v[24:27], v[8:11], 0
    ds_read_b64_tr_b16 v[100:101], v249 offset:9472
    v_mfma_f32_16x16x32_bf16 v[188:191], v[28:31], v[8:11], 0
    ds_read_b64_tr_b16 v[102:103], v249 offset:11776
    v_mfma_f32_16x16x32_bf16 v[192:195], v[32:35], v[8:11], 0
    s_add_u32 s59, s59, 1
    v_mfma_f32_16x16x32_bf16 v[196:199], v[36:39], v[8:11], 0
    s_cmp_eq_u32 s59, 3
    v_mfma_f32_16x16x32_bf16 v[200:203], v[40:43], v[8:11], 0
    s_cselect_b32 s59, 0, s59
    v_mfma_f32_16x16x32_bf16 v[204:207], v[44:47], v[8:11], 0
    s_cselect_b32 s55, s56, s57
    v_mfma_f32_16x16x32_bf16 v[208:211], v[48:51], v[8:11], 0
    v_add_u32 v248, s55, v248
    v_mfma_f32_16x16x32_bf16 v[244:247], v[48:51], v[12:15], 0
    v_add_u32 v249, s55, v249
    v_mfma_f32_16x16x32_bf16 v[240:243], v[44:47], v[12:15], 0
    v_mfma_f32_16x16x32_bf16 v[236:239], v[40:43], v[12:15], 0
    v_mfma_f32_16x16x32_bf16 v[232:235], v[36:39], v[12:15], 0
    v_mfma_f32_16x16x32_bf16 v[228:231], v[32:35], v[12:15], 0
    v_mfma_f32_16x16x32_bf16 v[224:227], v[28:31], v[12:15], 0
    v_mfma_f32_16x16x32_bf16 v[220:223], v[24:27], v[12:15], 0
    v_mfma_f32_16x16x32_bf16 v[216:219], v[20:23], v[12:15], 0
    v_mfma_f32_16x16x32_bf16 v[212:215], v[16:19], v[12:15], 0
    s_waitcnt vmcnt(0) lgkmcnt(0)
parallel_sum__sliding_local_dilated__mixer_gmlp__prompt_kernel_top35:
    s_barrier
    v_mfma_f32_16x16x32_bf16 v[104:107], v[68:71], v[52:55], v[104:107]
    ds_read_b128 v[0:3], v248 offset:0
    v_mfma_f32_16x16x32_bf16 v[108:111], v[72:75], v[52:55], v[108:111]
    ds_read_b128 v[4:7], v248 offset:2048
    v_mfma_f32_16x16x32_bf16 v[112:115], v[76:79], v[52:55], v[112:115]
    ds_read_b128 v[8:11], v248 offset:4096
    v_mfma_f32_16x16x32_bf16 v[116:119], v[80:83], v[52:55], v[116:119]
    ds_read_b128 v[12:15], v248 offset:6144
    v_mfma_f32_16x16x32_bf16 v[120:123], v[84:87], v[52:55], v[120:123]
    ds_read_b64_tr_b16 v[16:17], v249 offset:0
    v_mfma_f32_16x16x32_bf16 v[124:127], v[88:91], v[52:55], v[124:127]
    ds_read_b64_tr_b16 v[18:19], v249 offset:2304
    v_mfma_f32_16x16x32_bf16 v[128:131], v[92:95], v[52:55], v[128:131]
    ds_read_b64_tr_b16 v[20:21], v249 offset:32
    v_mfma_f32_16x16x32_bf16 v[132:135], v[96:99], v[52:55], v[132:135]
    ds_read_b64_tr_b16 v[22:23], v249 offset:2336
    v_mfma_f32_16x16x32_bf16 v[136:139], v[100:103], v[52:55], v[136:139]
    ds_read_b64_tr_b16 v[24:25], v249 offset:64
    v_mfma_f32_16x16x32_bf16 v[172:175], v[100:103], v[56:59], v[172:175]
    ds_read_b64_tr_b16 v[26:27], v249 offset:2368
    v_mfma_f32_16x16x32_bf16 v[168:171], v[96:99], v[56:59], v[168:171]
    ds_read_b64_tr_b16 v[28:29], v249 offset:96
    v_mfma_f32_16x16x32_bf16 v[164:167], v[92:95], v[56:59], v[164:167]
    ds_read_b64_tr_b16 v[30:31], v249 offset:2400
    v_mfma_f32_16x16x32_bf16 v[160:163], v[88:91], v[56:59], v[160:163]
    ds_read_b64_tr_b16 v[32:33], v249 offset:128
    v_mfma_f32_16x16x32_bf16 v[156:159], v[84:87], v[56:59], v[156:159]
    ds_read_b64_tr_b16 v[34:35], v249 offset:2432
    v_mfma_f32_16x16x32_bf16 v[152:155], v[80:83], v[56:59], v[152:155]
    ds_read_b64_tr_b16 v[36:37], v249 offset:160
    v_mfma_f32_16x16x32_bf16 v[148:151], v[76:79], v[56:59], v[148:151]
    ds_read_b64_tr_b16 v[38:39], v249 offset:2464
    v_mfma_f32_16x16x32_bf16 v[144:147], v[72:75], v[56:59], v[144:147]
    ds_read_b64_tr_b16 v[40:41], v249 offset:192
    v_mfma_f32_16x16x32_bf16 v[140:143], v[68:71], v[56:59], v[140:143]
    ds_read_b64_tr_b16 v[42:43], v249 offset:2496
    v_mfma_f32_16x16x32_bf16 v[176:179], v[68:71], v[60:63], v[176:179]
    ds_read_b64_tr_b16 v[44:45], v249 offset:224
    v_mfma_f32_16x16x32_bf16 v[180:183], v[72:75], v[60:63], v[180:183]
    ds_read_b64_tr_b16 v[46:47], v249 offset:2528
    v_mfma_f32_16x16x32_bf16 v[184:187], v[76:79], v[60:63], v[184:187]
    ds_read_b64_tr_b16 v[48:49], v249 offset:256
    v_mfma_f32_16x16x32_bf16 v[188:191], v[80:83], v[60:63], v[188:191]
    ds_read_b64_tr_b16 v[50:51], v249 offset:2560
    v_mfma_f32_16x16x32_bf16 v[192:195], v[84:87], v[60:63], v[192:195]
    v_mfma_f32_16x16x32_bf16 v[196:199], v[88:91], v[60:63], v[196:199]
    v_mfma_f32_16x16x32_bf16 v[200:203], v[92:95], v[60:63], v[200:203]
    v_mfma_f32_16x16x32_bf16 v[204:207], v[96:99], v[60:63], v[204:207]
    v_mfma_f32_16x16x32_bf16 v[208:211], v[100:103], v[60:63], v[208:211]
    v_mfma_f32_16x16x32_bf16 v[244:247], v[100:103], v[64:67], v[244:247]
    v_mfma_f32_16x16x32_bf16 v[240:243], v[96:99], v[64:67], v[240:243]
    v_mfma_f32_16x16x32_bf16 v[236:239], v[92:95], v[64:67], v[236:239]
    v_mfma_f32_16x16x32_bf16 v[232:235], v[88:91], v[64:67], v[232:235]
    v_mfma_f32_16x16x32_bf16 v[228:231], v[84:87], v[64:67], v[228:231]
    v_mfma_f32_16x16x32_bf16 v[224:227], v[80:83], v[64:67], v[224:227]
    v_mfma_f32_16x16x32_bf16 v[220:223], v[76:79], v[64:67], v[220:223]
    v_mfma_f32_16x16x32_bf16 v[216:219], v[72:75], v[64:67], v[216:219]
    v_mfma_f32_16x16x32_bf16 v[212:215], v[68:71], v[64:67], v[212:215]
    s_waitcnt lgkmcnt(0)
    v_mfma_f32_16x16x32_bf16 v[104:107], v[16:19], v[0:3], v[104:107]
    ds_read_b128 v[52:55], v248 offset:1024
    v_mfma_f32_16x16x32_bf16 v[108:111], v[20:23], v[0:3], v[108:111]
    ds_read_b128 v[56:59], v248 offset:3072
    v_mfma_f32_16x16x32_bf16 v[112:115], v[24:27], v[0:3], v[112:115]
    ds_read_b128 v[60:63], v248 offset:5120
    v_mfma_f32_16x16x32_bf16 v[116:119], v[28:31], v[0:3], v[116:119]
    ds_read_b128 v[64:67], v248 offset:7168
    v_mfma_f32_16x16x32_bf16 v[120:123], v[32:35], v[0:3], v[120:123]
    ds_read_b64_tr_b16 v[68:69], v249 offset:9216
    v_mfma_f32_16x16x32_bf16 v[124:127], v[36:39], v[0:3], v[124:127]
    ds_read_b64_tr_b16 v[70:71], v249 offset:11520
    v_mfma_f32_16x16x32_bf16 v[128:131], v[40:43], v[0:3], v[128:131]
    ds_read_b64_tr_b16 v[72:73], v249 offset:9248
    v_mfma_f32_16x16x32_bf16 v[132:135], v[44:47], v[0:3], v[132:135]
    ds_read_b64_tr_b16 v[74:75], v249 offset:11552
    v_mfma_f32_16x16x32_bf16 v[136:139], v[48:51], v[0:3], v[136:139]
    ds_read_b64_tr_b16 v[76:77], v249 offset:9280
    v_mfma_f32_16x16x32_bf16 v[172:175], v[48:51], v[4:7], v[172:175]
    ds_read_b64_tr_b16 v[78:79], v249 offset:11584
    v_mfma_f32_16x16x32_bf16 v[168:171], v[44:47], v[4:7], v[168:171]
    ds_read_b64_tr_b16 v[80:81], v249 offset:9312
    v_mfma_f32_16x16x32_bf16 v[164:167], v[40:43], v[4:7], v[164:167]
    ds_read_b64_tr_b16 v[82:83], v249 offset:11616
    v_mfma_f32_16x16x32_bf16 v[160:163], v[36:39], v[4:7], v[160:163]
    ds_read_b64_tr_b16 v[84:85], v249 offset:9344
    v_mfma_f32_16x16x32_bf16 v[156:159], v[32:35], v[4:7], v[156:159]
    ds_read_b64_tr_b16 v[86:87], v249 offset:11648
    v_mfma_f32_16x16x32_bf16 v[152:155], v[28:31], v[4:7], v[152:155]
    ds_read_b64_tr_b16 v[88:89], v249 offset:9376
    v_mfma_f32_16x16x32_bf16 v[148:151], v[24:27], v[4:7], v[148:151]
    ds_read_b64_tr_b16 v[90:91], v249 offset:11680
    v_mfma_f32_16x16x32_bf16 v[144:147], v[20:23], v[4:7], v[144:147]
    ds_read_b64_tr_b16 v[92:93], v249 offset:9408
    v_mfma_f32_16x16x32_bf16 v[140:143], v[16:19], v[4:7], v[140:143]
    ds_read_b64_tr_b16 v[94:95], v249 offset:11712
    v_mfma_f32_16x16x32_bf16 v[176:179], v[16:19], v[8:11], v[176:179]
    ds_read_b64_tr_b16 v[96:97], v249 offset:9440
    v_mfma_f32_16x16x32_bf16 v[180:183], v[20:23], v[8:11], v[180:183]
    ds_read_b64_tr_b16 v[98:99], v249 offset:11744
    v_mfma_f32_16x16x32_bf16 v[184:187], v[24:27], v[8:11], v[184:187]
    ds_read_b64_tr_b16 v[100:101], v249 offset:9472
    v_mfma_f32_16x16x32_bf16 v[188:191], v[28:31], v[8:11], v[188:191]
    ds_read_b64_tr_b16 v[102:103], v249 offset:11776
    v_mfma_f32_16x16x32_bf16 v[192:195], v[32:35], v[8:11], v[192:195]
    s_add_u32 s59, s59, 1
    v_mfma_f32_16x16x32_bf16 v[196:199], v[36:39], v[8:11], v[196:199]
    s_cmp_eq_u32 s59, 3
    v_mfma_f32_16x16x32_bf16 v[200:203], v[40:43], v[8:11], v[200:203]
    s_cselect_b32 s59, 0, s59
    v_mfma_f32_16x16x32_bf16 v[204:207], v[44:47], v[8:11], v[204:207]
    s_cselect_b32 s55, s56, s57
    v_mfma_f32_16x16x32_bf16 v[208:211], v[48:51], v[8:11], v[208:211]
    v_add_u32 v248, s55, v248
    v_mfma_f32_16x16x32_bf16 v[244:247], v[48:51], v[12:15], v[244:247]
    v_add_u32 v249, s55, v249
    v_mfma_f32_16x16x32_bf16 v[240:243], v[44:47], v[12:15], v[240:243]
    s_sub_u32 s58, s58, 1
    v_mfma_f32_16x16x32_bf16 v[236:239], v[40:43], v[12:15], v[236:239]
    s_cmp_lg_u32 s58, 0
    v_mfma_f32_16x16x32_bf16 v[232:235], v[36:39], v[12:15], v[232:235]
    v_mfma_f32_16x16x32_bf16 v[228:231], v[32:35], v[12:15], v[228:231]
    v_mfma_f32_16x16x32_bf16 v[224:227], v[28:31], v[12:15], v[224:227]
    v_mfma_f32_16x16x32_bf16 v[220:223], v[24:27], v[12:15], v[220:223]
    v_mfma_f32_16x16x32_bf16 v[216:219], v[20:23], v[12:15], v[216:219]
    v_mfma_f32_16x16x32_bf16 v[212:215], v[16:19], v[12:15], v[212:215]
    s_waitcnt lgkmcnt(0)
    s_cbranch_scc1 parallel_sum__sliding_local_dilated__mixer_gmlp__prompt_kernel_top35
    v_mfma_f32_16x16x32_bf16 v[104:107], v[68:71], v[52:55], v[104:107]
    v_mfma_f32_16x16x32_bf16 v[108:111], v[72:75], v[52:55], v[108:111]
    v_mfma_f32_16x16x32_bf16 v[112:115], v[76:79], v[52:55], v[112:115]
    v_mfma_f32_16x16x32_bf16 v[116:119], v[80:83], v[52:55], v[116:119]
    v_mfma_f32_16x16x32_bf16 v[120:123], v[84:87], v[52:55], v[120:123]
    v_mfma_f32_16x16x32_bf16 v[124:127], v[88:91], v[52:55], v[124:127]
    v_mfma_f32_16x16x32_bf16 v[128:131], v[92:95], v[52:55], v[128:131]
    v_mfma_f32_16x16x32_bf16 v[132:135], v[96:99], v[52:55], v[132:135]
    v_mfma_f32_16x16x32_bf16 v[136:139], v[100:103], v[52:55], v[136:139]
    v_mfma_f32_16x16x32_bf16 v[172:175], v[100:103], v[56:59], v[172:175]
    v_mfma_f32_16x16x32_bf16 v[168:171], v[96:99], v[56:59], v[168:171]
    v_mfma_f32_16x16x32_bf16 v[164:167], v[92:95], v[56:59], v[164:167]
    v_mfma_f32_16x16x32_bf16 v[160:163], v[88:91], v[56:59], v[160:163]
    v_mfma_f32_16x16x32_bf16 v[156:159], v[84:87], v[56:59], v[156:159]
    v_mfma_f32_16x16x32_bf16 v[152:155], v[80:83], v[56:59], v[152:155]
    v_mfma_f32_16x16x32_bf16 v[148:151], v[76:79], v[56:59], v[148:151]
    v_mfma_f32_16x16x32_bf16 v[144:147], v[72:75], v[56:59], v[144:147]
    v_mfma_f32_16x16x32_bf16 v[140:143], v[68:71], v[56:59], v[140:143]
    v_mfma_f32_16x16x32_bf16 v[176:179], v[68:71], v[60:63], v[176:179]
    v_mfma_f32_16x16x32_bf16 v[180:183], v[72:75], v[60:63], v[180:183]
    v_mfma_f32_16x16x32_bf16 v[184:187], v[76:79], v[60:63], v[184:187]
    v_mfma_f32_16x16x32_bf16 v[188:191], v[80:83], v[60:63], v[188:191]
    v_mfma_f32_16x16x32_bf16 v[192:195], v[84:87], v[60:63], v[192:195]
    v_mfma_f32_16x16x32_bf16 v[196:199], v[88:91], v[60:63], v[196:199]
    v_mfma_f32_16x16x32_bf16 v[200:203], v[92:95], v[60:63], v[200:203]
    v_mfma_f32_16x16x32_bf16 v[204:207], v[96:99], v[60:63], v[204:207]
    v_mfma_f32_16x16x32_bf16 v[208:211], v[100:103], v[60:63], v[208:211]
    v_mfma_f32_16x16x32_bf16 v[244:247], v[100:103], v[64:67], v[244:247]
    v_mfma_f32_16x16x32_bf16 v[240:243], v[96:99], v[64:67], v[240:243]
    v_mfma_f32_16x16x32_bf16 v[236:239], v[92:95], v[64:67], v[236:239]
    v_mfma_f32_16x16x32_bf16 v[232:235], v[88:91], v[64:67], v[232:235]
    v_mfma_f32_16x16x32_bf16 v[228:231], v[84:87], v[64:67], v[228:231]
    v_mfma_f32_16x16x32_bf16 v[224:227], v[80:83], v[64:67], v[224:227]
    v_mfma_f32_16x16x32_bf16 v[220:223], v[76:79], v[64:67], v[220:223]
    v_mfma_f32_16x16x32_bf16 v[216:219], v[72:75], v[64:67], v[216:219]
    v_mfma_f32_16x16x32_bf16 v[212:215], v[68:71], v[64:67], v[212:215]
    v_mov_b32 v0, 0xc0135761
    v_mov_b32 v1, 0xc0135761
    v_mov_b32 v2, 0xbdd2d3e8
    v_mov_b32 v3, 0xbdd2d3e8
    v_mov_b32 v4, 1.0
    v_mov_b32 v5, 1.0
    s_lshl_b32 s46, s38, 4
    s_lshl_b32 s47, s40, 2
    s_add_u32 s46, s46, s47
    s_mul_i32 s46, s46, 92160
    s_bfe_u32 s47, s39, 0x10001
    s_lshl_b32 s47, s47, 2
    s_lshr_b32 s48, s39, 2
    s_add_u32 s47, s47, s48
    s_mul_i32 s47, s47, 9216
    s_add_u32 s46, s46, s47
    s_and_b32 s47, s39, 1
    s_lshl_b32 s48, s47, 9
    s_add_u32 s48, s48, s46
    s_add_u32 s48, s48, 26624
    s_lshl_b32 s47, s47, 12
    s_add_u32 s46, s46, s47
    s_add_u32 s46, s46, 18432
    v_pk_mul_f32 v[8:9], v[104:105], v[104:105]
    v_pk_mul_f32 v[10:11], v[106:107], v[106:107]
    v_pk_mul_f32 v[12:13], v[108:109], v[108:109]
    v_pk_mul_f32 v[14:15], v[110:111], v[110:111]
    v_pk_fma_f32 v[8:9], v[8:9], v[2:3], v[0:1]
    v_pk_fma_f32 v[10:11], v[10:11], v[2:3], v[0:1]
    v_pk_fma_f32 v[12:13], v[12:13], v[2:3], v[0:1]
    v_pk_fma_f32 v[14:15], v[14:15], v[2:3], v[0:1]
    v_pk_mul_f32 v[8:9], v[8:9], v[104:105]
    v_pk_mul_f32 v[10:11], v[10:11], v[106:107]
    v_pk_mul_f32 v[12:13], v[12:13], v[108:109]
    v_pk_mul_f32 v[14:15], v[14:15], v[110:111]
    v_exp_f32 v8, v8
    v_exp_f32 v9, v9
    v_exp_f32 v10, v10
    v_exp_f32 v11, v11
    v_exp_f32 v12, v12
    v_exp_f32 v13, v13
    v_exp_f32 v14, v14
    v_exp_f32 v15, v15
    v_pk_add_f32 v[8:9], v[8:9], v[4:5]
    v_pk_add_f32 v[10:11], v[10:11], v[4:5]
    v_pk_add_f32 v[12:13], v[12:13], v[4:5]
    v_pk_add_f32 v[14:15], v[14:15], v[4:5]
    v_rcp_f32 v8, v8
    v_rcp_f32 v9, v9
    v_rcp_f32 v10, v10
    v_rcp_f32 v11, v11
    v_rcp_f32 v12, v12
    v_rcp_f32 v13, v13
    v_rcp_f32 v14, v14
    v_rcp_f32 v15, v15
    v_pk_mul_f32 v[104:105], v[104:105], v[8:9]
    v_pk_mul_f32 v[106:107], v[106:107], v[10:11]
    v_pk_mul_f32 v[108:109], v[108:109], v[12:13]
    v_pk_mul_f32 v[110:111], v[110:111], v[14:15]
    v_cvt_pk_bf16_f32 v16, v104, v105
    v_cvt_pk_bf16_f32 v17, v106, v107
    v_cvt_pk_bf16_f32 v18, v108, v109
    v_cvt_pk_bf16_f32 v19, v110, v111
    buffer_store_dwordx4 v[16:19], v250, s[16:19], s46 offen offset:0 sc1
    v_pk_mul_f32 v[8:9], v[112:113], v[112:113]
    v_pk_mul_f32 v[10:11], v[114:115], v[114:115]
    v_pk_mul_f32 v[12:13], v[116:117], v[116:117]
    v_pk_mul_f32 v[14:15], v[118:119], v[118:119]
    v_pk_fma_f32 v[8:9], v[8:9], v[2:3], v[0:1]
    v_pk_fma_f32 v[10:11], v[10:11], v[2:3], v[0:1]
    v_pk_fma_f32 v[12:13], v[12:13], v[2:3], v[0:1]
    v_pk_fma_f32 v[14:15], v[14:15], v[2:3], v[0:1]
    v_pk_mul_f32 v[8:9], v[8:9], v[112:113]
    v_pk_mul_f32 v[10:11], v[10:11], v[114:115]
    v_pk_mul_f32 v[12:13], v[12:13], v[116:117]
    v_pk_mul_f32 v[14:15], v[14:15], v[118:119]
    v_exp_f32 v8, v8
    v_exp_f32 v9, v9
    v_exp_f32 v10, v10
    v_exp_f32 v11, v11
    v_exp_f32 v12, v12
    v_exp_f32 v13, v13
    v_exp_f32 v14, v14
    v_exp_f32 v15, v15
    v_pk_add_f32 v[8:9], v[8:9], v[4:5]
    v_pk_add_f32 v[10:11], v[10:11], v[4:5]
    v_pk_add_f32 v[12:13], v[12:13], v[4:5]
    v_pk_add_f32 v[14:15], v[14:15], v[4:5]
    v_rcp_f32 v8, v8
    v_rcp_f32 v9, v9
    v_rcp_f32 v10, v10
    v_rcp_f32 v11, v11
    v_rcp_f32 v12, v12
    v_rcp_f32 v13, v13
    v_rcp_f32 v14, v14
    v_rcp_f32 v15, v15
    v_pk_mul_f32 v[112:113], v[112:113], v[8:9]
    v_pk_mul_f32 v[114:115], v[114:115], v[10:11]
    v_pk_mul_f32 v[116:117], v[116:117], v[12:13]
    v_pk_mul_f32 v[118:119], v[118:119], v[14:15]
    v_cvt_pk_bf16_f32 v20, v112, v113
    v_cvt_pk_bf16_f32 v21, v114, v115
    v_cvt_pk_bf16_f32 v22, v116, v117
    v_cvt_pk_bf16_f32 v23, v118, v119
    buffer_store_dwordx4 v[20:23], v250, s[16:19], s46 offen offset:1024 sc1
    v_pk_mul_f32 v[8:9], v[120:121], v[120:121]
    v_pk_mul_f32 v[10:11], v[122:123], v[122:123]
    v_pk_mul_f32 v[12:13], v[124:125], v[124:125]
    v_pk_mul_f32 v[14:15], v[126:127], v[126:127]
    v_pk_fma_f32 v[8:9], v[8:9], v[2:3], v[0:1]
    v_pk_fma_f32 v[10:11], v[10:11], v[2:3], v[0:1]
    v_pk_fma_f32 v[12:13], v[12:13], v[2:3], v[0:1]
    v_pk_fma_f32 v[14:15], v[14:15], v[2:3], v[0:1]
    v_pk_mul_f32 v[8:9], v[8:9], v[120:121]
    v_pk_mul_f32 v[10:11], v[10:11], v[122:123]
    v_pk_mul_f32 v[12:13], v[12:13], v[124:125]
    v_pk_mul_f32 v[14:15], v[14:15], v[126:127]
    v_exp_f32 v8, v8
    v_exp_f32 v9, v9
    v_exp_f32 v10, v10
    v_exp_f32 v11, v11
    v_exp_f32 v12, v12
    v_exp_f32 v13, v13
    v_exp_f32 v14, v14
    v_exp_f32 v15, v15
    v_pk_add_f32 v[8:9], v[8:9], v[4:5]
    v_pk_add_f32 v[10:11], v[10:11], v[4:5]
    v_pk_add_f32 v[12:13], v[12:13], v[4:5]
    v_pk_add_f32 v[14:15], v[14:15], v[4:5]
    v_rcp_f32 v8, v8
    v_rcp_f32 v9, v9
    v_rcp_f32 v10, v10
    v_rcp_f32 v11, v11
    v_rcp_f32 v12, v12
    v_rcp_f32 v13, v13
    v_rcp_f32 v14, v14
    v_rcp_f32 v15, v15
    v_pk_mul_f32 v[120:121], v[120:121], v[8:9]
    v_pk_mul_f32 v[122:123], v[122:123], v[10:11]
    v_pk_mul_f32 v[124:125], v[124:125], v[12:13]
    v_pk_mul_f32 v[126:127], v[126:127], v[14:15]
    v_cvt_pk_bf16_f32 v16, v120, v121
    v_cvt_pk_bf16_f32 v17, v122, v123
    v_cvt_pk_bf16_f32 v18, v124, v125
    v_cvt_pk_bf16_f32 v19, v126, v127
    buffer_store_dwordx4 v[16:19], v250, s[16:19], s46 offen offset:2048 sc1
    v_pk_mul_f32 v[8:9], v[128:129], v[128:129]
    v_pk_mul_f32 v[10:11], v[130:131], v[130:131]
    v_pk_mul_f32 v[12:13], v[132:133], v[132:133]
    v_pk_mul_f32 v[14:15], v[134:135], v[134:135]
    v_pk_fma_f32 v[8:9], v[8:9], v[2:3], v[0:1]
    v_pk_fma_f32 v[10:11], v[10:11], v[2:3], v[0:1]
    v_pk_fma_f32 v[12:13], v[12:13], v[2:3], v[0:1]
    v_pk_fma_f32 v[14:15], v[14:15], v[2:3], v[0:1]
    v_pk_mul_f32 v[8:9], v[8:9], v[128:129]
    v_pk_mul_f32 v[10:11], v[10:11], v[130:131]
    v_pk_mul_f32 v[12:13], v[12:13], v[132:133]
    v_pk_mul_f32 v[14:15], v[14:15], v[134:135]
    v_exp_f32 v8, v8
    v_exp_f32 v9, v9
    v_exp_f32 v10, v10
    v_exp_f32 v11, v11
    v_exp_f32 v12, v12
    v_exp_f32 v13, v13
    v_exp_f32 v14, v14
    v_exp_f32 v15, v15
    v_pk_add_f32 v[8:9], v[8:9], v[4:5]
    v_pk_add_f32 v[10:11], v[10:11], v[4:5]
    v_pk_add_f32 v[12:13], v[12:13], v[4:5]
    v_pk_add_f32 v[14:15], v[14:15], v[4:5]
    v_rcp_f32 v8, v8
    v_rcp_f32 v9, v9
    v_rcp_f32 v10, v10
    v_rcp_f32 v11, v11
    v_rcp_f32 v12, v12
    v_rcp_f32 v13, v13
    v_rcp_f32 v14, v14
    v_rcp_f32 v15, v15
    v_pk_mul_f32 v[128:129], v[128:129], v[8:9]
    v_pk_mul_f32 v[130:131], v[130:131], v[10:11]
    v_pk_mul_f32 v[132:133], v[132:133], v[12:13]
    v_pk_mul_f32 v[134:135], v[134:135], v[14:15]
    v_cvt_pk_bf16_f32 v20, v128, v129
    v_cvt_pk_bf16_f32 v21, v130, v131
    v_cvt_pk_bf16_f32 v22, v132, v133
    v_cvt_pk_bf16_f32 v23, v134, v135
    buffer_store_dwordx4 v[20:23], v250, s[16:19], s46 offen offset:3072 sc1
    s_add_u32 s46, s46, 92160
    s_add_u32 s49, s48, 92160
    v_pk_mul_f32 v[8:9], v[140:141], v[140:141]
    v_pk_mul_f32 v[10:11], v[142:143], v[142:143]
    v_pk_mul_f32 v[12:13], v[144:145], v[144:145]
    v_pk_mul_f32 v[14:15], v[146:147], v[146:147]
    v_pk_fma_f32 v[8:9], v[8:9], v[2:3], v[0:1]
    v_pk_fma_f32 v[10:11], v[10:11], v[2:3], v[0:1]
    v_pk_fma_f32 v[12:13], v[12:13], v[2:3], v[0:1]
    v_pk_fma_f32 v[14:15], v[14:15], v[2:3], v[0:1]
    v_pk_mul_f32 v[8:9], v[8:9], v[140:141]
    v_pk_mul_f32 v[10:11], v[10:11], v[142:143]
    v_pk_mul_f32 v[12:13], v[12:13], v[144:145]
    v_pk_mul_f32 v[14:15], v[14:15], v[146:147]
    v_exp_f32 v8, v8
    v_exp_f32 v9, v9
    v_exp_f32 v10, v10
    v_exp_f32 v11, v11
    v_exp_f32 v12, v12
    v_exp_f32 v13, v13
    v_exp_f32 v14, v14
    v_exp_f32 v15, v15
    v_pk_add_f32 v[8:9], v[8:9], v[4:5]
    v_pk_add_f32 v[10:11], v[10:11], v[4:5]
    v_pk_add_f32 v[12:13], v[12:13], v[4:5]
    v_pk_add_f32 v[14:15], v[14:15], v[4:5]
    v_rcp_f32 v8, v8
    v_rcp_f32 v9, v9
    v_rcp_f32 v10, v10
    v_rcp_f32 v11, v11
    v_rcp_f32 v12, v12
    v_rcp_f32 v13, v13
    v_rcp_f32 v14, v14
    v_rcp_f32 v15, v15
    v_pk_mul_f32 v[140:141], v[140:141], v[8:9]
    v_pk_mul_f32 v[142:143], v[142:143], v[10:11]
    v_pk_mul_f32 v[144:145], v[144:145], v[12:13]
    v_pk_mul_f32 v[146:147], v[146:147], v[14:15]
    v_cvt_pk_bf16_f32 v16, v140, v141
    v_cvt_pk_bf16_f32 v17, v142, v143
    v_cvt_pk_bf16_f32 v18, v144, v145
    v_cvt_pk_bf16_f32 v19, v146, v147
    buffer_store_dwordx4 v[16:19], v250, s[16:19], s46 offen offset:0 sc1
    v_pk_mul_f32 v[8:9], v[148:149], v[148:149]
    v_pk_mul_f32 v[10:11], v[150:151], v[150:151]
    v_pk_mul_f32 v[12:13], v[152:153], v[152:153]
    v_pk_mul_f32 v[14:15], v[154:155], v[154:155]
    v_pk_fma_f32 v[8:9], v[8:9], v[2:3], v[0:1]
    v_pk_fma_f32 v[10:11], v[10:11], v[2:3], v[0:1]
    v_pk_fma_f32 v[12:13], v[12:13], v[2:3], v[0:1]
    v_pk_fma_f32 v[14:15], v[14:15], v[2:3], v[0:1]
    v_pk_mul_f32 v[8:9], v[8:9], v[148:149]
    v_pk_mul_f32 v[10:11], v[10:11], v[150:151]
    v_pk_mul_f32 v[12:13], v[12:13], v[152:153]
    v_pk_mul_f32 v[14:15], v[14:15], v[154:155]
    v_exp_f32 v8, v8
    v_exp_f32 v9, v9
    v_exp_f32 v10, v10
    v_exp_f32 v11, v11
    v_exp_f32 v12, v12
    v_exp_f32 v13, v13
    v_exp_f32 v14, v14
    v_exp_f32 v15, v15
    v_pk_add_f32 v[8:9], v[8:9], v[4:5]
    v_pk_add_f32 v[10:11], v[10:11], v[4:5]
    v_pk_add_f32 v[12:13], v[12:13], v[4:5]
    v_pk_add_f32 v[14:15], v[14:15], v[4:5]
    v_rcp_f32 v8, v8
    v_rcp_f32 v9, v9
    v_rcp_f32 v10, v10
    v_rcp_f32 v11, v11
    v_rcp_f32 v12, v12
    v_rcp_f32 v13, v13
    v_rcp_f32 v14, v14
    v_rcp_f32 v15, v15
    v_pk_mul_f32 v[148:149], v[148:149], v[8:9]
    v_pk_mul_f32 v[150:151], v[150:151], v[10:11]
    v_pk_mul_f32 v[152:153], v[152:153], v[12:13]
    v_pk_mul_f32 v[154:155], v[154:155], v[14:15]
    v_cvt_pk_bf16_f32 v20, v148, v149
    v_cvt_pk_bf16_f32 v21, v150, v151
    v_cvt_pk_bf16_f32 v22, v152, v153
    v_cvt_pk_bf16_f32 v23, v154, v155
    buffer_store_dwordx4 v[20:23], v250, s[16:19], s46 offen offset:1024 sc1
    v_pk_mul_f32 v[8:9], v[156:157], v[156:157]
    v_pk_mul_f32 v[10:11], v[158:159], v[158:159]
    v_pk_mul_f32 v[12:13], v[160:161], v[160:161]
    v_pk_mul_f32 v[14:15], v[162:163], v[162:163]
    v_pk_fma_f32 v[8:9], v[8:9], v[2:3], v[0:1]
    v_pk_fma_f32 v[10:11], v[10:11], v[2:3], v[0:1]
    v_pk_fma_f32 v[12:13], v[12:13], v[2:3], v[0:1]
    v_pk_fma_f32 v[14:15], v[14:15], v[2:3], v[0:1]
    v_pk_mul_f32 v[8:9], v[8:9], v[156:157]
    v_pk_mul_f32 v[10:11], v[10:11], v[158:159]
    v_pk_mul_f32 v[12:13], v[12:13], v[160:161]
    v_pk_mul_f32 v[14:15], v[14:15], v[162:163]
    v_exp_f32 v8, v8
    v_exp_f32 v9, v9
    v_exp_f32 v10, v10
    v_exp_f32 v11, v11
    v_exp_f32 v12, v12
    v_exp_f32 v13, v13
    v_exp_f32 v14, v14
    v_exp_f32 v15, v15
    v_pk_add_f32 v[8:9], v[8:9], v[4:5]
    v_pk_add_f32 v[10:11], v[10:11], v[4:5]
    v_pk_add_f32 v[12:13], v[12:13], v[4:5]
    v_pk_add_f32 v[14:15], v[14:15], v[4:5]
    v_rcp_f32 v8, v8
    v_rcp_f32 v9, v9
    v_rcp_f32 v10, v10
    v_rcp_f32 v11, v11
    v_rcp_f32 v12, v12
    v_rcp_f32 v13, v13
    v_rcp_f32 v14, v14
    v_rcp_f32 v15, v15
    v_pk_mul_f32 v[156:157], v[156:157], v[8:9]
    v_pk_mul_f32 v[158:159], v[158:159], v[10:11]
    v_pk_mul_f32 v[160:161], v[160:161], v[12:13]
    v_pk_mul_f32 v[162:163], v[162:163], v[14:15]
    v_cvt_pk_bf16_f32 v16, v156, v157
    v_cvt_pk_bf16_f32 v17, v158, v159
    v_cvt_pk_bf16_f32 v18, v160, v161
    v_cvt_pk_bf16_f32 v19, v162, v163
    buffer_store_dwordx4 v[16:19], v250, s[16:19], s46 offen offset:2048 sc1
    v_pk_mul_f32 v[8:9], v[164:165], v[164:165]
    v_pk_mul_f32 v[10:11], v[166:167], v[166:167]
    v_pk_mul_f32 v[12:13], v[168:169], v[168:169]
    v_pk_mul_f32 v[14:15], v[170:171], v[170:171]
    v_pk_fma_f32 v[8:9], v[8:9], v[2:3], v[0:1]
    v_pk_fma_f32 v[10:11], v[10:11], v[2:3], v[0:1]
    v_pk_fma_f32 v[12:13], v[12:13], v[2:3], v[0:1]
    v_pk_fma_f32 v[14:15], v[14:15], v[2:3], v[0:1]
    v_pk_mul_f32 v[8:9], v[8:9], v[164:165]
    v_pk_mul_f32 v[10:11], v[10:11], v[166:167]
    v_pk_mul_f32 v[12:13], v[12:13], v[168:169]
    v_pk_mul_f32 v[14:15], v[14:15], v[170:171]
    v_exp_f32 v8, v8
    v_exp_f32 v9, v9
    v_exp_f32 v10, v10
    v_exp_f32 v11, v11
    v_exp_f32 v12, v12
    v_exp_f32 v13, v13
    v_exp_f32 v14, v14
    v_exp_f32 v15, v15
    v_pk_add_f32 v[8:9], v[8:9], v[4:5]
    v_pk_add_f32 v[10:11], v[10:11], v[4:5]
    v_pk_add_f32 v[12:13], v[12:13], v[4:5]
    v_pk_add_f32 v[14:15], v[14:15], v[4:5]
    v_rcp_f32 v8, v8
    v_rcp_f32 v9, v9
    v_rcp_f32 v10, v10
    v_rcp_f32 v11, v11
    v_rcp_f32 v12, v12
    v_rcp_f32 v13, v13
    v_rcp_f32 v14, v14
    v_rcp_f32 v15, v15
    v_pk_mul_f32 v[164:165], v[164:165], v[8:9]
    v_pk_mul_f32 v[166:167], v[166:167], v[10:11]
    v_pk_mul_f32 v[168:169], v[168:169], v[12:13]
    v_pk_mul_f32 v[170:171], v[170:171], v[14:15]
    v_cvt_pk_bf16_f32 v20, v164, v165
    v_cvt_pk_bf16_f32 v21, v166, v167
    v_cvt_pk_bf16_f32 v22, v168, v169
    v_cvt_pk_bf16_f32 v23, v170, v171
    buffer_store_dwordx4 v[20:23], v250, s[16:19], s46 offen offset:3072 sc1
    s_add_u32 s46, s46, 92160
    s_add_u32 s50, s49, 92160
    v_pk_mul_f32 v[8:9], v[176:177], v[176:177]
    v_pk_mul_f32 v[10:11], v[178:179], v[178:179]
    v_pk_mul_f32 v[12:13], v[180:181], v[180:181]
    v_pk_mul_f32 v[14:15], v[182:183], v[182:183]
    v_pk_fma_f32 v[8:9], v[8:9], v[2:3], v[0:1]
    v_pk_fma_f32 v[10:11], v[10:11], v[2:3], v[0:1]
    v_pk_fma_f32 v[12:13], v[12:13], v[2:3], v[0:1]
    v_pk_fma_f32 v[14:15], v[14:15], v[2:3], v[0:1]
    v_pk_mul_f32 v[8:9], v[8:9], v[176:177]
    v_pk_mul_f32 v[10:11], v[10:11], v[178:179]
    v_pk_mul_f32 v[12:13], v[12:13], v[180:181]
    v_pk_mul_f32 v[14:15], v[14:15], v[182:183]
    v_exp_f32 v8, v8
    v_exp_f32 v9, v9
    v_exp_f32 v10, v10
    v_exp_f32 v11, v11
    v_exp_f32 v12, v12
    v_exp_f32 v13, v13
    v_exp_f32 v14, v14
    v_exp_f32 v15, v15
    v_pk_add_f32 v[8:9], v[8:9], v[4:5]
    v_pk_add_f32 v[10:11], v[10:11], v[4:5]
    v_pk_add_f32 v[12:13], v[12:13], v[4:5]
    v_pk_add_f32 v[14:15], v[14:15], v[4:5]
    v_rcp_f32 v8, v8
    v_rcp_f32 v9, v9
    v_rcp_f32 v10, v10
    v_rcp_f32 v11, v11
    v_rcp_f32 v12, v12
    v_rcp_f32 v13, v13
    v_rcp_f32 v14, v14
    v_rcp_f32 v15, v15
    v_pk_mul_f32 v[176:177], v[176:177], v[8:9]
    v_pk_mul_f32 v[178:179], v[178:179], v[10:11]
    v_pk_mul_f32 v[180:181], v[180:181], v[12:13]
    v_pk_mul_f32 v[182:183], v[182:183], v[14:15]
    v_cvt_pk_bf16_f32 v16, v176, v177
    v_cvt_pk_bf16_f32 v17, v178, v179
    v_cvt_pk_bf16_f32 v18, v180, v181
    v_cvt_pk_bf16_f32 v19, v182, v183
    buffer_store_dwordx4 v[16:19], v250, s[16:19], s46 offen offset:0 sc1
    v_pk_mul_f32 v[8:9], v[184:185], v[184:185]
    v_pk_mul_f32 v[10:11], v[186:187], v[186:187]
    v_pk_mul_f32 v[12:13], v[188:189], v[188:189]
    v_pk_mul_f32 v[14:15], v[190:191], v[190:191]
    v_pk_fma_f32 v[8:9], v[8:9], v[2:3], v[0:1]
    v_pk_fma_f32 v[10:11], v[10:11], v[2:3], v[0:1]
    v_pk_fma_f32 v[12:13], v[12:13], v[2:3], v[0:1]
    v_pk_fma_f32 v[14:15], v[14:15], v[2:3], v[0:1]
    v_pk_mul_f32 v[8:9], v[8:9], v[184:185]
    v_pk_mul_f32 v[10:11], v[10:11], v[186:187]
    v_pk_mul_f32 v[12:13], v[12:13], v[188:189]
    v_pk_mul_f32 v[14:15], v[14:15], v[190:191]
    v_exp_f32 v8, v8
    v_exp_f32 v9, v9
    v_exp_f32 v10, v10
    v_exp_f32 v11, v11
    v_exp_f32 v12, v12
    v_exp_f32 v13, v13
    v_exp_f32 v14, v14
    v_exp_f32 v15, v15
    v_pk_add_f32 v[8:9], v[8:9], v[4:5]
    v_pk_add_f32 v[10:11], v[10:11], v[4:5]
    v_pk_add_f32 v[12:13], v[12:13], v[4:5]
    v_pk_add_f32 v[14:15], v[14:15], v[4:5]
    v_rcp_f32 v8, v8
    v_rcp_f32 v9, v9
    v_rcp_f32 v10, v10
    v_rcp_f32 v11, v11
    v_rcp_f32 v12, v12
    v_rcp_f32 v13, v13
    v_rcp_f32 v14, v14
    v_rcp_f32 v15, v15
    v_pk_mul_f32 v[184:185], v[184:185], v[8:9]
    v_pk_mul_f32 v[186:187], v[186:187], v[10:11]
    v_pk_mul_f32 v[188:189], v[188:189], v[12:13]
    v_pk_mul_f32 v[190:191], v[190:191], v[14:15]
    v_cvt_pk_bf16_f32 v20, v184, v185
    v_cvt_pk_bf16_f32 v21, v186, v187
    v_cvt_pk_bf16_f32 v22, v188, v189
    v_cvt_pk_bf16_f32 v23, v190, v191
    buffer_store_dwordx4 v[20:23], v250, s[16:19], s46 offen offset:1024 sc1
    v_pk_mul_f32 v[8:9], v[192:193], v[192:193]
    v_pk_mul_f32 v[10:11], v[194:195], v[194:195]
    v_pk_mul_f32 v[12:13], v[196:197], v[196:197]
    v_pk_mul_f32 v[14:15], v[198:199], v[198:199]
    v_pk_fma_f32 v[8:9], v[8:9], v[2:3], v[0:1]
    v_pk_fma_f32 v[10:11], v[10:11], v[2:3], v[0:1]
    v_pk_fma_f32 v[12:13], v[12:13], v[2:3], v[0:1]
    v_pk_fma_f32 v[14:15], v[14:15], v[2:3], v[0:1]
    v_pk_mul_f32 v[8:9], v[8:9], v[192:193]
    v_pk_mul_f32 v[10:11], v[10:11], v[194:195]
    v_pk_mul_f32 v[12:13], v[12:13], v[196:197]
    v_pk_mul_f32 v[14:15], v[14:15], v[198:199]
    v_exp_f32 v8, v8
    v_exp_f32 v9, v9
    v_exp_f32 v10, v10
    v_exp_f32 v11, v11
    v_exp_f32 v12, v12
    v_exp_f32 v13, v13
    v_exp_f32 v14, v14
    v_exp_f32 v15, v15
    v_pk_add_f32 v[8:9], v[8:9], v[4:5]
    v_pk_add_f32 v[10:11], v[10:11], v[4:5]
    v_pk_add_f32 v[12:13], v[12:13], v[4:5]
    v_pk_add_f32 v[14:15], v[14:15], v[4:5]
    v_rcp_f32 v8, v8
    v_rcp_f32 v9, v9
    v_rcp_f32 v10, v10
    v_rcp_f32 v11, v11
    v_rcp_f32 v12, v12
    v_rcp_f32 v13, v13
    v_rcp_f32 v14, v14
    v_rcp_f32 v15, v15
    v_pk_mul_f32 v[192:193], v[192:193], v[8:9]
    v_pk_mul_f32 v[194:195], v[194:195], v[10:11]
    v_pk_mul_f32 v[196:197], v[196:197], v[12:13]
    v_pk_mul_f32 v[198:199], v[198:199], v[14:15]
    v_cvt_pk_bf16_f32 v16, v192, v193
    v_cvt_pk_bf16_f32 v17, v194, v195
    v_cvt_pk_bf16_f32 v18, v196, v197
    v_cvt_pk_bf16_f32 v19, v198, v199
    buffer_store_dwordx4 v[16:19], v250, s[16:19], s46 offen offset:2048 sc1
    v_pk_mul_f32 v[8:9], v[200:201], v[200:201]
    v_pk_mul_f32 v[10:11], v[202:203], v[202:203]
    v_pk_mul_f32 v[12:13], v[204:205], v[204:205]
    v_pk_mul_f32 v[14:15], v[206:207], v[206:207]
    v_pk_fma_f32 v[8:9], v[8:9], v[2:3], v[0:1]
    v_pk_fma_f32 v[10:11], v[10:11], v[2:3], v[0:1]
    v_pk_fma_f32 v[12:13], v[12:13], v[2:3], v[0:1]
    v_pk_fma_f32 v[14:15], v[14:15], v[2:3], v[0:1]
    v_pk_mul_f32 v[8:9], v[8:9], v[200:201]
    v_pk_mul_f32 v[10:11], v[10:11], v[202:203]
    v_pk_mul_f32 v[12:13], v[12:13], v[204:205]
    v_pk_mul_f32 v[14:15], v[14:15], v[206:207]
    v_exp_f32 v8, v8
    v_exp_f32 v9, v9
    v_exp_f32 v10, v10
    v_exp_f32 v11, v11
    v_exp_f32 v12, v12
    v_exp_f32 v13, v13
    v_exp_f32 v14, v14
    v_exp_f32 v15, v15
    v_pk_add_f32 v[8:9], v[8:9], v[4:5]
    v_pk_add_f32 v[10:11], v[10:11], v[4:5]
    v_pk_add_f32 v[12:13], v[12:13], v[4:5]
    v_pk_add_f32 v[14:15], v[14:15], v[4:5]
    v_rcp_f32 v8, v8
    v_rcp_f32 v9, v9
    v_rcp_f32 v10, v10
    v_rcp_f32 v11, v11
    v_rcp_f32 v12, v12
    v_rcp_f32 v13, v13
    v_rcp_f32 v14, v14
    v_rcp_f32 v15, v15
    v_pk_mul_f32 v[200:201], v[200:201], v[8:9]
    v_pk_mul_f32 v[202:203], v[202:203], v[10:11]
    v_pk_mul_f32 v[204:205], v[204:205], v[12:13]
    v_pk_mul_f32 v[206:207], v[206:207], v[14:15]
    v_cvt_pk_bf16_f32 v20, v200, v201
    v_cvt_pk_bf16_f32 v21, v202, v203
    v_cvt_pk_bf16_f32 v22, v204, v205
    v_cvt_pk_bf16_f32 v23, v206, v207
    buffer_store_dwordx4 v[20:23], v250, s[16:19], s46 offen offset:3072 sc1
    s_add_u32 s46, s46, 92160
    s_add_u32 s51, s50, 92160
    v_pk_mul_f32 v[8:9], v[212:213], v[212:213]
    v_pk_mul_f32 v[10:11], v[214:215], v[214:215]
    v_pk_mul_f32 v[12:13], v[216:217], v[216:217]
    v_pk_mul_f32 v[14:15], v[218:219], v[218:219]
    v_pk_fma_f32 v[8:9], v[8:9], v[2:3], v[0:1]
    v_pk_fma_f32 v[10:11], v[10:11], v[2:3], v[0:1]
    v_pk_fma_f32 v[12:13], v[12:13], v[2:3], v[0:1]
    v_pk_fma_f32 v[14:15], v[14:15], v[2:3], v[0:1]
    v_pk_mul_f32 v[8:9], v[8:9], v[212:213]
    v_pk_mul_f32 v[10:11], v[10:11], v[214:215]
    v_pk_mul_f32 v[12:13], v[12:13], v[216:217]
    v_pk_mul_f32 v[14:15], v[14:15], v[218:219]
    v_exp_f32 v8, v8
    v_exp_f32 v9, v9
    v_exp_f32 v10, v10
    v_exp_f32 v11, v11
    v_exp_f32 v12, v12
    v_exp_f32 v13, v13
    v_exp_f32 v14, v14
    v_exp_f32 v15, v15
    v_pk_add_f32 v[8:9], v[8:9], v[4:5]
    v_pk_add_f32 v[10:11], v[10:11], v[4:5]
    v_pk_add_f32 v[12:13], v[12:13], v[4:5]
    v_pk_add_f32 v[14:15], v[14:15], v[4:5]
    v_rcp_f32 v8, v8
    v_rcp_f32 v9, v9
    v_rcp_f32 v10, v10
    v_rcp_f32 v11, v11
    v_rcp_f32 v12, v12
    v_rcp_f32 v13, v13
    v_rcp_f32 v14, v14
    v_rcp_f32 v15, v15
    v_pk_mul_f32 v[212:213], v[212:213], v[8:9]
    v_pk_mul_f32 v[214:215], v[214:215], v[10:11]
    v_pk_mul_f32 v[216:217], v[216:217], v[12:13]
    v_pk_mul_f32 v[218:219], v[218:219], v[14:15]
    v_cvt_pk_bf16_f32 v16, v212, v213
    v_cvt_pk_bf16_f32 v17, v214, v215
    v_cvt_pk_bf16_f32 v18, v216, v217
    v_cvt_pk_bf16_f32 v19, v218, v219
    buffer_store_dwordx4 v[16:19], v250, s[16:19], s46 offen offset:0 sc1
    v_pk_mul_f32 v[8:9], v[220:221], v[220:221]
    v_pk_mul_f32 v[10:11], v[222:223], v[222:223]
    v_pk_mul_f32 v[12:13], v[224:225], v[224:225]
    v_pk_mul_f32 v[14:15], v[226:227], v[226:227]
    v_pk_fma_f32 v[8:9], v[8:9], v[2:3], v[0:1]
    v_pk_fma_f32 v[10:11], v[10:11], v[2:3], v[0:1]
    v_pk_fma_f32 v[12:13], v[12:13], v[2:3], v[0:1]
    v_pk_fma_f32 v[14:15], v[14:15], v[2:3], v[0:1]
    v_pk_mul_f32 v[8:9], v[8:9], v[220:221]
    v_pk_mul_f32 v[10:11], v[10:11], v[222:223]
    v_pk_mul_f32 v[12:13], v[12:13], v[224:225]
    v_pk_mul_f32 v[14:15], v[14:15], v[226:227]
    v_exp_f32 v8, v8
    v_exp_f32 v9, v9
    v_exp_f32 v10, v10
    v_exp_f32 v11, v11
    v_exp_f32 v12, v12
    v_exp_f32 v13, v13
    v_exp_f32 v14, v14
    v_exp_f32 v15, v15
    v_pk_add_f32 v[8:9], v[8:9], v[4:5]
    v_pk_add_f32 v[10:11], v[10:11], v[4:5]
    v_pk_add_f32 v[12:13], v[12:13], v[4:5]
    v_pk_add_f32 v[14:15], v[14:15], v[4:5]
    v_rcp_f32 v8, v8
    v_rcp_f32 v9, v9
    v_rcp_f32 v10, v10
    v_rcp_f32 v11, v11
    v_rcp_f32 v12, v12
    v_rcp_f32 v13, v13
    v_rcp_f32 v14, v14
    v_rcp_f32 v15, v15
    v_pk_mul_f32 v[220:221], v[220:221], v[8:9]
    v_pk_mul_f32 v[222:223], v[222:223], v[10:11]
    v_pk_mul_f32 v[224:225], v[224:225], v[12:13]
    v_pk_mul_f32 v[226:227], v[226:227], v[14:15]
    v_cvt_pk_bf16_f32 v20, v220, v221
    v_cvt_pk_bf16_f32 v21, v222, v223
    v_cvt_pk_bf16_f32 v22, v224, v225
    v_cvt_pk_bf16_f32 v23, v226, v227
    buffer_store_dwordx4 v[20:23], v250, s[16:19], s46 offen offset:1024 sc1
    v_pk_mul_f32 v[8:9], v[228:229], v[228:229]
    v_pk_mul_f32 v[10:11], v[230:231], v[230:231]
    v_pk_mul_f32 v[12:13], v[232:233], v[232:233]
    v_pk_mul_f32 v[14:15], v[234:235], v[234:235]
    v_pk_fma_f32 v[8:9], v[8:9], v[2:3], v[0:1]
    v_pk_fma_f32 v[10:11], v[10:11], v[2:3], v[0:1]
    v_pk_fma_f32 v[12:13], v[12:13], v[2:3], v[0:1]
    v_pk_fma_f32 v[14:15], v[14:15], v[2:3], v[0:1]
    v_pk_mul_f32 v[8:9], v[8:9], v[228:229]
    v_pk_mul_f32 v[10:11], v[10:11], v[230:231]
    v_pk_mul_f32 v[12:13], v[12:13], v[232:233]
    v_pk_mul_f32 v[14:15], v[14:15], v[234:235]
    v_exp_f32 v8, v8
    v_exp_f32 v9, v9
    v_exp_f32 v10, v10
    v_exp_f32 v11, v11
    v_exp_f32 v12, v12
    v_exp_f32 v13, v13
    v_exp_f32 v14, v14
    v_exp_f32 v15, v15
    v_pk_add_f32 v[8:9], v[8:9], v[4:5]
    v_pk_add_f32 v[10:11], v[10:11], v[4:5]
    v_pk_add_f32 v[12:13], v[12:13], v[4:5]
    v_pk_add_f32 v[14:15], v[14:15], v[4:5]
    v_rcp_f32 v8, v8
    v_rcp_f32 v9, v9
    v_rcp_f32 v10, v10
    v_rcp_f32 v11, v11
    v_rcp_f32 v12, v12
    v_rcp_f32 v13, v13
    v_rcp_f32 v14, v14
    v_rcp_f32 v15, v15
    v_pk_mul_f32 v[228:229], v[228:229], v[8:9]
    v_pk_mul_f32 v[230:231], v[230:231], v[10:11]
    v_pk_mul_f32 v[232:233], v[232:233], v[12:13]
    v_pk_mul_f32 v[234:235], v[234:235], v[14:15]
    v_cvt_pk_bf16_f32 v16, v228, v229
    v_cvt_pk_bf16_f32 v17, v230, v231
    v_cvt_pk_bf16_f32 v18, v232, v233
    v_cvt_pk_bf16_f32 v19, v234, v235
    buffer_store_dwordx4 v[16:19], v250, s[16:19], s46 offen offset:2048 sc1
    v_pk_mul_f32 v[8:9], v[236:237], v[236:237]
    v_pk_mul_f32 v[10:11], v[238:239], v[238:239]
    v_pk_mul_f32 v[12:13], v[240:241], v[240:241]
    v_pk_mul_f32 v[14:15], v[242:243], v[242:243]
    v_pk_fma_f32 v[8:9], v[8:9], v[2:3], v[0:1]
    v_pk_fma_f32 v[10:11], v[10:11], v[2:3], v[0:1]
    v_pk_fma_f32 v[12:13], v[12:13], v[2:3], v[0:1]
    v_pk_fma_f32 v[14:15], v[14:15], v[2:3], v[0:1]
    v_pk_mul_f32 v[8:9], v[8:9], v[236:237]
    v_pk_mul_f32 v[10:11], v[10:11], v[238:239]
    v_pk_mul_f32 v[12:13], v[12:13], v[240:241]
    v_pk_mul_f32 v[14:15], v[14:15], v[242:243]
    v_exp_f32 v8, v8
    v_exp_f32 v9, v9
    v_exp_f32 v10, v10
    v_exp_f32 v11, v11
    v_exp_f32 v12, v12
    v_exp_f32 v13, v13
    v_exp_f32 v14, v14
    v_exp_f32 v15, v15
    v_pk_add_f32 v[8:9], v[8:9], v[4:5]
    v_pk_add_f32 v[10:11], v[10:11], v[4:5]
    v_pk_add_f32 v[12:13], v[12:13], v[4:5]
    v_pk_add_f32 v[14:15], v[14:15], v[4:5]
    v_rcp_f32 v8, v8
    v_rcp_f32 v9, v9
    v_rcp_f32 v10, v10
    v_rcp_f32 v11, v11
    v_rcp_f32 v12, v12
    v_rcp_f32 v13, v13
    v_rcp_f32 v14, v14
    v_rcp_f32 v15, v15
    v_pk_mul_f32 v[236:237], v[236:237], v[8:9]
    v_pk_mul_f32 v[238:239], v[238:239], v[10:11]
    v_pk_mul_f32 v[240:241], v[240:241], v[12:13]
    v_pk_mul_f32 v[242:243], v[242:243], v[14:15]
    v_cvt_pk_bf16_f32 v20, v236, v237
    v_cvt_pk_bf16_f32 v21, v238, v239
    v_cvt_pk_bf16_f32 v22, v240, v241
    v_cvt_pk_bf16_f32 v23, v242, v243
    buffer_store_dwordx4 v[20:23], v250, s[16:19], s46 offen offset:3072 sc1
    v_pk_mul_f32 v[8:9], v[136:137], v[136:137]
    v_pk_mul_f32 v[10:11], v[138:139], v[138:139]
    v_pk_mul_f32 v[12:13], v[172:173], v[172:173]
    v_pk_mul_f32 v[14:15], v[174:175], v[174:175]
    v_pk_fma_f32 v[8:9], v[8:9], v[2:3], v[0:1]
    v_pk_fma_f32 v[10:11], v[10:11], v[2:3], v[0:1]
    v_pk_fma_f32 v[12:13], v[12:13], v[2:3], v[0:1]
    v_pk_fma_f32 v[14:15], v[14:15], v[2:3], v[0:1]
    v_pk_mul_f32 v[8:9], v[8:9], v[136:137]
    v_pk_mul_f32 v[10:11], v[10:11], v[138:139]
    v_pk_mul_f32 v[12:13], v[12:13], v[172:173]
    v_pk_mul_f32 v[14:15], v[14:15], v[174:175]
    v_exp_f32 v8, v8
    v_exp_f32 v9, v9
    v_exp_f32 v10, v10
    v_exp_f32 v11, v11
    v_exp_f32 v12, v12
    v_exp_f32 v13, v13
    v_exp_f32 v14, v14
    v_exp_f32 v15, v15
    v_pk_add_f32 v[8:9], v[8:9], v[4:5]
    v_pk_add_f32 v[10:11], v[10:11], v[4:5]
    v_pk_add_f32 v[12:13], v[12:13], v[4:5]
    v_pk_add_f32 v[14:15], v[14:15], v[4:5]
    v_rcp_f32 v8, v8
    v_rcp_f32 v9, v9
    v_rcp_f32 v10, v10
    v_rcp_f32 v11, v11
    v_rcp_f32 v12, v12
    v_rcp_f32 v13, v13
    v_rcp_f32 v14, v14
    v_rcp_f32 v15, v15
    v_pk_mul_f32 v[136:137], v[136:137], v[8:9]
    v_pk_mul_f32 v[138:139], v[138:139], v[10:11]
    v_pk_mul_f32 v[172:173], v[172:173], v[12:13]
    v_pk_mul_f32 v[174:175], v[174:175], v[14:15]
    v_cvt_pk_bf16_f32 v16, v136, v137
    v_cvt_pk_bf16_f32 v17, v138, v139
    v_cvt_pk_bf16_f32 v18, v172, v173
    v_cvt_pk_bf16_f32 v19, v174, v175
    buffer_store_dwordx2 v[16:17], v251, s[16:19], s48 offen sc1
    buffer_store_dwordx2 v[18:19], v251, s[16:19], s49 offen sc1
    v_pk_mul_f32 v[8:9], v[208:209], v[208:209]
    v_pk_mul_f32 v[10:11], v[210:211], v[210:211]
    v_pk_mul_f32 v[12:13], v[244:245], v[244:245]
    v_pk_mul_f32 v[14:15], v[246:247], v[246:247]
    v_pk_fma_f32 v[8:9], v[8:9], v[2:3], v[0:1]
    v_pk_fma_f32 v[10:11], v[10:11], v[2:3], v[0:1]
    v_pk_fma_f32 v[12:13], v[12:13], v[2:3], v[0:1]
    v_pk_fma_f32 v[14:15], v[14:15], v[2:3], v[0:1]
    v_pk_mul_f32 v[8:9], v[8:9], v[208:209]
    v_pk_mul_f32 v[10:11], v[10:11], v[210:211]
    v_pk_mul_f32 v[12:13], v[12:13], v[244:245]
    v_pk_mul_f32 v[14:15], v[14:15], v[246:247]
    v_exp_f32 v8, v8
    v_exp_f32 v9, v9
    v_exp_f32 v10, v10
    v_exp_f32 v11, v11
    v_exp_f32 v12, v12
    v_exp_f32 v13, v13
    v_exp_f32 v14, v14
    v_exp_f32 v15, v15
    v_pk_add_f32 v[8:9], v[8:9], v[4:5]
    v_pk_add_f32 v[10:11], v[10:11], v[4:5]
    v_pk_add_f32 v[12:13], v[12:13], v[4:5]
    v_pk_add_f32 v[14:15], v[14:15], v[4:5]
    v_rcp_f32 v8, v8
    v_rcp_f32 v9, v9
    v_rcp_f32 v10, v10
    v_rcp_f32 v11, v11
    v_rcp_f32 v12, v12
    v_rcp_f32 v13, v13
    v_rcp_f32 v14, v14
    v_rcp_f32 v15, v15
    v_pk_mul_f32 v[208:209], v[208:209], v[8:9]
    v_pk_mul_f32 v[210:211], v[210:211], v[10:11]
    v_pk_mul_f32 v[244:245], v[244:245], v[12:13]
    v_pk_mul_f32 v[246:247], v[246:247], v[14:15]
    v_cvt_pk_bf16_f32 v20, v208, v209
    v_cvt_pk_bf16_f32 v21, v210, v211
    v_cvt_pk_bf16_f32 v22, v244, v245
    v_cvt_pk_bf16_f32 v23, v246, v247
    buffer_store_dwordx2 v[20:21], v251, s[16:19], s50 offen sc1
    buffer_store_dwordx2 v[22:23], v251, s[16:19], s51 offen sc1
    s_branch parallel_sum__sliding_local_dilated__mixer_gmlp__prompt_kernel_g2C5
parallel_sum__sliding_local_dilated__mixer_gmlp__prompt_kernel_D2:
    s_setprio 3
    s_add_u32 s47, s41, 16384
    s_lshl_b32 s48, s40, 9
    s_add_u32 s48, s48, 32768
    s_mov_b32 s49, 102400
    s_add_u32 s72, s4, 0x1000000
    s_addc_u32 s73, s5, 0
    s_mov_b32 s74, 0x1f8000
    s_mov_b32 s75, 0x20000
    s_add_u32 s16, s4, 0x2300000
    s_addc_u32 s17, s5, 0
    s_mov_b32 s18, 0xb40000
    s_mov_b32 s19, 0x20000
    s_add_u32 s20, s4, 0x3400000
    s_addc_u32 s21, s5, 0
    s_mov_b32 s22, 0x4000
    s_mov_b32 s23, 0x20000
    s_mov_b32 s24, s66
    s_mov_b32 s25, s67
    s_mov_b32 s26, 0x800000
    s_mov_b32 s27, 0x20000
    s_add_u32 s80, s4, 0x400000
    s_addc_u32 s81, s5, 0
    s_mov_b32 s82, 0x900000
    s_mov_b32 s83, 0x20000
    s_add_u32 s84, s4, 0x3450000
    s_addc_u32 s85, s5, 0
    s_mov_b32 s86, 0x24000
    s_mov_b32 s87, 0x20000
    s_cmp_lg_u32 s32, 0
    s_cbranch_scc1 parallel_sum__sliding_local_dilated__mixer_gmlp__prompt_kernel_dq36
    s_lshl_b32 s63, s40, 13
    s_lshl_b32 s60, s38, 15
    s_add_u32 s60, s60, s63
    s_mul_i32 s61, s39, 288
    s_add_u32 s88, s41, 32768
    s_lshl_b32 s89, s40, 9
    s_add_u32 s89, s89, 49152
    s_mov_b32 s62, 0
    s_branch parallel_sum__sliding_local_dilated__mixer_gmlp__prompt_kernel_dd37
parallel_sum__sliding_local_dilated__mixer_gmlp__prompt_kernel_dq36:
    s_lshl_b32 s60, s38, 14
    s_lshl_b32 s89, s40, 9
    s_sub_u32 s62, s60, 2048
    s_cmp_eq_u32 s38, 0
    s_cselect_b32 s62, 0, s62
    s_add_u32 s62, s62, s89
    s_add_u32 s60, s60, s41
    s_add_u32 s63, s41, 2048
    s_mul_i32 s61, s39, 258048
    s_mul_i32 s88, s40, 7168
    s_add_u32 s61, s61, s88
    s_add_u32 s88, s88, 18432
parallel_sum__sliding_local_dilated__mixer_gmlp__prompt_kernel_dd37:
    v_lshlrev_b32 v28, 7, v0
    s_lshl_b32 s44, s2, 2
    s_add_u32 s44, s44, s40
    s_lshl_b32 s44, s44, 13
    v_lshlrev_b32 v29, 2, v0
    v_lshrrev_b32 v30, 4, v0
    v_lshlrev_b32 v30, 5, v30
    s_lshl_b32 s45, s36, 10
    s_lshl_b32 s50, s40, 8
    s_add_u32 s45, s45, s50
    s_mul_i32 s50, s40, 9216
    s_add_u32 s50, s50, 102400
    v_add_u32 v31, s50, v1
    s_lshl_b32 s46, s36, 1
    s_lshr_b32 s50, s40, 1
    s_add_u32 s46, s46, s50
    s_mul_i32 s46, s46, 144
    s_mul_i32 s50, s37, 9
    s_add_u32 s46, s46, s50
    s_lshl_b32 s46, s46, 11
    s_and_b32 s50, s40, 1
    s_lshl_b32 s50, s50, 10
    s_add_u32 s46, s46, s50
    s_lshl_b32 s53, s36, 11
    s_add_u32 s53, s53, 32768
    v_lshrrev_b32 v26, 2, v0
    v_lshlrev_b32 v26, 7, v26
    v_and_b32 v2, 3, v0
    v_lshl_add_u32 v26, v2, 2, v26
    s_lshl_b32 s50, s40, 9
    s_add_u32 s50, s50, 139264
    v_add_u32 v35, s50, v29
    v_bfe_u32 v27, v0, 3, 1
    v_lshlrev_b32 v27, 5, v27
    v_lshrrev_b32 v2, 4, v0
    v_lshl_add_u32 v27, v2, 3, v27
    v_and_b32 v2, 7, v0
    v_add_lshl_u32 v27, v27, v2, 2
    s_lshl_b32 s55, s36, 10
    s_and_b32 s50, s40, 1
    s_lshl_b32 s50, s50, 9
    s_add_u32 s55, s55, s50
    s_waitcnt vmcnt(9) lgkmcnt(0)
    s_barrier
    s_load_dwordx2 s[56:57], s[0:1], 72
    s_waitcnt lgkmcnt(0)
    s_mov_b32 s28, s56
    s_mov_b32 s29, s57
    s_mov_b32 s30, 0x100
    s_mov_b32 s31, 0x20000
    v_mov_b32 v34, 0
    s_cmp_lg_u32 s40, 2
    s_cbranch_scc1 parallel_sum__sliding_local_dilated__mixer_gmlp__prompt_kernel_tg38
    buffer_load_dword v33, v34, s[28:31], 0 offen sc1
parallel_sum__sliding_local_dilated__mixer_gmlp__prompt_kernel_tg38:
    s_add_u32 m0, s41, s49
    s_nop 0
    buffer_load_dwordx4 v105, s[76:79], s42 offen lds
    s_add_u32 m0, m0, 1024
    s_add_u32 s50, s42, 9216
    buffer_load_dwordx4 v106, s[76:79], s50 offen lds
    s_add_u32 m0, m0, 1024
    s_add_u32 s50, s42, 18432
    buffer_load_dwordx4 v105, s[76:79], s50 offen lds
    s_add_u32 m0, m0, 1024
    s_add_u32 s50, s42, 27648
    buffer_load_dwordx4 v106, s[76:79], s50 offen lds
    s_add_u32 s42, s42, 128
    s_add_u32 m0, s47, s49
    s_nop 0
    buffer_load_dwordx4 v100, s[12:15], s43 offen lds
    s_add_u32 m0, m0, 1024
    s_nop 0
    buffer_load_dwordx4 v101, s[12:15], s43 offen lds
    s_add_u32 m0, m0, 1024
    s_nop 0
    buffer_load_dwordx4 v102, s[12:15], s43 offen lds
    s_add_u32 m0, m0, 1024
    s_nop 0
    buffer_load_dwordx4 v103, s[12:15], s43 offen lds
    s_add_u32 m0, s48, s49
    s_mov_b32 exec_hi, 0
    buffer_load_dwordx4 v104, s[12:15], s43 offen lds
    s_mov_b32 exec_hi, -1
    s_add_u32 s43, s43, 589824
    s_add_u32 s49, s49, 51200
    s_cmp_eq_u32 s49, 153600
    s_cselect_b32 s49, 0, s49
    s_waitcnt vmcnt(9)
    s_cmp_lg_u32 s40, 2
    s_cbranch_scc1 parallel_sum__sliding_local_dilated__mixer_gmlp__prompt_kernel_tg39
    v_cmp_eq_u32 vcc, 0, v33
    s_cbranch_vccz parallel_sum__sliding_local_dilated__mixer_gmlp__prompt_kernel_sd41
    s_mov_b32 s50, 0x20000
parallel_sum__sliding_local_dilated__mixer_gmlp__prompt_kernel_sp40:
    s_sleep 2
    buffer_load_dword v33, v34, s[28:31], 0 offen sc1
    s_waitcnt vmcnt(0)
    s_sub_u32 s50, s50, 1
    v_cmp_eq_u32 vcc, 0, v33
    s_cmp_eq_u32 s50, 0
    s_cselect_b64 vcc, 0, vcc
    s_cbranch_vccnz parallel_sum__sliding_local_dilated__mixer_gmlp__prompt_kernel_sp40
parallel_sum__sliding_local_dilated__mixer_gmlp__prompt_kernel_sd41:
    v_readfirstlane_b32 s101, v33
    v_mov_b32 v34, 163072
    ds_write_b32 v34, v33
    s_waitcnt lgkmcnt(0)
parallel_sum__sliding_local_dilated__mixer_gmlp__prompt_kernel_tg39:
    s_barrier
    s_add_u32 m0, s41, s49
    s_nop 0
    buffer_load_dwordx4 v105, s[76:79], s42 offen lds
    s_add_u32 m0, m0, 1024
    s_add_u32 s50, s42, 9216
    buffer_load_dwordx4 v106, s[76:79], s50 offen lds
    s_add_u32 m0, m0, 1024
    s_add_u32 s50, s42, 18432
    buffer_load_dwordx4 v105, s[76:79], s50 offen lds
    s_add_u32 m0, m0, 1024
    s_add_u32 s50, s42, 27648
    buffer_load_dwordx4 v106, s[76:79], s50 offen lds
    s_add_u32 s42, s42, 128
    s_add_u32 m0, s47, s49
    s_nop 0
    buffer_load_dwordx4 v100, s[12:15], s43 offen lds
    s_add_u32 m0, m0, 1024
    s_nop 0
    buffer_load_dwordx4 v101, s[12:15], s43 offen lds
    s_add_u32 m0, m0, 1024
    s_nop 0
    buffer_load_dwordx4 v102, s[12:15], s43 offen lds
    s_add_u32 m0, m0, 1024
    s_nop 0
    buffer_load_dwordx4 v103, s[12:15], s43 offen lds
    s_add_u32 m0, s48, s49
    s_mov_b32 exec_hi, 0
    buffer_load_dwordx4 v104, s[12:15], s43 offen lds
    s_mov_b32 exec_hi, -1
    s_add_u32 s43, s43, 589824
    s_add_u32 s49, s49, 51200
    s_cmp_eq_u32 s49, 153600
    s_cselect_b32 s49, 0, s49
    v_mov_b32 v33, 163072
    ds_read_b32 v33, v33
    s_waitcnt vmcnt(9) lgkmcnt(0)
    v_readfirstlane_b32 s101, v33
    s_barrier
    s_cmp_lg_u32 s40, 0
    s_cbranch_scc1 parallel_sum__sliding_local_dilated__mixer_gmlp__prompt_kernel_nb42
    v_mov_b32 v33, s101
    s_mov_b32 s51, 131072
    s_cmp_eq_u32 s32, 0
    s_cselect_b32 s51, s51, 16384
    s_lshl_b32 s50, s3, 7
    s_add_u32 s50, s50, s51
    s_mov_b32 exec_hi, 0
    buffer_store_dword v33, v29, s[84:87], s50 offen sc1
    s_mov_b32 exec_hi, -1
parallel_sum__sliding_local_dilated__mixer_gmlp__prompt_kernel_nb42:
    s_add_u32 m0, s41, s49
    s_nop 0
    buffer_load_dwordx4 v105, s[76:79], s42 offen lds
    s_add_u32 m0, m0, 1024
    s_add_u32 s50, s42, 9216
    buffer_load_dwordx4 v106, s[76:79], s50 offen lds
    s_add_u32 m0, m0, 1024
    s_add_u32 s50, s42, 18432
    buffer_load_dwordx4 v105, s[76:79], s50 offen lds
    s_add_u32 m0, m0, 1024
    s_add_u32 s50, s42, 27648
    buffer_load_dwordx4 v106, s[76:79], s50 offen lds
    s_add_u32 s42, s42, 128
    s_add_u32 m0, s47, s49
    s_nop 0
    buffer_load_dwordx4 v100, s[12:15], s43 offen lds
    s_add_u32 m0, m0, 1024
    s_nop 0
    buffer_load_dwordx4 v101, s[12:15], s43 offen lds
    s_add_u32 m0, m0, 1024
    s_nop 0
    buffer_load_dwordx4 v102, s[12:15], s43 offen lds
    s_add_u32 m0, m0, 1024
    s_nop 0
    buffer_load_dwordx4 v103, s[12:15], s43 offen lds
    s_add_u32 m0, s48, s49
    s_mov_b32 exec_hi, 0
    buffer_load_dwordx4 v104, s[12:15], s43 offen lds
    s_mov_b32 exec_hi, -1
    s_add_u32 s43, s43, 589824
    s_add_u32 s49, s49, 51200
    s_cmp_eq_u32 s49, 153600
    s_cselect_b32 s49, 0, s49
    s_mov_b32 s58, 3
parallel_sum__sliding_local_dilated__mixer_gmlp__prompt_kernel_pl43:
    s_waitcnt vmcnt(9)
    s_barrier
    s_add_u32 m0, s41, s49
    s_nop 0
    buffer_load_dwordx4 v105, s[76:79], s42 offen lds
    s_add_u32 m0, m0, 1024
    s_add_u32 s50, s42, 9216
    buffer_load_dwordx4 v106, s[76:79], s50 offen lds
    s_add_u32 m0, m0, 1024
    s_add_u32 s50, s42, 18432
    buffer_load_dwordx4 v105, s[76:79], s50 offen lds
    s_add_u32 m0, m0, 1024
    s_add_u32 s50, s42, 27648
    buffer_load_dwordx4 v106, s[76:79], s50 offen lds
    s_add_u32 s42, s42, 128
    s_add_u32 m0, s47, s49
    s_nop 0
    buffer_load_dwordx4 v100, s[12:15], s43 offen lds
    s_add_u32 m0, m0, 1024
    s_nop 0
    buffer_load_dwordx4 v101, s[12:15], s43 offen lds
    s_add_u32 m0, m0, 1024
    s_nop 0
    buffer_load_dwordx4 v102, s[12:15], s43 offen lds
    s_add_u32 m0, m0, 1024
    s_nop 0
    buffer_load_dwordx4 v103, s[12:15], s43 offen lds
    s_add_u32 m0, s48, s49
    s_mov_b32 exec_hi, 0
    buffer_load_dwordx4 v104, s[12:15], s43 offen lds
    s_mov_b32 exec_hi, -1
    s_add_u32 s43, s43, 589824
    s_add_u32 s49, s49, 51200
    s_cmp_eq_u32 s49, 153600
    s_cselect_b32 s49, 0, s49
    s_sub_u32 s58, s58, 1
    s_cmp_lg_u32 s58, 0
    s_cbranch_scc1 parallel_sum__sliding_local_dilated__mixer_gmlp__prompt_kernel_pl43
    s_lshl_b32 s54, s38, 3
    s_lshl_b32 s50, s38, 4
    s_cmp_eq_u32 s32, 0
    s_cselect_b32 s54, s50, s54
    s_max_u32 s54, s54, 1
    s_min_u32 s54, s54, 112
    s_lshl_b32 s54, s54, 7
    s_add_u32 s54, s54, 16256
    s_lshl_b32 s50, s36, 10
    s_add_u32 s50, s50, 14208
    v_cmp_gt_u32 vcc, 17, v0
    v_mov_b32 v24, s50
    v_mov_b32 v25, s54
    v_cndmask_b32 v24, v24, v25, vcc
    v_add_u32 v24, v24, v28
    v_subrev_u32 v25, 25, v0
    v_lshrrev_b32 v22, 1, v25
    v_lshlrev_b32 v22, 4, v22
    v_and_b32 v25, 1, v25
    v_sub_u32 v22, v22, v25
    s_lshl_b32 s50, s39, 1
    s_sub_u32 s50, 15, s50
    v_add_u32 v22, s50, v22
    v_lshlrev_b32 v22, 7, v22
    v_add_u32 v22, 131072, v22
    v_cmp_gt_u32 vcc, 25, v0
    s_cmp_eq_u32 s32, 0
    s_cselect_b32 s57, 0, 0x1ff
    s_cselect_b32 s56, 0x1ffffff, -1
    v_cndmask_b32 v24, v22, v24, vcc
    v_mov_b32 v33, s101
    s_cmp_lg_u32 s40, 1
    s_cbranch_scc1 parallel_sum__sliding_local_dilated__mixer_gmlp__prompt_kernel_ow44
    s_mov_b64 exec, s[56:57]
    buffer_load_dword v33, v24, s[84:87], 0 offen sc1
    s_mov_b64 exec, -1
parallel_sum__sliding_local_dilated__mixer_gmlp__prompt_kernel_ow44:
    s_mov_b32 s58, 1
parallel_sum__sliding_local_dilated__mixer_gmlp__prompt_kernel_pl45:
    s_waitcnt vmcnt(9)
    s_barrier
    s_add_u32 m0, s41, s49
    s_nop 0
    buffer_load_dwordx4 v105, s[76:79], s42 offen lds
    s_add_u32 m0, m0, 1024
    s_add_u32 s50, s42, 9216
    buffer_load_dwordx4 v106, s[76:79], s50 offen lds
    s_add_u32 m0, m0, 1024
    s_add_u32 s50, s42, 18432
    buffer_load_dwordx4 v105, s[76:79], s50 offen lds
    s_add_u32 m0, m0, 1024
    s_add_u32 s50, s42, 27648
    buffer_load_dwordx4 v106, s[76:79], s50 offen lds
    s_add_u32 s42, s42, 128
    s_add_u32 m0, s47, s49
    s_nop 0
    buffer_load_dwordx4 v100, s[12:15], s43 offen lds
    s_add_u32 m0, m0, 1024
    s_nop 0
    buffer_load_dwordx4 v101, s[12:15], s43 offen lds
    s_add_u32 m0, m0, 1024
    s_nop 0
    buffer_load_dwordx4 v102, s[12:15], s43 offen lds
    s_add_u32 m0, m0, 1024
    s_nop 0
    buffer_load_dwordx4 v103, s[12:15], s43 offen lds
    s_add_u32 m0, s48, s49
    s_mov_b32 exec_hi, 0
    buffer_load_dwordx4 v104, s[12:15], s43 offen lds
    s_mov_b32 exec_hi, -1
    s_add_u32 s43, s43, 589824
    s_add_u32 s49, s49, 51200
    s_cmp_eq_u32 s49, 153600
    s_cselect_b32 s49, 0, s49
    s_sub_u32 s58, s58, 1
    s_cmp_lg_u32 s58, 0
    s_cbranch_scc1 parallel_sum__sliding_local_dilated__mixer_gmlp__prompt_kernel_pl45
    s_waitcnt vmcnt(9)
    s_add_u32 s28, s4, 0x3440000
    s_addc_u32 s29, s5, 0
    s_mov_b32 s30, 0x4000
    s_mov_b32 s31, 0x20000
    s_cmp_lg_u32 s40, 1
    s_cbranch_scc1 parallel_sum__sliding_local_dilated__mixer_gmlp__prompt_kernel_ow46
    v_cmp_ne_u32 vcc, s101, v33
    s_cbranch_vccz parallel_sum__sliding_local_dilated__mixer_gmlp__prompt_kernel_sd48
    s_mov_b32 s50, 0x20000
parallel_sum__sliding_local_dilated__mixer_gmlp__prompt_kernel_sp47:
    s_sleep 2
    s_mov_b64 exec, s[56:57]
    buffer_load_dword v33, v24, s[84:87], 0 offen sc1
    s_mov_b64 exec, -1
    s_waitcnt vmcnt(0)
    s_sub_u32 s50, s50, 1
    v_cmp_ne_u32 vcc, s101, v33
    s_cmp_eq_u32 s50, 0
    s_cselect_b64 vcc, 0, vcc
    s_cbranch_vccnz parallel_sum__sliding_local_dilated__mixer_gmlp__prompt_kernel_sp47
parallel_sum__sliding_local_dilated__mixer_gmlp__prompt_kernel_sd48:
    s_lshl_b32 s50, s36, 10
    s_mov_b32 m0, 143360
    s_nop 0
    buffer_load_dwordx4 v1, s[28:31], s50 offen sc1 lds
parallel_sum__sliding_local_dilated__mixer_gmlp__prompt_kernel_ow46:
    s_barrier
    s_cmp_lg_u32 s32, 0
    s_cbranch_scc1 parallel_sum__sliding_local_dilated__mixer_gmlp__prompt_kernel_iq49
    s_add_u32 m0, s63, s49
    s_nop 0
    buffer_load_dwordx4 v1, s[8:11], s60 offen offset:0 sc1 lds
    buffer_load_dwordx4 v1, s[8:11], s60 offen offset:1024 sc1 lds
    buffer_load_dwordx4 v1, s[8:11], s60 offen offset:2048 sc1 lds
    buffer_load_dwordx4 v1, s[8:11], s60 offen offset:3072 sc1 lds
    s_add_u32 m0, m0, 4096
    s_add_u32 s50, s60, 4096
    buffer_load_dwordx4 v1, s[8:11], s50 offen offset:0 sc1 lds
    buffer_load_dwordx4 v1, s[8:11], s50 offen offset:1024 sc1 lds
    buffer_load_dwordx4 v1, s[8:11], s50 offen offset:2048 sc1 lds
    buffer_load_dwordx4 v1, s[8:11], s50 offen offset:3072 sc1 lds
    s_add_u32 m0, s88, s49
    s_nop 0
    buffer_load_dwordx4 v100, s[12:15], s61 offen lds
    s_add_u32 m0, m0, 1024
    s_nop 0
    buffer_load_dwordx4 v101, s[12:15], s61 offen lds
    s_add_u32 m0, m0, 1024
    s_nop 0
    buffer_load_dwordx4 v102, s[12:15], s61 offen lds
    s_add_u32 m0, m0, 1024
    s_nop 0
    buffer_load_dwordx4 v103, s[12:15], s61 offen lds
    s_add_u32 m0, s89, s49
    s_mov_b32 exec_hi, 0
    buffer_load_dwordx4 v104, s[12:15], s61 offen lds
    s_mov_b32 exec_hi, -1
    s_add_u32 s61, s61, 589824
    s_branch parallel_sum__sliding_local_dilated__mixer_gmlp__prompt_kernel_id50
parallel_sum__sliding_local_dilated__mixer_gmlp__prompt_kernel_iq49:
    s_add_u32 m0, s63, s49
    s_nop 0
    buffer_load_dwordx4 v1, s[8:11], s60 offen offset:0 sc1 lds
    buffer_load_dwordx4 v1, s[8:11], s60 offen offset:1024 sc1 lds
    buffer_load_dwordx4 v1, s[8:11], s60 offen offset:2048 sc1 lds
    buffer_load_dwordx4 v1, s[8:11], s60 offen offset:3072 sc1 lds
    s_add_u32 m0, s89, s49
    s_mov_b32 exec_hi, 0
    buffer_load_dwordx4 v1, s[8:11], s62 offen sc1 lds
    s_mov_b32 exec_hi, -1
    s_add_u32 m0, s88, s49
    s_nop 0
    buffer_load_dwordx4 v1, s[72:75], s61 offen offset:0 sc1 lds
    buffer_load_dwordx4 v1, s[72:75], s61 offen offset:1024 sc1 lds
    buffer_load_dwordx4 v1, s[72:75], s61 offen offset:2048 sc1 lds
    buffer_load_dwordx4 v1, s[72:75], s61 offen offset:3072 sc1 lds
    s_add_u32 m0, m0, 4096
    s_add_u32 s50, s61, 4096
    buffer_load_dwordx4 v1, s[72:75], s50 offen offset:0 sc1 lds
    buffer_load_dwordx4 v1, s[72:75], s50 offen offset:1024 sc1 lds
    buffer_load_dwordx4 v1, s[72:75], s50 offen offset:2048 sc1 lds
    s_add_u32 s62, s62, 262144
    s_add_u32 s61, s61, 28672
parallel_sum__sliding_local_dilated__mixer_gmlp__prompt_kernel_id50:
    s_add_u32 s60, s60, 262144
    s_add_u32 s49, s49, 51200
    s_cmp_eq_u32 s49, 153600
    s_cselect_b32 s49, 0, s49
    s_waitcnt vmcnt(12)
    s_barrier
    s_cmp_lg_u32 s32, 0
    s_cbranch_scc1 parallel_sum__sliding_local_dilated__mixer_gmlp__prompt_kernel_iq51
    s_add_u32 m0, s63, s49
    s_nop 0
    buffer_load_dwordx4 v1, s[8:11], s60 offen offset:0 sc1 lds
    buffer_load_dwordx4 v1, s[8:11], s60 offen offset:1024 sc1 lds
    buffer_load_dwordx4 v1, s[8:11], s60 offen offset:2048 sc1 lds
    buffer_load_dwordx4 v1, s[8:11], s60 offen offset:3072 sc1 lds
    s_add_u32 m0, m0, 4096
    s_add_u32 s50, s60, 4096
    buffer_load_dwordx4 v1, s[8:11], s50 offen offset:0 sc1 lds
    buffer_load_dwordx4 v1, s[8:11], s50 offen offset:1024 sc1 lds
    buffer_load_dwordx4 v1, s[8:11], s50 offen offset:2048 sc1 lds
    buffer_load_dwordx4 v1, s[8:11], s50 offen offset:3072 sc1 lds
    s_add_u32 m0, s88, s49
    s_nop 0
    buffer_load_dwordx4 v100, s[12:15], s61 offen lds
    s_add_u32 m0, m0, 1024
    s_nop 0
    buffer_load_dwordx4 v101, s[12:15], s61 offen lds
    s_add_u32 m0, m0, 1024
    s_nop 0
    buffer_load_dwordx4 v102, s[12:15], s61 offen lds
    s_add_u32 m0, m0, 1024
    s_nop 0
    buffer_load_dwordx4 v103, s[12:15], s61 offen lds
    s_add_u32 m0, s89, s49
    s_mov_b32 exec_hi, 0
    buffer_load_dwordx4 v104, s[12:15], s61 offen lds
    s_mov_b32 exec_hi, -1
    s_add_u32 s61, s61, 589824
    s_branch parallel_sum__sliding_local_dilated__mixer_gmlp__prompt_kernel_id52
parallel_sum__sliding_local_dilated__mixer_gmlp__prompt_kernel_iq51:
    s_add_u32 m0, s63, s49
    s_nop 0
    buffer_load_dwordx4 v1, s[8:11], s60 offen offset:0 sc1 lds
    buffer_load_dwordx4 v1, s[8:11], s60 offen offset:1024 sc1 lds
    buffer_load_dwordx4 v1, s[8:11], s60 offen offset:2048 sc1 lds
    buffer_load_dwordx4 v1, s[8:11], s60 offen offset:3072 sc1 lds
    s_add_u32 m0, s89, s49
    s_mov_b32 exec_hi, 0
    buffer_load_dwordx4 v1, s[8:11], s62 offen sc1 lds
    s_mov_b32 exec_hi, -1
    s_add_u32 m0, s88, s49
    s_nop 0
    buffer_load_dwordx4 v1, s[72:75], s61 offen offset:0 sc1 lds
    buffer_load_dwordx4 v1, s[72:75], s61 offen offset:1024 sc1 lds
    buffer_load_dwordx4 v1, s[72:75], s61 offen offset:2048 sc1 lds
    buffer_load_dwordx4 v1, s[72:75], s61 offen offset:3072 sc1 lds
    s_add_u32 m0, m0, 4096
    s_add_u32 s50, s61, 4096
    buffer_load_dwordx4 v1, s[72:75], s50 offen offset:0 sc1 lds
    buffer_load_dwordx4 v1, s[72:75], s50 offen offset:1024 sc1 lds
    buffer_load_dwordx4 v1, s[72:75], s50 offen offset:2048 sc1 lds
    s_add_u32 s62, s62, 262144
    s_add_u32 s61, s61, 28672
parallel_sum__sliding_local_dilated__mixer_gmlp__prompt_kernel_id52:
    s_add_u32 s60, s60, 262144
    s_add_u32 s49, s49, 51200
    s_cmp_eq_u32 s49, 153600
    s_cselect_b32 s49, 0, s49
    s_barrier
    buffer_load_dword v32, v28, s[24:27], s44 offen
    s_load_dwordx2 s[28:29], s[0:1], 16
    s_load_dwordx2 s[30:31], s[0:1], 56
    s_load_dwordx2 s[56:57], s[0:1], 48
    s_and_b32 s50, s34, 3
    s_lshl_b32 s50, s50, 3
    s_and_b32 s51, s35, 7
    s_add_u32 s50, s50, s51
    s_mul_i32 s50, s50, 73728
    s_lshr_b32 s51, s34, 2
    s_lshl_b32 s51, s51, 2
    s_lshr_b32 s54, s35, 3
    s_add_u32 s51, s51, s54
    s_mul_i32 s51, s51, 144
    s_add_u32 s54, s50, s51
    s_mov_b32 s76, s68
    s_mov_b32 s77, s69
    s_mov_b32 s78, 2359296
    s_mov_b32 s79, 0x20000
    s_lshl_b32 s51, s40, 6
    s_lshl_b32 s50, s40, 10
    s_add_u32 m0, s50, 153600
    v_add_u32 v2, s51, v0
    v_mul_u32_u24 v3, 3641, v2
    v_lshrrev_b32 v3, 15, v3
    v_mul_u32_u24 v3, 1008, v3
    v_lshl_add_u32 v2, v2, 4, v3
    buffer_load_dwordx4 v2, s[76:79], s54 offen lds
    s_add_u32 s51, s51, 256
    s_add_u32 m0, m0, 4096
    v_add_u32 v2, s51, v0
    v_mul_u32_u24 v3, 3641, v2
    v_lshrrev_b32 v3, 15, v3
    v_mul_u32_u24 v3, 1008, v3
    v_lshl_add_u32 v2, v2, 4, v3
    buffer_load_dwordx4 v2, s[76:79], s54 offen lds
    s_add_u32 s51, s51, 256
    s_add_u32 m0, m0, 4096
    s_cmp_lg_u32 s40, 0
    s_cbranch_scc1 parallel_sum__sliding_local_dilated__mixer_gmlp__prompt_kernel_xw53
    v_add_u32 v2, s51, v0
    v_mul_u32_u24 v3, 3641, v2
    v_lshrrev_b32 v3, 15, v3
    v_mul_u32_u24 v3, 1008, v3
    v_lshl_add_u32 v2, v2, 4, v3
    buffer_load_dwordx4 v2, s[76:79], s54 offen lds
    s_add_u32 s51, s51, 256
    s_add_u32 m0, m0, 4096
    s_waitcnt lgkmcnt(0)
    s_mov_b32 s76, s56
    s_mov_b32 s77, s57
    s_mov_b32 s78, 4096
    s_mov_b32 s79, 0x20000
    s_lshl_b32 s50, s36, 8
    s_mov_b32 m0, 162816
    s_mov_b64 exec, 0xffff
    buffer_load_dwordx4 v1, s[76:79], s50 offen lds
    s_mov_b64 exec, -1
parallel_sum__sliding_local_dilated__mixer_gmlp__prompt_kernel_xw53:
    s_lshr_b32 s50, s44, 13
    s_sub_u32 s51, s50, 81
    s_waitcnt lgkmcnt(0)
    s_cmp_lt_u32 s50, 81
    s_cselect_b32 s24, s28, s30
    s_cselect_b32 s25, s29, s31
    s_cselect_b32 s50, s50, s51
    s_mov_b32 s26, 2654208
    s_cselect_b32 s26, 663552, s26
    s_mov_b32 s27, 0x20000
    s_lshl_b32 s50, s50, 13
    buffer_load_dword v240, v28, s[24:27], s50 offen
    s_waitcnt vmcnt(16)
    s_barrier
    ds_read_b128 v[64:67], v31 offset:0
    ds_read_b128 v[68:71], v31 offset:1024
    ds_read_b128 v[72:75], v31 offset:2048
    ds_read_b128 v[76:79], v31 offset:3072
    ds_read_b128 v[80:83], v31 offset:4096
    ds_read_b128 v[84:87], v31 offset:5120
    ds_read_b128 v[88:91], v31 offset:6144
    ds_read_b128 v[92:95], v31 offset:7168
    ds_read_b128 v[96:99], v31 offset:8192
    ds_read_b32 v34, v35
    ds_read_b32 v33, v35 offset:256
    s_waitcnt lgkmcnt(0)
    s_barrier
    buffer_atomic_add_f32 v34, v27, s[20:23], s55 offen
    buffer_atomic_add_f32 v33, v27, s[20:23], s55 offen offset:256
    s_cmp_lg_u32 s32, 0
    s_cbranch_scc1 parallel_sum__sliding_local_dilated__mixer_gmlp__prompt_kernel_iq54
    s_add_u32 m0, s63, s49
    s_nop 0
    buffer_load_dwordx4 v1, s[8:11], s60 offen offset:0 sc1 lds
    buffer_load_dwordx4 v1, s[8:11], s60 offen offset:1024 sc1 lds
    buffer_load_dwordx4 v1, s[8:11], s60 offen offset:2048 sc1 lds
    buffer_load_dwordx4 v1, s[8:11], s60 offen offset:3072 sc1 lds
    s_add_u32 m0, m0, 4096
    s_add_u32 s50, s60, 4096
    buffer_load_dwordx4 v1, s[8:11], s50 offen offset:0 sc1 lds
    buffer_load_dwordx4 v1, s[8:11], s50 offen offset:1024 sc1 lds
    buffer_load_dwordx4 v1, s[8:11], s50 offen offset:2048 sc1 lds
    buffer_load_dwordx4 v1, s[8:11], s50 offen offset:3072 sc1 lds
    s_add_u32 m0, s88, s49
    s_nop 0
    buffer_load_dwordx4 v100, s[12:15], s61 offen lds
    s_add_u32 m0, m0, 1024
    s_nop 0
    buffer_load_dwordx4 v101, s[12:15], s61 offen lds
    s_add_u32 m0, m0, 1024
    s_nop 0
    buffer_load_dwordx4 v102, s[12:15], s61 offen lds
    s_add_u32 m0, m0, 1024
    s_nop 0
    buffer_load_dwordx4 v103, s[12:15], s61 offen lds
    s_add_u32 m0, s89, s49
    s_mov_b32 exec_hi, 0
    buffer_load_dwordx4 v104, s[12:15], s61 offen lds
    s_mov_b32 exec_hi, -1
    s_add_u32 s61, s61, 589824
    s_branch parallel_sum__sliding_local_dilated__mixer_gmlp__prompt_kernel_id55
parallel_sum__sliding_local_dilated__mixer_gmlp__prompt_kernel_iq54:
    s_add_u32 m0, s63, s49
    s_nop 0
    buffer_load_dwordx4 v1, s[8:11], s60 offen offset:0 sc1 lds
    buffer_load_dwordx4 v1, s[8:11], s60 offen offset:1024 sc1 lds
    buffer_load_dwordx4 v1, s[8:11], s60 offen offset:2048 sc1 lds
    buffer_load_dwordx4 v1, s[8:11], s60 offen offset:3072 sc1 lds
    s_add_u32 m0, s89, s49
    s_mov_b32 exec_hi, 0
    buffer_load_dwordx4 v1, s[8:11], s62 offen sc1 lds
    s_mov_b32 exec_hi, -1
    s_add_u32 m0, s88, s49
    s_nop 0
    buffer_load_dwordx4 v1, s[72:75], s61 offen offset:0 sc1 lds
    buffer_load_dwordx4 v1, s[72:75], s61 offen offset:1024 sc1 lds
    buffer_load_dwordx4 v1, s[72:75], s61 offen offset:2048 sc1 lds
    buffer_load_dwordx4 v1, s[72:75], s61 offen offset:3072 sc1 lds
    s_add_u32 m0, m0, 4096
    s_add_u32 s50, s61, 4096
    buffer_load_dwordx4 v1, s[72:75], s50 offen offset:0 sc1 lds
    buffer_load_dwordx4 v1, s[72:75], s50 offen offset:1024 sc1 lds
    buffer_load_dwordx4 v1, s[72:75], s50 offen offset:2048 sc1 lds
    s_add_u32 s62, s62, 262144
    s_add_u32 s61, s61, 28672
parallel_sum__sliding_local_dilated__mixer_gmlp__prompt_kernel_id55:
    s_add_u32 s60, s60, 262144
    s_add_u32 s49, s49, 51200
    s_cmp_eq_u32 s49, 153600
    s_cselect_b32 s49, 0, s49
    s_waitcnt vmcnt(18)
    s_barrier
    s_cmp_lg_u32 s32, 0
    s_cbranch_scc1 parallel_sum__sliding_local_dilated__mixer_gmlp__prompt_kernel_iq56
    s_add_u32 m0, s63, s49
    s_nop 0
    buffer_load_dwordx4 v1, s[8:11], s60 offen offset:0 sc1 lds
    buffer_load_dwordx4 v1, s[8:11], s60 offen offset:1024 sc1 lds
    buffer_load_dwordx4 v1, s[8:11], s60 offen offset:2048 sc1 lds
    buffer_load_dwordx4 v1, s[8:11], s60 offen offset:3072 sc1 lds
    s_add_u32 m0, m0, 4096
    s_add_u32 s50, s60, 4096
    buffer_load_dwordx4 v1, s[8:11], s50 offen offset:0 sc1 lds
    buffer_load_dwordx4 v1, s[8:11], s50 offen offset:1024 sc1 lds
    buffer_load_dwordx4 v1, s[8:11], s50 offen offset:2048 sc1 lds
    buffer_load_dwordx4 v1, s[8:11], s50 offen offset:3072 sc1 lds
    s_add_u32 m0, s88, s49
    s_nop 0
    buffer_load_dwordx4 v100, s[12:15], s61 offen lds
    s_add_u32 m0, m0, 1024
    s_nop 0
    buffer_load_dwordx4 v101, s[12:15], s61 offen lds
    s_add_u32 m0, m0, 1024
    s_nop 0
    buffer_load_dwordx4 v102, s[12:15], s61 offen lds
    s_add_u32 m0, m0, 1024
    s_nop 0
    buffer_load_dwordx4 v103, s[12:15], s61 offen lds
    s_add_u32 m0, s89, s49
    s_mov_b32 exec_hi, 0
    buffer_load_dwordx4 v104, s[12:15], s61 offen lds
    s_mov_b32 exec_hi, -1
    s_add_u32 s61, s61, 589824
    s_branch parallel_sum__sliding_local_dilated__mixer_gmlp__prompt_kernel_id57
parallel_sum__sliding_local_dilated__mixer_gmlp__prompt_kernel_iq56:
    s_add_u32 m0, s63, s49
    s_nop 0
    buffer_load_dwordx4 v1, s[8:11], s60 offen offset:0 sc1 lds
    buffer_load_dwordx4 v1, s[8:11], s60 offen offset:1024 sc1 lds
    buffer_load_dwordx4 v1, s[8:11], s60 offen offset:2048 sc1 lds
    buffer_load_dwordx4 v1, s[8:11], s60 offen offset:3072 sc1 lds
    s_add_u32 m0, s89, s49
    s_mov_b32 exec_hi, 0
    buffer_load_dwordx4 v1, s[8:11], s62 offen sc1 lds
    s_mov_b32 exec_hi, -1
    s_add_u32 m0, s88, s49
    s_nop 0
    buffer_load_dwordx4 v1, s[72:75], s61 offen offset:0 sc1 lds
    buffer_load_dwordx4 v1, s[72:75], s61 offen offset:1024 sc1 lds
    buffer_load_dwordx4 v1, s[72:75], s61 offen offset:2048 sc1 lds
    buffer_load_dwordx4 v1, s[72:75], s61 offen offset:3072 sc1 lds
    s_add_u32 m0, m0, 4096
    s_add_u32 s50, s61, 4096
    buffer_load_dwordx4 v1, s[72:75], s50 offen offset:0 sc1 lds
    buffer_load_dwordx4 v1, s[72:75], s50 offen offset:1024 sc1 lds
    buffer_load_dwordx4 v1, s[72:75], s50 offen offset:2048 sc1 lds
    s_add_u32 s62, s62, 262144
    s_add_u32 s61, s61, 28672
parallel_sum__sliding_local_dilated__mixer_gmlp__prompt_kernel_id57:
    s_add_u32 s60, s60, 262144
    s_add_u32 s49, s49, 51200
    s_cmp_eq_u32 s49, 153600
    s_cselect_b32 s49, 0, s49
    s_waitcnt vmcnt(12)
    s_lshl_b32 s50, s37, 7
    s_add_u32 s50, s50, s53
    s_lshl_b32 s51, s40, 2
    s_add_u32 s50, s50, s51
    v_mov_b32 v33, s101
    v_mov_b32 v34, 0
    s_mov_b64 exec, 1
    buffer_store_dword v33, v34, s[84:87], s50 offen sc1
    s_mov_b64 exec, -1
    s_barrier
    s_cmp_lg_u32 s32, 0
    s_cbranch_scc1 parallel_sum__sliding_local_dilated__mixer_gmlp__prompt_kernel_iq58
    s_add_u32 m0, s63, s49
    s_nop 0
    buffer_load_dwordx4 v1, s[8:11], s60 offen offset:0 sc1 lds
    buffer_load_dwordx4 v1, s[8:11], s60 offen offset:1024 sc1 lds
    buffer_load_dwordx4 v1, s[8:11], s60 offen offset:2048 sc1 lds
    buffer_load_dwordx4 v1, s[8:11], s60 offen offset:3072 sc1 lds
    s_add_u32 m0, m0, 4096
    s_add_u32 s50, s60, 4096
    buffer_load_dwordx4 v1, s[8:11], s50 offen offset:0 sc1 lds
    buffer_load_dwordx4 v1, s[8:11], s50 offen offset:1024 sc1 lds
    buffer_load_dwordx4 v1, s[8:11], s50 offen offset:2048 sc1 lds
    buffer_load_dwordx4 v1, s[8:11], s50 offen offset:3072 sc1 lds
    s_add_u32 m0, s88, s49
    s_nop 0
    buffer_load_dwordx4 v100, s[12:15], s61 offen lds
    s_add_u32 m0, m0, 1024
    s_nop 0
    buffer_load_dwordx4 v101, s[12:15], s61 offen lds
    s_add_u32 m0, m0, 1024
    s_nop 0
    buffer_load_dwordx4 v102, s[12:15], s61 offen lds
    s_add_u32 m0, m0, 1024
    s_nop 0
    buffer_load_dwordx4 v103, s[12:15], s61 offen lds
    s_add_u32 m0, s89, s49
    s_mov_b32 exec_hi, 0
    buffer_load_dwordx4 v104, s[12:15], s61 offen lds
    s_mov_b32 exec_hi, -1
    s_add_u32 s61, s61, 589824
    s_branch parallel_sum__sliding_local_dilated__mixer_gmlp__prompt_kernel_id59
parallel_sum__sliding_local_dilated__mixer_gmlp__prompt_kernel_iq58:
    s_add_u32 m0, s63, s49
    s_nop 0
    buffer_load_dwordx4 v1, s[8:11], s60 offen offset:0 sc1 lds
    buffer_load_dwordx4 v1, s[8:11], s60 offen offset:1024 sc1 lds
    buffer_load_dwordx4 v1, s[8:11], s60 offen offset:2048 sc1 lds
    buffer_load_dwordx4 v1, s[8:11], s60 offen offset:3072 sc1 lds
    s_add_u32 m0, s89, s49
    s_mov_b32 exec_hi, 0
    buffer_load_dwordx4 v1, s[8:11], s62 offen sc1 lds
    s_mov_b32 exec_hi, -1
    s_add_u32 m0, s88, s49
    s_nop 0
    buffer_load_dwordx4 v1, s[72:75], s61 offen offset:0 sc1 lds
    buffer_load_dwordx4 v1, s[72:75], s61 offen offset:1024 sc1 lds
    buffer_load_dwordx4 v1, s[72:75], s61 offen offset:2048 sc1 lds
    buffer_load_dwordx4 v1, s[72:75], s61 offen offset:3072 sc1 lds
    s_add_u32 m0, m0, 4096
    s_add_u32 s50, s61, 4096
    buffer_load_dwordx4 v1, s[72:75], s50 offen offset:0 sc1 lds
    buffer_load_dwordx4 v1, s[72:75], s50 offen offset:1024 sc1 lds
    buffer_load_dwordx4 v1, s[72:75], s50 offen offset:2048 sc1 lds
    s_add_u32 s62, s62, 262144
    s_add_u32 s61, s61, 28672
parallel_sum__sliding_local_dilated__mixer_gmlp__prompt_kernel_id59:
    s_add_u32 s60, s60, 262144
    s_add_u32 s49, s49, 51200
    s_cmp_eq_u32 s49, 153600
    s_cselect_b32 s49, 0, s49
    s_mov_b32 s58, 1
parallel_sum__sliding_local_dilated__mixer_gmlp__prompt_kernel_pl60:
    s_waitcnt vmcnt(12)
    s_barrier
    s_cmp_lg_u32 s32, 0
    s_cbranch_scc1 parallel_sum__sliding_local_dilated__mixer_gmlp__prompt_kernel_iq61
    s_add_u32 m0, s63, s49
    s_nop 0
    buffer_load_dwordx4 v1, s[8:11], s60 offen offset:0 sc1 lds
    buffer_load_dwordx4 v1, s[8:11], s60 offen offset:1024 sc1 lds
    buffer_load_dwordx4 v1, s[8:11], s60 offen offset:2048 sc1 lds
    buffer_load_dwordx4 v1, s[8:11], s60 offen offset:3072 sc1 lds
    s_add_u32 m0, m0, 4096
    s_add_u32 s50, s60, 4096
    buffer_load_dwordx4 v1, s[8:11], s50 offen offset:0 sc1 lds
    buffer_load_dwordx4 v1, s[8:11], s50 offen offset:1024 sc1 lds
    buffer_load_dwordx4 v1, s[8:11], s50 offen offset:2048 sc1 lds
    buffer_load_dwordx4 v1, s[8:11], s50 offen offset:3072 sc1 lds
    s_add_u32 m0, s88, s49
    s_nop 0
    buffer_load_dwordx4 v100, s[12:15], s61 offen lds
    s_add_u32 m0, m0, 1024
    s_nop 0
    buffer_load_dwordx4 v101, s[12:15], s61 offen lds
    s_add_u32 m0, m0, 1024
    s_nop 0
    buffer_load_dwordx4 v102, s[12:15], s61 offen lds
    s_add_u32 m0, m0, 1024
    s_nop 0
    buffer_load_dwordx4 v103, s[12:15], s61 offen lds
    s_add_u32 m0, s89, s49
    s_mov_b32 exec_hi, 0
    buffer_load_dwordx4 v104, s[12:15], s61 offen lds
    s_mov_b32 exec_hi, -1
    s_add_u32 s61, s61, 589824
    s_branch parallel_sum__sliding_local_dilated__mixer_gmlp__prompt_kernel_id62
parallel_sum__sliding_local_dilated__mixer_gmlp__prompt_kernel_iq61:
    s_add_u32 m0, s63, s49
    s_nop 0
    buffer_load_dwordx4 v1, s[8:11], s60 offen offset:0 sc1 lds
    buffer_load_dwordx4 v1, s[8:11], s60 offen offset:1024 sc1 lds
    buffer_load_dwordx4 v1, s[8:11], s60 offen offset:2048 sc1 lds
    buffer_load_dwordx4 v1, s[8:11], s60 offen offset:3072 sc1 lds
    s_add_u32 m0, s89, s49
    s_mov_b32 exec_hi, 0
    buffer_load_dwordx4 v1, s[8:11], s62 offen sc1 lds
    s_mov_b32 exec_hi, -1
    s_add_u32 m0, s88, s49
    s_nop 0
    buffer_load_dwordx4 v1, s[72:75], s61 offen offset:0 sc1 lds
    buffer_load_dwordx4 v1, s[72:75], s61 offen offset:1024 sc1 lds
    buffer_load_dwordx4 v1, s[72:75], s61 offen offset:2048 sc1 lds
    buffer_load_dwordx4 v1, s[72:75], s61 offen offset:3072 sc1 lds
    s_add_u32 m0, m0, 4096
    s_add_u32 s50, s61, 4096
    buffer_load_dwordx4 v1, s[72:75], s50 offen offset:0 sc1 lds
    buffer_load_dwordx4 v1, s[72:75], s50 offen offset:1024 sc1 lds
    buffer_load_dwordx4 v1, s[72:75], s50 offen offset:2048 sc1 lds
    s_add_u32 s62, s62, 262144
    s_add_u32 s61, s61, 28672
parallel_sum__sliding_local_dilated__mixer_gmlp__prompt_kernel_id62:
    s_add_u32 s60, s60, 262144
    s_add_u32 s49, s49, 51200
    s_cmp_eq_u32 s49, 153600
    s_cselect_b32 s49, 0, s49
    s_sub_u32 s58, s58, 1
    s_cmp_lg_u32 s58, 0
    s_cbranch_scc1 parallel_sum__sliding_local_dilated__mixer_gmlp__prompt_kernel_pl60
    buffer_load_dword v33, v26, s[84:87], s53 offen sc1
    s_waitcnt vmcnt(13)
    s_barrier
    s_cmp_lg_u32 s32, 0
    s_cbranch_scc1 parallel_sum__sliding_local_dilated__mixer_gmlp__prompt_kernel_iq63
    s_add_u32 m0, s63, s49
    s_nop 0
    buffer_load_dwordx4 v1, s[8:11], s60 offen offset:0 sc1 lds
    buffer_load_dwordx4 v1, s[8:11], s60 offen offset:1024 sc1 lds
    buffer_load_dwordx4 v1, s[8:11], s60 offen offset:2048 sc1 lds
    buffer_load_dwordx4 v1, s[8:11], s60 offen offset:3072 sc1 lds
    s_add_u32 m0, m0, 4096
    s_add_u32 s50, s60, 4096
    buffer_load_dwordx4 v1, s[8:11], s50 offen offset:0 sc1 lds
    buffer_load_dwordx4 v1, s[8:11], s50 offen offset:1024 sc1 lds
    buffer_load_dwordx4 v1, s[8:11], s50 offen offset:2048 sc1 lds
    buffer_load_dwordx4 v1, s[8:11], s50 offen offset:3072 sc1 lds
    s_add_u32 m0, s88, s49
    s_nop 0
    buffer_load_dwordx4 v100, s[12:15], s61 offen lds
    s_add_u32 m0, m0, 1024
    s_nop 0
    buffer_load_dwordx4 v101, s[12:15], s61 offen lds
    s_add_u32 m0, m0, 1024
    s_nop 0
    buffer_load_dwordx4 v102, s[12:15], s61 offen lds
    s_add_u32 m0, m0, 1024
    s_nop 0
    buffer_load_dwordx4 v103, s[12:15], s61 offen lds
    s_add_u32 m0, s89, s49
    s_mov_b32 exec_hi, 0
    buffer_load_dwordx4 v104, s[12:15], s61 offen lds
    s_mov_b32 exec_hi, -1
    s_add_u32 s61, s61, 589824
    s_branch parallel_sum__sliding_local_dilated__mixer_gmlp__prompt_kernel_id64
parallel_sum__sliding_local_dilated__mixer_gmlp__prompt_kernel_iq63:
    s_add_u32 m0, s63, s49
    s_nop 0
    buffer_load_dwordx4 v1, s[8:11], s60 offen offset:0 sc1 lds
    buffer_load_dwordx4 v1, s[8:11], s60 offen offset:1024 sc1 lds
    buffer_load_dwordx4 v1, s[8:11], s60 offen offset:2048 sc1 lds
    buffer_load_dwordx4 v1, s[8:11], s60 offen offset:3072 sc1 lds
    s_add_u32 m0, s89, s49
    s_mov_b32 exec_hi, 0
    buffer_load_dwordx4 v1, s[8:11], s62 offen sc1 lds
    s_mov_b32 exec_hi, -1
    s_add_u32 m0, s88, s49
    s_nop 0
    buffer_load_dwordx4 v1, s[72:75], s61 offen offset:0 sc1 lds
    buffer_load_dwordx4 v1, s[72:75], s61 offen offset:1024 sc1 lds
    buffer_load_dwordx4 v1, s[72:75], s61 offen offset:2048 sc1 lds
    buffer_load_dwordx4 v1, s[72:75], s61 offen offset:3072 sc1 lds
    s_add_u32 m0, m0, 4096
    s_add_u32 s50, s61, 4096
    buffer_load_dwordx4 v1, s[72:75], s50 offen offset:0 sc1 lds
    buffer_load_dwordx4 v1, s[72:75], s50 offen offset:1024 sc1 lds
    buffer_load_dwordx4 v1, s[72:75], s50 offen offset:2048 sc1 lds
    s_add_u32 s62, s62, 262144
    s_add_u32 s61, s61, 28672
parallel_sum__sliding_local_dilated__mixer_gmlp__prompt_kernel_id64:
    s_add_u32 s60, s60, 262144
    s_add_u32 s49, s49, 51200
    s_cmp_eq_u32 s49, 153600
    s_cselect_b32 s49, 0, s49
    s_waitcnt vmcnt(12)
    v_cmp_ne_u32 vcc, s101, v33
    s_cbranch_vccz parallel_sum__sliding_local_dilated__mixer_gmlp__prompt_kernel_sd66
    s_mov_b32 s50, 0x20000
parallel_sum__sliding_local_dilated__mixer_gmlp__prompt_kernel_sp65:
    s_sleep 2
    buffer_load_dword v33, v26, s[84:87], s53 offen sc1
    s_waitcnt vmcnt(0)
    s_sub_u32 s50, s50, 1
    v_cmp_ne_u32 vcc, s101, v33
    s_cmp_eq_u32 s50, 0
    s_cselect_b64 vcc, 0, vcc
    s_cbranch_vccnz parallel_sum__sliding_local_dilated__mixer_gmlp__prompt_kernel_sp65
parallel_sum__sliding_local_dilated__mixer_gmlp__prompt_kernel_sd66:
    buffer_load_dwordx4 v[36:39], v30, s[20:23], s45 offen offset:0 sc1
    buffer_load_dwordx4 v[40:43], v30, s[20:23], s45 offen offset:16 sc1
    buffer_load_dwordx4 v[44:47], v30, s[20:23], s45 offen offset:128 sc1
    buffer_load_dwordx4 v[48:51], v30, s[20:23], s45 offen offset:144 sc1
    s_barrier
    s_cmp_lg_u32 s32, 0
    s_cbranch_scc1 parallel_sum__sliding_local_dilated__mixer_gmlp__prompt_kernel_iq67
    s_add_u32 m0, s63, s49
    s_nop 0
    buffer_load_dwordx4 v1, s[8:11], s60 offen offset:0 sc1 lds
    buffer_load_dwordx4 v1, s[8:11], s60 offen offset:1024 sc1 lds
    buffer_load_dwordx4 v1, s[8:11], s60 offen offset:2048 sc1 lds
    buffer_load_dwordx4 v1, s[8:11], s60 offen offset:3072 sc1 lds
    s_add_u32 m0, m0, 4096
    s_add_u32 s50, s60, 4096
    buffer_load_dwordx4 v1, s[8:11], s50 offen offset:0 sc1 lds
    buffer_load_dwordx4 v1, s[8:11], s50 offen offset:1024 sc1 lds
    buffer_load_dwordx4 v1, s[8:11], s50 offen offset:2048 sc1 lds
    buffer_load_dwordx4 v1, s[8:11], s50 offen offset:3072 sc1 lds
    s_add_u32 m0, s88, s49
    s_nop 0
    buffer_load_dwordx4 v100, s[12:15], s61 offen lds
    s_add_u32 m0, m0, 1024
    s_nop 0
    buffer_load_dwordx4 v101, s[12:15], s61 offen lds
    s_add_u32 m0, m0, 1024
    s_nop 0
    buffer_load_dwordx4 v102, s[12:15], s61 offen lds
    s_add_u32 m0, m0, 1024
    s_nop 0
    buffer_load_dwordx4 v103, s[12:15], s61 offen lds
    s_add_u32 m0, s89, s49
    s_mov_b32 exec_hi, 0
    buffer_load_dwordx4 v104, s[12:15], s61 offen lds
    s_mov_b32 exec_hi, -1
    s_add_u32 s61, s61, 589824
    s_branch parallel_sum__sliding_local_dilated__mixer_gmlp__prompt_kernel_id68
parallel_sum__sliding_local_dilated__mixer_gmlp__prompt_kernel_iq67:
    s_add_u32 m0, s63, s49
    s_nop 0
    buffer_load_dwordx4 v1, s[8:11], s60 offen offset:0 sc1 lds
    buffer_load_dwordx4 v1, s[8:11], s60 offen offset:1024 sc1 lds
    buffer_load_dwordx4 v1, s[8:11], s60 offen offset:2048 sc1 lds
    buffer_load_dwordx4 v1, s[8:11], s60 offen offset:3072 sc1 lds
    s_add_u32 m0, s89, s49
    s_mov_b32 exec_hi, 0
    buffer_load_dwordx4 v1, s[8:11], s62 offen sc1 lds
    s_mov_b32 exec_hi, -1
    s_add_u32 m0, s88, s49
    s_nop 0
    buffer_load_dwordx4 v1, s[72:75], s61 offen offset:0 sc1 lds
    buffer_load_dwordx4 v1, s[72:75], s61 offen offset:1024 sc1 lds
    buffer_load_dwordx4 v1, s[72:75], s61 offen offset:2048 sc1 lds
    buffer_load_dwordx4 v1, s[72:75], s61 offen offset:3072 sc1 lds
    s_add_u32 m0, m0, 4096
    s_add_u32 s50, s61, 4096
    buffer_load_dwordx4 v1, s[72:75], s50 offen offset:0 sc1 lds
    buffer_load_dwordx4 v1, s[72:75], s50 offen offset:1024 sc1 lds
    buffer_load_dwordx4 v1, s[72:75], s50 offen offset:2048 sc1 lds
    s_add_u32 s62, s62, 262144
    s_add_u32 s61, s61, 28672
parallel_sum__sliding_local_dilated__mixer_gmlp__prompt_kernel_id68:
    s_add_u32 s60, s60, 262144
    s_add_u32 s49, s49, 51200
    s_cmp_eq_u32 s49, 153600
    s_cselect_b32 s49, 0, s49
    s_waitcnt vmcnt(12)
    v_mul_f32 v36, 0x39e38e39, v36
    v_mul_f32 v38, 0x39e38e39, v38
    v_mul_f32 v40, 0x39e38e39, v40
    v_mul_f32 v42, 0x39e38e39, v42
    v_mul_f32 v44, 0x39e38e39, v44
    v_mul_f32 v46, 0x39e38e39, v46
    v_mul_f32 v48, 0x39e38e39, v48
    v_mul_f32 v50, 0x39e38e39, v50
    v_mul_f32 v37, 0x39e38e39, v37
    v_mul_f32 v39, 0x39e38e39, v39
    v_mul_f32 v41, 0x39e38e39, v41
    v_mul_f32 v43, 0x39e38e39, v43
    v_mul_f32 v45, 0x39e38e39, v45
    v_mul_f32 v47, 0x39e38e39, v47
    v_mul_f32 v49, 0x39e38e39, v49
    v_mul_f32 v51, 0x39e38e39, v51
    v_fma_f32 v37, -v36, v36, v37
    v_fma_f32 v39, -v38, v38, v39
    v_fma_f32 v41, -v40, v40, v41
    v_fma_f32 v43, -v42, v42, v43
    v_fma_f32 v45, -v44, v44, v45
    v_fma_f32 v47, -v46, v46, v47
    v_fma_f32 v49, -v48, v48, v49
    v_fma_f32 v51, -v50, v50, v51
    v_max_f32 v37, 0, v37
    v_max_f32 v39, 0, v39
    v_max_f32 v41, 0, v41
    v_max_f32 v43, 0, v43
    v_max_f32 v45, 0, v45
    v_max_f32 v47, 0, v47
    v_max_f32 v49, 0, v49
    v_max_f32 v51, 0, v51
    v_cvt_pk_bf16_f32 v52, v36, v38
    v_cvt_pk_bf16_f32 v53, v40, v42
    v_cvt_pk_bf16_f32 v54, v44, v46
    v_cvt_pk_bf16_f32 v55, v48, v50
    v_lshlrev_b32 v36, 16, v52
    v_and_b32 v38, 0xffff0000, v52
    v_lshlrev_b32 v40, 16, v53
    v_and_b32 v42, 0xffff0000, v53
    v_lshlrev_b32 v44, 16, v54
    v_and_b32 v46, 0xffff0000, v54
    v_lshlrev_b32 v48, 16, v55
    v_and_b32 v50, 0xffff0000, v55
    v_cvt_pk_bf16_f32 v52, v37, v39
    v_cvt_pk_bf16_f32 v53, v41, v43
    v_cvt_pk_bf16_f32 v54, v45, v47
    v_cvt_pk_bf16_f32 v55, v49, v51
    v_lshlrev_b32 v37, 16, v52
    v_and_b32 v39, 0xffff0000, v52
    v_lshlrev_b32 v41, 16, v53
    v_and_b32 v43, 0xffff0000, v53
    v_lshlrev_b32 v45, 16, v54
    v_and_b32 v47, 0xffff0000, v54
    v_lshlrev_b32 v49, 16, v55
    v_and_b32 v51, 0xffff0000, v55
    v_add_f32 v37, 0x3727c5ac, v37
    v_add_f32 v39, 0x3727c5ac, v39
    v_add_f32 v41, 0x3727c5ac, v41
    v_add_f32 v43, 0x3727c5ac, v43
    v_add_f32 v45, 0x3727c5ac, v45
    v_add_f32 v47, 0x3727c5ac, v47
    v_add_f32 v49, 0x3727c5ac, v49
    v_add_f32 v51, 0x3727c5ac, v51
    v_cvt_pk_bf16_f32 v52, v37, v39
    v_cvt_pk_bf16_f32 v53, v41, v43
    v_cvt_pk_bf16_f32 v54, v45, v47
    v_cvt_pk_bf16_f32 v55, v49, v51
    v_lshlrev_b32 v37, 16, v52
    v_and_b32 v39, 0xffff0000, v52
    v_lshlrev_b32 v41, 16, v53
    v_and_b32 v43, 0xffff0000, v53
    v_lshlrev_b32 v45, 16, v54
    v_and_b32 v47, 0xffff0000, v54
    v_lshlrev_b32 v49, 16, v55
    v_and_b32 v51, 0xffff0000, v55
    v_sqrt_f32 v37, v37
    v_sqrt_f32 v39, v39
    v_sqrt_f32 v41, v41
    v_sqrt_f32 v43, v43
    v_sqrt_f32 v45, v45
    v_sqrt_f32 v47, v47
    v_sqrt_f32 v49, v49
    v_sqrt_f32 v51, v51
    v_cvt_pk_bf16_f32 v52, v37, v39
    v_cvt_pk_bf16_f32 v53, v41, v43
    v_cvt_pk_bf16_f32 v54, v45, v47
    v_cvt_pk_bf16_f32 v55, v49, v51
    v_lshlrev_b32 v37, 16, v52
    v_and_b32 v39, 0xffff0000, v52
    v_lshlrev_b32 v41, 16, v53
    v_and_b32 v43, 0xffff0000, v53
    v_lshlrev_b32 v45, 16, v54
    v_and_b32 v47, 0xffff0000, v54
    v_lshlrev_b32 v49, 16, v55
    v_and_b32 v51, 0xffff0000, v55
    v_rcp_f32 v37, v37
    v_rcp_f32 v39, v39
    v_rcp_f32 v41, v41
    v_rcp_f32 v43, v43
    v_rcp_f32 v45, v45
    v_rcp_f32 v47, v47
    v_rcp_f32 v49, v49
    v_rcp_f32 v51, v51
    v_mul_f32 v36, v36, v37
    v_mul_f32 v38, v38, v39
    v_mul_f32 v40, v40, v41
    v_mul_f32 v42, v42, v43
    v_mul_f32 v44, v44, v45
    v_mul_f32 v46, v46, v47
    v_mul_f32 v48, v48, v49
    v_mul_f32 v50, v50, v51
    v_lshlrev_b32 v56, 16, v64
    v_and_b32 v57, 0xffff0000, v64
    v_lshlrev_b32 v58, 16, v65
    v_and_b32 v59, 0xffff0000, v65
    v_lshlrev_b32 v60, 16, v66
    v_and_b32 v61, 0xffff0000, v66
    v_lshlrev_b32 v62, 16, v67
    v_and_b32 v63, 0xffff0000, v67
    v_fma_f32 v56, v56, v37, -v36
    v_fma_f32 v57, v57, v39, -v38
    v_fma_f32 v58, v58, v41, -v40
    v_fma_f32 v59, v59, v43, -v42
    v_fma_f32 v60, v60, v45, -v44
    v_fma_f32 v61, v61, v47, -v46
    v_fma_f32 v62, v62, v49, -v48
    v_fma_f32 v63, v63, v51, -v50
    v_cvt_pk_bf16_f32 v64, v56, v57
    v_cvt_pk_bf16_f32 v65, v58, v59
    v_cvt_pk_bf16_f32 v66, v60, v61
    v_cvt_pk_bf16_f32 v67, v62, v63
    s_nop 0
    v_permlane32_swap_b32 v64, v66
    v_permlane32_swap_b32 v65, v67
    s_nop 0
    v_permlane16_swap_b32 v64, v66
    v_permlane16_swap_b32 v65, v67
    buffer_store_dwordx4 v[64:67], v1, s[80:83], s46 offen offset:0 sc1
    v_lshlrev_b32 v56, 16, v68
    v_and_b32 v57, 0xffff0000, v68
    v_lshlrev_b32 v58, 16, v69
    v_and_b32 v59, 0xffff0000, v69
    v_lshlrev_b32 v60, 16, v70
    v_and_b32 v61, 0xffff0000, v70
    v_lshlrev_b32 v62, 16, v71
    v_and_b32 v63, 0xffff0000, v71
    v_fma_f32 v56, v56, v37, -v36
    v_fma_f32 v57, v57, v39, -v38
    v_fma_f32 v58, v58, v41, -v40
    v_fma_f32 v59, v59, v43, -v42
    v_fma_f32 v60, v60, v45, -v44
    v_fma_f32 v61, v61, v47, -v46
    v_fma_f32 v62, v62, v49, -v48
    v_fma_f32 v63, v63, v51, -v50
    v_cvt_pk_bf16_f32 v68, v56, v57
    v_cvt_pk_bf16_f32 v69, v58, v59
    v_cvt_pk_bf16_f32 v70, v60, v61
    v_cvt_pk_bf16_f32 v71, v62, v63
    s_nop 0
    v_permlane32_swap_b32 v68, v70
    v_permlane32_swap_b32 v69, v71
    s_nop 0
    v_permlane16_swap_b32 v68, v70
    v_permlane16_swap_b32 v69, v71
    buffer_store_dwordx4 v[68:71], v1, s[80:83], s46 offen offset:2048 sc1
    s_waitcnt vmcnt(18)
    s_barrier
    s_cmp_lg_u32 s32, 0
    s_cbranch_scc1 parallel_sum__sliding_local_dilated__mixer_gmlp__prompt_kernel_iq69
    s_add_u32 m0, s63, s49
    s_nop 0
    buffer_load_dwordx4 v1, s[8:11], s60 offen offset:0 sc1 lds
    buffer_load_dwordx4 v1, s[8:11], s60 offen offset:1024 sc1 lds
    buffer_load_dwordx4 v1, s[8:11], s60 offen offset:2048 sc1 lds
    buffer_load_dwordx4 v1, s[8:11], s60 offen offset:3072 sc1 lds
    s_add_u32 m0, m0, 4096
    s_add_u32 s50, s60, 4096
    buffer_load_dwordx4 v1, s[8:11], s50 offen offset:0 sc1 lds
    buffer_load_dwordx4 v1, s[8:11], s50 offen offset:1024 sc1 lds
    buffer_load_dwordx4 v1, s[8:11], s50 offen offset:2048 sc1 lds
    buffer_load_dwordx4 v1, s[8:11], s50 offen offset:3072 sc1 lds
    s_add_u32 m0, s88, s49
    s_nop 0
    buffer_load_dwordx4 v100, s[12:15], s61 offen lds
    s_add_u32 m0, m0, 1024
    s_nop 0
    buffer_load_dwordx4 v101, s[12:15], s61 offen lds
    s_add_u32 m0, m0, 1024
    s_nop 0
    buffer_load_dwordx4 v102, s[12:15], s61 offen lds
    s_add_u32 m0, m0, 1024
    s_nop 0
    buffer_load_dwordx4 v103, s[12:15], s61 offen lds
    s_add_u32 m0, s89, s49
    s_mov_b32 exec_hi, 0
    buffer_load_dwordx4 v104, s[12:15], s61 offen lds
    s_mov_b32 exec_hi, -1
    s_add_u32 s61, s61, 589824
    s_branch parallel_sum__sliding_local_dilated__mixer_gmlp__prompt_kernel_id70
parallel_sum__sliding_local_dilated__mixer_gmlp__prompt_kernel_iq69:
    s_add_u32 m0, s63, s49
    s_nop 0
    buffer_load_dwordx4 v1, s[8:11], s60 offen offset:0 sc1 lds
    buffer_load_dwordx4 v1, s[8:11], s60 offen offset:1024 sc1 lds
    buffer_load_dwordx4 v1, s[8:11], s60 offen offset:2048 sc1 lds
    buffer_load_dwordx4 v1, s[8:11], s60 offen offset:3072 sc1 lds
    s_add_u32 m0, s89, s49
    s_mov_b32 exec_hi, 0
    buffer_load_dwordx4 v1, s[8:11], s62 offen sc1 lds
    s_mov_b32 exec_hi, -1
    s_add_u32 m0, s88, s49
    s_nop 0
    buffer_load_dwordx4 v1, s[72:75], s61 offen offset:0 sc1 lds
    buffer_load_dwordx4 v1, s[72:75], s61 offen offset:1024 sc1 lds
    buffer_load_dwordx4 v1, s[72:75], s61 offen offset:2048 sc1 lds
    buffer_load_dwordx4 v1, s[72:75], s61 offen offset:3072 sc1 lds
    s_add_u32 m0, m0, 4096
    s_add_u32 s50, s61, 4096
    buffer_load_dwordx4 v1, s[72:75], s50 offen offset:0 sc1 lds
    buffer_load_dwordx4 v1, s[72:75], s50 offen offset:1024 sc1 lds
    buffer_load_dwordx4 v1, s[72:75], s50 offen offset:2048 sc1 lds
    s_add_u32 s62, s62, 262144
    s_add_u32 s61, s61, 28672
parallel_sum__sliding_local_dilated__mixer_gmlp__prompt_kernel_id70:
    s_add_u32 s60, s60, 262144
    s_add_u32 s49, s49, 51200
    s_cmp_eq_u32 s49, 153600
    s_cselect_b32 s49, 0, s49
    v_lshlrev_b32 v56, 16, v72
    v_and_b32 v57, 0xffff0000, v72
    v_lshlrev_b32 v58, 16, v73
    v_and_b32 v59, 0xffff0000, v73
    v_lshlrev_b32 v60, 16, v74
    v_and_b32 v61, 0xffff0000, v74
    v_lshlrev_b32 v62, 16, v75
    v_and_b32 v63, 0xffff0000, v75
    v_fma_f32 v56, v56, v37, -v36
    v_fma_f32 v57, v57, v39, -v38
    v_fma_f32 v58, v58, v41, -v40
    v_fma_f32 v59, v59, v43, -v42
    v_fma_f32 v60, v60, v45, -v44
    v_fma_f32 v61, v61, v47, -v46
    v_fma_f32 v62, v62, v49, -v48
    v_fma_f32 v63, v63, v51, -v50
    v_cvt_pk_bf16_f32 v72, v56, v57
    v_cvt_pk_bf16_f32 v73, v58, v59
    v_cvt_pk_bf16_f32 v74, v60, v61
    v_cvt_pk_bf16_f32 v75, v62, v63
    s_nop 0
    v_permlane32_swap_b32 v72, v74
    v_permlane32_swap_b32 v73, v75
    s_nop 0
    v_permlane16_swap_b32 v72, v74
    v_permlane16_swap_b32 v73, v75
    s_add_u32 s46, s46, 4096
    buffer_store_dwordx4 v[72:75], v1, s[80:83], s46 offen offset:0 sc1
    v_lshlrev_b32 v56, 16, v76
    v_and_b32 v57, 0xffff0000, v76
    v_lshlrev_b32 v58, 16, v77
    v_and_b32 v59, 0xffff0000, v77
    v_lshlrev_b32 v60, 16, v78
    v_and_b32 v61, 0xffff0000, v78
    v_lshlrev_b32 v62, 16, v79
    v_and_b32 v63, 0xffff0000, v79
    v_fma_f32 v56, v56, v37, -v36
    v_fma_f32 v57, v57, v39, -v38
    v_fma_f32 v58, v58, v41, -v40
    v_fma_f32 v59, v59, v43, -v42
    v_fma_f32 v60, v60, v45, -v44
    v_fma_f32 v61, v61, v47, -v46
    v_fma_f32 v62, v62, v49, -v48
    v_fma_f32 v63, v63, v51, -v50
    v_cvt_pk_bf16_f32 v76, v56, v57
    v_cvt_pk_bf16_f32 v77, v58, v59
    v_cvt_pk_bf16_f32 v78, v60, v61
    v_cvt_pk_bf16_f32 v79, v62, v63
    s_nop 0
    v_permlane32_swap_b32 v76, v78
    v_permlane32_swap_b32 v77, v79
    s_nop 0
    v_permlane16_swap_b32 v76, v78
    v_permlane16_swap_b32 v77, v79
    buffer_store_dwordx4 v[76:79], v1, s[80:83], s46 offen offset:2048 sc1
    v_lshlrev_b32 v56, 16, v80
    v_and_b32 v57, 0xffff0000, v80
    v_lshlrev_b32 v58, 16, v81
    v_and_b32 v59, 0xffff0000, v81
    v_lshlrev_b32 v60, 16, v82
    v_and_b32 v61, 0xffff0000, v82
    v_lshlrev_b32 v62, 16, v83
    v_and_b32 v63, 0xffff0000, v83
    v_fma_f32 v56, v56, v37, -v36
    v_fma_f32 v57, v57, v39, -v38
    v_fma_f32 v58, v58, v41, -v40
    v_fma_f32 v59, v59, v43, -v42
    v_fma_f32 v60, v60, v45, -v44
    v_fma_f32 v61, v61, v47, -v46
    v_fma_f32 v62, v62, v49, -v48
    v_fma_f32 v63, v63, v51, -v50
    v_cvt_pk_bf16_f32 v80, v56, v57
    v_cvt_pk_bf16_f32 v81, v58, v59
    v_cvt_pk_bf16_f32 v82, v60, v61
    v_cvt_pk_bf16_f32 v83, v62, v63
    s_nop 0
    v_permlane32_swap_b32 v80, v82
    v_permlane32_swap_b32 v81, v83
    s_nop 0
    v_permlane16_swap_b32 v80, v82
    v_permlane16_swap_b32 v81, v83
    s_add_u32 s46, s46, 4096
    buffer_store_dwordx4 v[80:83], v1, s[80:83], s46 offen offset:0 sc1
    s_waitcnt vmcnt(17)
    s_barrier
    v_lshlrev_b32 v56, 16, v84
    v_and_b32 v57, 0xffff0000, v84
    v_lshlrev_b32 v58, 16, v85
    v_and_b32 v59, 0xffff0000, v85
    v_lshlrev_b32 v60, 16, v86
    v_and_b32 v61, 0xffff0000, v86
    v_lshlrev_b32 v62, 16, v87
    v_and_b32 v63, 0xffff0000, v87
    v_fma_f32 v56, v56, v37, -v36
    v_fma_f32 v57, v57, v39, -v38
    v_fma_f32 v58, v58, v41, -v40
    v_fma_f32 v59, v59, v43, -v42
    v_fma_f32 v60, v60, v45, -v44
    v_fma_f32 v61, v61, v47, -v46
    v_fma_f32 v62, v62, v49, -v48
    v_fma_f32 v63, v63, v51, -v50
    v_cvt_pk_bf16_f32 v84, v56, v57
    v_cvt_pk_bf16_f32 v85, v58, v59
    v_cvt_pk_bf16_f32 v86, v60, v61
    v_cvt_pk_bf16_f32 v87, v62, v63
    s_nop 0
    v_permlane32_swap_b32 v84, v86
    v_permlane32_swap_b32 v85, v87
    s_nop 0
    v_permlane16_swap_b32 v84, v86
    v_permlane16_swap_b32 v85, v87
    buffer_store_dwordx4 v[84:87], v1, s[80:83], s46 offen offset:2048 sc1
    v_lshlrev_b32 v56, 16, v88
    v_and_b32 v57, 0xffff0000, v88
    v_lshlrev_b32 v58, 16, v89
    v_and_b32 v59, 0xffff0000, v89
    v_lshlrev_b32 v60, 16, v90
    v_and_b32 v61, 0xffff0000, v90
    v_lshlrev_b32 v62, 16, v91
    v_and_b32 v63, 0xffff0000, v91
    v_fma_f32 v56, v56, v37, -v36
    v_fma_f32 v57, v57, v39, -v38
    v_fma_f32 v58, v58, v41, -v40
    v_fma_f32 v59, v59, v43, -v42
    v_fma_f32 v60, v60, v45, -v44
    v_fma_f32 v61, v61, v47, -v46
    v_fma_f32 v62, v62, v49, -v48
    v_fma_f32 v63, v63, v51, -v50
    v_cvt_pk_bf16_f32 v88, v56, v57
    v_cvt_pk_bf16_f32 v89, v58, v59
    v_cvt_pk_bf16_f32 v90, v60, v61
    v_cvt_pk_bf16_f32 v91, v62, v63
    s_nop 0
    v_permlane32_swap_b32 v88, v90
    v_permlane32_swap_b32 v89, v91
    s_nop 0
    v_permlane16_swap_b32 v88, v90
    v_permlane16_swap_b32 v89, v91
    s_add_u32 s46, s46, 4096
    buffer_store_dwordx4 v[88:91], v1, s[80:83], s46 offen offset:0 sc1
    v_lshlrev_b32 v56, 16, v92
    v_and_b32 v57, 0xffff0000, v92
    v_lshlrev_b32 v58, 16, v93
    v_and_b32 v59, 0xffff0000, v93
    v_lshlrev_b32 v60, 16, v94
    v_and_b32 v61, 0xffff0000, v94
    v_lshlrev_b32 v62, 16, v95
    v_and_b32 v63, 0xffff0000, v95
    v_fma_f32 v56, v56, v37, -v36
    v_fma_f32 v57, v57, v39, -v38
    v_fma_f32 v58, v58, v41, -v40
    v_fma_f32 v59, v59, v43, -v42
    v_fma_f32 v60, v60, v45, -v44
    v_fma_f32 v61, v61, v47, -v46
    v_fma_f32 v62, v62, v49, -v48
    v_fma_f32 v63, v63, v51, -v50
    v_cvt_pk_bf16_f32 v92, v56, v57
    v_cvt_pk_bf16_f32 v93, v58, v59
    v_cvt_pk_bf16_f32 v94, v60, v61
    v_cvt_pk_bf16_f32 v95, v62, v63
    s_nop 0
    v_permlane32_swap_b32 v92, v94
    v_permlane32_swap_b32 v93, v95
    s_nop 0
    v_permlane16_swap_b32 v92, v94
    v_permlane16_swap_b32 v93, v95
    buffer_store_dwordx4 v[92:95], v1, s[80:83], s46 offen offset:2048 sc1
    v_lshlrev_b32 v56, 16, v96
    v_and_b32 v57, 0xffff0000, v96
    v_lshlrev_b32 v58, 16, v97
    v_and_b32 v59, 0xffff0000, v97
    v_lshlrev_b32 v60, 16, v98
    v_and_b32 v61, 0xffff0000, v98
    v_lshlrev_b32 v62, 16, v99
    v_and_b32 v63, 0xffff0000, v99
    v_fma_f32 v56, v56, v37, -v36
    v_fma_f32 v57, v57, v39, -v38
    v_fma_f32 v58, v58, v41, -v40
    v_fma_f32 v59, v59, v43, -v42
    v_fma_f32 v60, v60, v45, -v44
    v_fma_f32 v61, v61, v47, -v46
    v_fma_f32 v62, v62, v49, -v48
    v_fma_f32 v63, v63, v51, -v50
    v_cvt_pk_bf16_f32 v96, v56, v57
    v_cvt_pk_bf16_f32 v97, v58, v59
    v_cvt_pk_bf16_f32 v98, v60, v61
    v_cvt_pk_bf16_f32 v99, v62, v63
    s_nop 0
    v_permlane32_swap_b32 v96, v98
    v_permlane32_swap_b32 v97, v99
    s_nop 0
    v_permlane16_swap_b32 v96, v98
    v_permlane16_swap_b32 v97, v99
    s_add_u32 s46, s46, 4096
    buffer_store_dwordx4 v[96:99], v1, s[80:83], s46 offen offset:0 sc1
    s_waitcnt vmcnt(7)
    s_barrier
    s_lshr_b32 s50, s40, 1
    s_mul_i32 s50, s50, 34816
    s_and_b32 s51, s40, 1
    s_lshl_b32 s51, s51, 10
    s_add_u32 s50, s50, s51
    s_add_u32 s50, s50, 16384
    v_add_u32 v31, s50, v1
    ds_write_b128 v31, v[64:67] offset:0
    ds_write_b128 v31, v[68:71] offset:2048
    ds_write_b128 v31, v[72:75] offset:4096
    ds_write_b128 v31, v[76:79] offset:6144
    ds_write_b128 v31, v[80:83] offset:8192
    ds_write_b128 v31, v[84:87] offset:10240
    ds_write_b128 v31, v[88:91] offset:12288
    ds_write_b128 v31, v[92:95] offset:14336
    ds_write_b128 v31, v[96:99] offset:16384
    s_waitcnt vmcnt(0) lgkmcnt(0)
    s_lshl_b32 s50, s37, 11
    s_lshl_b32 s51, s36, 7
    s_add_u32 s50, s50, s51
    s_lshl_b32 s51, s40, 2
    s_add_u32 s50, s50, s51
    s_add_u32 s50, s50, 65536
    v_mov_b32 v33, s101
    v_mov_b32 v34, 0
    s_mov_b64 exec, 1
    buffer_store_dword v33, v34, s[84:87], s50 offen sc1
    s_mov_b64 exec, -1
    s_cmp_lg_u32 s32, 0
    s_cbranch_scc1 parallel_sum__sliding_local_dilated__mixer_gmlp__prompt_kernel_ha71
    s_branch parallel_sum__sliding_local_dilated__mixer_gmlp__prompt_kernel_g2D6
parallel_sum__sliding_local_dilated__mixer_gmlp__prompt_kernel_ha71:
    s_setprio 0
    s_barrier
    s_branch parallel_sum__sliding_local_dilated__mixer_gmlp__prompt_kernel_att4
parallel_sum__sliding_local_dilated__mixer_gmlp__prompt_kernel_C2q3:
    s_cmp_eq_u32 s41, 0
    s_cselect_b64 vcc, -1, 0
    s_mov_b32 s58, 8
    s_barrier
    ds_read_b128 v[0:3], v248 offset:0
    ds_read_b128 v[4:7], v248 offset:2048
    ds_read_b128 v[8:11], v248 offset:4096
    ds_read_b128 v[12:15], v248 offset:6144
    ds_read_b128 v[16:19], v248 offset:8192
    ds_read_b128 v[20:23], v249 offset:0
    ds_read_b128 v[24:27], v249 offset:2048
    ds_read_b128 v[28:31], v249 offset:4096
    ds_read_b128 v[32:35], v249 offset:6144
    ds_read_b128 v[36:39], v249 offset:8192
    ds_read_b128 v[40:43], v249 offset:10240
    ds_read_b128 v[44:47], v249 offset:12288
    s_waitcnt lgkmcnt(0)
    s_barrier
    v_mfma_f32_16x16x32_bf16 v[104:107], v[20:23], v[0:3], 0
    ds_read_b128 v[48:51], v248 offset:1024
    v_mfma_f32_16x16x32_bf16 v[108:111], v[24:27], v[0:3], 0
    ds_read_b128 v[52:55], v248 offset:3072
    v_mfma_f32_16x16x32_bf16 v[112:115], v[28:31], v[0:3], 0
    ds_read_b128 v[56:59], v248 offset:5120
    v_mfma_f32_16x16x32_bf16 v[116:119], v[32:35], v[0:3], 0
    ds_read_b128 v[60:63], v248 offset:7168
    v_mfma_f32_16x16x32_bf16 v[120:123], v[36:39], v[0:3], 0
    ds_read_b128 v[64:67], v248 offset:9216
    v_mfma_f32_16x16x32_bf16 v[124:127], v[40:43], v[0:3], 0
    ds_read_b128 v[68:71], v249 offset:1024
    v_mfma_f32_16x16x32_bf16 v[128:131], v[44:47], v[0:3], 0
    ds_read_b128 v[72:75], v249 offset:3072
    v_mfma_f32_16x16x32_bf16 v[156:159], v[44:47], v[4:7], 0
    ds_read_b128 v[76:79], v249 offset:5120
    v_mfma_f32_16x16x32_bf16 v[152:155], v[40:43], v[4:7], 0
    ds_read_b128 v[80:83], v249 offset:7168
    v_mfma_f32_16x16x32_bf16 v[148:151], v[36:39], v[4:7], 0
    ds_read_b128 v[84:87], v249 offset:9216
    v_mfma_f32_16x16x32_bf16 v[144:147], v[32:35], v[4:7], 0
    ds_read_b128 v[88:91], v249 offset:11264
    v_mfma_f32_16x16x32_bf16 v[140:143], v[28:31], v[4:7], 0
    ds_read_b128 v[92:95], v249 offset:13312
    v_mfma_f32_16x16x32_bf16 v[136:139], v[24:27], v[4:7], 0
    s_add_u32 s59, s59, 1
    v_mfma_f32_16x16x32_bf16 v[132:135], v[20:23], v[4:7], 0
    s_cmp_eq_u32 s59, 3
    v_mfma_f32_16x16x32_bf16 v[160:163], v[20:23], v[8:11], 0
    s_cselect_b32 s59, 0, s59
    v_mfma_f32_16x16x32_bf16 v[164:167], v[24:27], v[8:11], 0
    s_cselect_b32 s55, s56, s57
    v_mfma_f32_16x16x32_bf16 v[168:171], v[28:31], v[8:11], 0
    v_add_u32 v248, s55, v248
    v_mfma_f32_16x16x32_bf16 v[172:175], v[32:35], v[8:11], 0
    v_add_u32 v249, s55, v249
    v_mfma_f32_16x16x32_bf16 v[176:179], v[36:39], v[8:11], 0
    v_mfma_f32_16x16x32_bf16 v[180:183], v[40:43], v[8:11], 0
    v_mfma_f32_16x16x32_bf16 v[184:187], v[44:47], v[8:11], 0
    v_mfma_f32_16x16x32_bf16 v[212:215], v[44:47], v[12:15], 0
    v_mfma_f32_16x16x32_bf16 v[208:211], v[40:43], v[12:15], 0
    v_mfma_f32_16x16x32_bf16 v[204:207], v[36:39], v[12:15], 0
    v_mfma_f32_16x16x32_bf16 v[200:203], v[32:35], v[12:15], 0
    v_mfma_f32_16x16x32_bf16 v[196:199], v[28:31], v[12:15], 0
    v_mfma_f32_16x16x32_bf16 v[192:195], v[24:27], v[12:15], 0
    v_mfma_f32_16x16x32_bf16 v[188:191], v[20:23], v[12:15], 0
    s_cbranch_vccz parallel_sum__sliding_local_dilated__mixer_gmlp__prompt_kernel_sk73
    v_mfma_f32_16x16x32_bf16 v[216:219], v[20:23], v[16:19], 0
    v_mfma_f32_16x16x32_bf16 v[220:223], v[24:27], v[16:19], 0
    v_mfma_f32_16x16x32_bf16 v[224:227], v[28:31], v[16:19], 0
    v_mfma_f32_16x16x32_bf16 v[228:231], v[32:35], v[16:19], 0
    v_mfma_f32_16x16x32_bf16 v[232:235], v[36:39], v[16:19], 0
    v_mfma_f32_16x16x32_bf16 v[236:239], v[40:43], v[16:19], 0
    v_mfma_f32_16x16x32_bf16 v[240:243], v[44:47], v[16:19], 0
parallel_sum__sliding_local_dilated__mixer_gmlp__prompt_kernel_sk73:
    s_waitcnt vmcnt(0) lgkmcnt(0)
parallel_sum__sliding_local_dilated__mixer_gmlp__prompt_kernel_top72:
    s_barrier
    v_mfma_f32_16x16x32_bf16 v[104:107], v[68:71], v[48:51], v[104:107]
    ds_read_b128 v[0:3], v248 offset:0
    v_mfma_f32_16x16x32_bf16 v[108:111], v[72:75], v[48:51], v[108:111]
    ds_read_b128 v[4:7], v248 offset:2048
    v_mfma_f32_16x16x32_bf16 v[112:115], v[76:79], v[48:51], v[112:115]
    ds_read_b128 v[8:11], v248 offset:4096
    v_mfma_f32_16x16x32_bf16 v[116:119], v[80:83], v[48:51], v[116:119]
    ds_read_b128 v[12:15], v248 offset:6144
    v_mfma_f32_16x16x32_bf16 v[120:123], v[84:87], v[48:51], v[120:123]
    ds_read_b128 v[16:19], v248 offset:8192
    v_mfma_f32_16x16x32_bf16 v[124:127], v[88:91], v[48:51], v[124:127]
    ds_read_b128 v[20:23], v249 offset:0
    v_mfma_f32_16x16x32_bf16 v[128:131], v[92:95], v[48:51], v[128:131]
    ds_read_b128 v[24:27], v249 offset:2048
    v_mfma_f32_16x16x32_bf16 v[156:159], v[92:95], v[52:55], v[156:159]
    ds_read_b128 v[28:31], v249 offset:4096
    v_mfma_f32_16x16x32_bf16 v[152:155], v[88:91], v[52:55], v[152:155]
    ds_read_b128 v[32:35], v249 offset:6144
    v_mfma_f32_16x16x32_bf16 v[148:151], v[84:87], v[52:55], v[148:151]
    ds_read_b128 v[36:39], v249 offset:8192
    v_mfma_f32_16x16x32_bf16 v[144:147], v[80:83], v[52:55], v[144:147]
    ds_read_b128 v[40:43], v249 offset:10240
    v_mfma_f32_16x16x32_bf16 v[140:143], v[76:79], v[52:55], v[140:143]
    ds_read_b128 v[44:47], v249 offset:12288
    v_mfma_f32_16x16x32_bf16 v[136:139], v[72:75], v[52:55], v[136:139]
    v_mfma_f32_16x16x32_bf16 v[132:135], v[68:71], v[52:55], v[132:135]
    v_mfma_f32_16x16x32_bf16 v[160:163], v[68:71], v[56:59], v[160:163]
    v_mfma_f32_16x16x32_bf16 v[164:167], v[72:75], v[56:59], v[164:167]
    v_mfma_f32_16x16x32_bf16 v[168:171], v[76:79], v[56:59], v[168:171]
    v_mfma_f32_16x16x32_bf16 v[172:175], v[80:83], v[56:59], v[172:175]
    v_mfma_f32_16x16x32_bf16 v[176:179], v[84:87], v[56:59], v[176:179]
    v_mfma_f32_16x16x32_bf16 v[180:183], v[88:91], v[56:59], v[180:183]
    v_mfma_f32_16x16x32_bf16 v[184:187], v[92:95], v[56:59], v[184:187]
    v_mfma_f32_16x16x32_bf16 v[212:215], v[92:95], v[60:63], v[212:215]
    v_mfma_f32_16x16x32_bf16 v[208:211], v[88:91], v[60:63], v[208:211]
    v_mfma_f32_16x16x32_bf16 v[204:207], v[84:87], v[60:63], v[204:207]
    v_mfma_f32_16x16x32_bf16 v[200:203], v[80:83], v[60:63], v[200:203]
    v_mfma_f32_16x16x32_bf16 v[196:199], v[76:79], v[60:63], v[196:199]
    v_mfma_f32_16x16x32_bf16 v[192:195], v[72:75], v[60:63], v[192:195]
    v_mfma_f32_16x16x32_bf16 v[188:191], v[68:71], v[60:63], v[188:191]
    s_cbranch_vccz parallel_sum__sliding_local_dilated__mixer_gmlp__prompt_kernel_sk74
    v_mfma_f32_16x16x32_bf16 v[216:219], v[68:71], v[64:67], v[216:219]
    v_mfma_f32_16x16x32_bf16 v[220:223], v[72:75], v[64:67], v[220:223]
    v_mfma_f32_16x16x32_bf16 v[224:227], v[76:79], v[64:67], v[224:227]
    v_mfma_f32_16x16x32_bf16 v[228:231], v[80:83], v[64:67], v[228:231]
    v_mfma_f32_16x16x32_bf16 v[232:235], v[84:87], v[64:67], v[232:235]
    v_mfma_f32_16x16x32_bf16 v[236:239], v[88:91], v[64:67], v[236:239]
    v_mfma_f32_16x16x32_bf16 v[240:243], v[92:95], v[64:67], v[240:243]
parallel_sum__sliding_local_dilated__mixer_gmlp__prompt_kernel_sk74:
    s_waitcnt lgkmcnt(0)
    v_mfma_f32_16x16x32_bf16 v[104:107], v[20:23], v[0:3], v[104:107]
    ds_read_b128 v[48:51], v248 offset:1024
    v_mfma_f32_16x16x32_bf16 v[108:111], v[24:27], v[0:3], v[108:111]
    ds_read_b128 v[52:55], v248 offset:3072
    v_mfma_f32_16x16x32_bf16 v[112:115], v[28:31], v[0:3], v[112:115]
    ds_read_b128 v[56:59], v248 offset:5120
    v_mfma_f32_16x16x32_bf16 v[116:119], v[32:35], v[0:3], v[116:119]
    ds_read_b128 v[60:63], v248 offset:7168
    v_mfma_f32_16x16x32_bf16 v[120:123], v[36:39], v[0:3], v[120:123]
    ds_read_b128 v[64:67], v248 offset:9216
    v_mfma_f32_16x16x32_bf16 v[124:127], v[40:43], v[0:3], v[124:127]
    ds_read_b128 v[68:71], v249 offset:1024
    v_mfma_f32_16x16x32_bf16 v[128:131], v[44:47], v[0:3], v[128:131]
    ds_read_b128 v[72:75], v249 offset:3072
    v_mfma_f32_16x16x32_bf16 v[156:159], v[44:47], v[4:7], v[156:159]
    ds_read_b128 v[76:79], v249 offset:5120
    v_mfma_f32_16x16x32_bf16 v[152:155], v[40:43], v[4:7], v[152:155]
    ds_read_b128 v[80:83], v249 offset:7168
    v_mfma_f32_16x16x32_bf16 v[148:151], v[36:39], v[4:7], v[148:151]
    ds_read_b128 v[84:87], v249 offset:9216
    v_mfma_f32_16x16x32_bf16 v[144:147], v[32:35], v[4:7], v[144:147]
    ds_read_b128 v[88:91], v249 offset:11264
    v_mfma_f32_16x16x32_bf16 v[140:143], v[28:31], v[4:7], v[140:143]
    ds_read_b128 v[92:95], v249 offset:13312
    v_mfma_f32_16x16x32_bf16 v[136:139], v[24:27], v[4:7], v[136:139]
    s_add_u32 s59, s59, 1
    v_mfma_f32_16x16x32_bf16 v[132:135], v[20:23], v[4:7], v[132:135]
    s_cmp_eq_u32 s59, 3
    v_mfma_f32_16x16x32_bf16 v[160:163], v[20:23], v[8:11], v[160:163]
    s_cselect_b32 s59, 0, s59
    v_mfma_f32_16x16x32_bf16 v[164:167], v[24:27], v[8:11], v[164:167]
    s_cselect_b32 s55, s56, s57
    v_mfma_f32_16x16x32_bf16 v[168:171], v[28:31], v[8:11], v[168:171]
    v_add_u32 v248, s55, v248
    v_mfma_f32_16x16x32_bf16 v[172:175], v[32:35], v[8:11], v[172:175]
    v_add_u32 v249, s55, v249
    v_mfma_f32_16x16x32_bf16 v[176:179], v[36:39], v[8:11], v[176:179]
    s_sub_u32 s58, s58, 1
    v_mfma_f32_16x16x32_bf16 v[180:183], v[40:43], v[8:11], v[180:183]
    s_cmp_lg_u32 s58, 0
    v_mfma_f32_16x16x32_bf16 v[184:187], v[44:47], v[8:11], v[184:187]
    v_mfma_f32_16x16x32_bf16 v[212:215], v[44:47], v[12:15], v[212:215]
    v_mfma_f32_16x16x32_bf16 v[208:211], v[40:43], v[12:15], v[208:211]
    v_mfma_f32_16x16x32_bf16 v[204:207], v[36:39], v[12:15], v[204:207]
    v_mfma_f32_16x16x32_bf16 v[200:203], v[32:35], v[12:15], v[200:203]
    v_mfma_f32_16x16x32_bf16 v[196:199], v[28:31], v[12:15], v[196:199]
    v_mfma_f32_16x16x32_bf16 v[192:195], v[24:27], v[12:15], v[192:195]
    v_mfma_f32_16x16x32_bf16 v[188:191], v[20:23], v[12:15], v[188:191]
    s_cbranch_vccz parallel_sum__sliding_local_dilated__mixer_gmlp__prompt_kernel_sk75
    v_mfma_f32_16x16x32_bf16 v[216:219], v[20:23], v[16:19], v[216:219]
    v_mfma_f32_16x16x32_bf16 v[220:223], v[24:27], v[16:19], v[220:223]
    v_mfma_f32_16x16x32_bf16 v[224:227], v[28:31], v[16:19], v[224:227]
    v_mfma_f32_16x16x32_bf16 v[228:231], v[32:35], v[16:19], v[228:231]
    v_mfma_f32_16x16x32_bf16 v[232:235], v[36:39], v[16:19], v[232:235]
    v_mfma_f32_16x16x32_bf16 v[236:239], v[40:43], v[16:19], v[236:239]
    v_mfma_f32_16x16x32_bf16 v[240:243], v[44:47], v[16:19], v[240:243]
parallel_sum__sliding_local_dilated__mixer_gmlp__prompt_kernel_sk75:
    s_waitcnt lgkmcnt(0)
    s_cbranch_scc1 parallel_sum__sliding_local_dilated__mixer_gmlp__prompt_kernel_top72
    s_barrier
    s_cbranch_vccz parallel_sum__sliding_local_dilated__mixer_gmlp__prompt_kernel_sk76
    v_mfma_f32_16x16x32_bf16 v[216:219], v[68:71], v[64:67], v[216:219]
    v_mfma_f32_16x16x32_bf16 v[220:223], v[72:75], v[64:67], v[220:223]
    v_mfma_f32_16x16x32_bf16 v[224:227], v[76:79], v[64:67], v[224:227]
    v_mfma_f32_16x16x32_bf16 v[228:231], v[80:83], v[64:67], v[228:231]
    v_mfma_f32_16x16x32_bf16 v[232:235], v[84:87], v[64:67], v[232:235]
    v_mfma_f32_16x16x32_bf16 v[236:239], v[88:91], v[64:67], v[236:239]
    v_mfma_f32_16x16x32_bf16 v[240:243], v[92:95], v[64:67], v[240:243]
parallel_sum__sliding_local_dilated__mixer_gmlp__prompt_kernel_sk76:
    v_mfma_f32_16x16x32_bf16 v[104:107], v[68:71], v[48:51], v[104:107]
    v_mfma_f32_16x16x32_bf16 v[108:111], v[72:75], v[48:51], v[108:111]
    v_mfma_f32_16x16x32_bf16 v[112:115], v[76:79], v[48:51], v[112:115]
    v_mfma_f32_16x16x32_bf16 v[116:119], v[80:83], v[48:51], v[116:119]
    v_mfma_f32_16x16x32_bf16 v[120:123], v[84:87], v[48:51], v[120:123]
    v_mfma_f32_16x16x32_bf16 v[124:127], v[88:91], v[48:51], v[124:127]
    v_mfma_f32_16x16x32_bf16 v[128:131], v[92:95], v[48:51], v[128:131]
    v_mfma_f32_16x16x32_bf16 v[132:135], v[68:71], v[52:55], v[132:135]
    s_nop 0
    v_cvt_pk_bf16_f32 v0, v104, v105
    v_cvt_pk_bf16_f32 v1, v106, v107
    ds_write_b64 v251, v[0:1] offset:0
    v_mfma_f32_16x16x32_bf16 v[136:139], v[72:75], v[52:55], v[136:139]
    v_cvt_pk_bf16_f32 v2, v108, v109
    v_cvt_pk_bf16_f32 v3, v110, v111
    ds_write_b64 v251, v[2:3] offset:32
    v_mfma_f32_16x16x32_bf16 v[140:143], v[76:79], v[52:55], v[140:143]
    v_cvt_pk_bf16_f32 v4, v112, v113
    v_cvt_pk_bf16_f32 v5, v114, v115
    ds_write_b64 v251, v[4:5] offset:64
    v_mfma_f32_16x16x32_bf16 v[144:147], v[80:83], v[52:55], v[144:147]
    v_cvt_pk_bf16_f32 v6, v116, v117
    v_cvt_pk_bf16_f32 v7, v118, v119
    ds_write_b64 v251, v[6:7] offset:96
    v_mfma_f32_16x16x32_bf16 v[148:151], v[84:87], v[52:55], v[148:151]
    v_cvt_pk_bf16_f32 v0, v120, v121
    v_cvt_pk_bf16_f32 v1, v122, v123
    ds_write_b64 v251, v[0:1] offset:128
    v_mfma_f32_16x16x32_bf16 v[152:155], v[88:91], v[52:55], v[152:155]
    v_cvt_pk_bf16_f32 v2, v124, v125
    v_cvt_pk_bf16_f32 v3, v126, v127
    ds_write_b64 v251, v[2:3] offset:160
    v_mfma_f32_16x16x32_bf16 v[156:159], v[92:95], v[52:55], v[156:159]
    v_mfma_f32_16x16x32_bf16 v[160:163], v[68:71], v[56:59], v[160:163]
    v_cvt_pk_bf16_f32 v4, v132, v133
    v_cvt_pk_bf16_f32 v5, v134, v135
    ds_write_b64 v251, v[4:5] offset:7040
    v_mfma_f32_16x16x32_bf16 v[164:167], v[72:75], v[56:59], v[164:167]
    v_cvt_pk_bf16_f32 v6, v136, v137
    v_cvt_pk_bf16_f32 v7, v138, v139
    ds_write_b64 v251, v[6:7] offset:7072
    v_mfma_f32_16x16x32_bf16 v[168:171], v[76:79], v[56:59], v[168:171]
    v_cvt_pk_bf16_f32 v0, v140, v141
    v_cvt_pk_bf16_f32 v1, v142, v143
    ds_write_b64 v251, v[0:1] offset:7104
    v_mfma_f32_16x16x32_bf16 v[172:175], v[80:83], v[56:59], v[172:175]
    v_cvt_pk_bf16_f32 v2, v144, v145
    v_cvt_pk_bf16_f32 v3, v146, v147
    ds_write_b64 v251, v[2:3] offset:7136
    v_mfma_f32_16x16x32_bf16 v[176:179], v[84:87], v[56:59], v[176:179]
    v_cvt_pk_bf16_f32 v4, v148, v149
    v_cvt_pk_bf16_f32 v5, v150, v151
    ds_write_b64 v251, v[4:5] offset:7168
    v_mfma_f32_16x16x32_bf16 v[180:183], v[88:91], v[56:59], v[180:183]
    v_cvt_pk_bf16_f32 v6, v152, v153
    v_cvt_pk_bf16_f32 v7, v154, v155
    ds_write_b64 v251, v[6:7] offset:7200
    v_mfma_f32_16x16x32_bf16 v[184:187], v[92:95], v[56:59], v[184:187]
    v_mfma_f32_16x16x32_bf16 v[188:191], v[68:71], v[60:63], v[188:191]
    v_cvt_pk_bf16_f32 v0, v160, v161
    v_cvt_pk_bf16_f32 v1, v162, v163
    ds_write_b64 v251, v[0:1] offset:14080
    v_mfma_f32_16x16x32_bf16 v[192:195], v[72:75], v[60:63], v[192:195]
    v_cvt_pk_bf16_f32 v2, v164, v165
    v_cvt_pk_bf16_f32 v3, v166, v167
    ds_write_b64 v251, v[2:3] offset:14112
    v_mfma_f32_16x16x32_bf16 v[196:199], v[76:79], v[60:63], v[196:199]
    v_cvt_pk_bf16_f32 v4, v168, v169
    v_cvt_pk_bf16_f32 v5, v170, v171
    ds_write_b64 v251, v[4:5] offset:14144
    v_mfma_f32_16x16x32_bf16 v[200:203], v[80:83], v[60:63], v[200:203]
    v_cvt_pk_bf16_f32 v6, v172, v173
    v_cvt_pk_bf16_f32 v7, v174, v175
    ds_write_b64 v251, v[6:7] offset:14176
    v_mfma_f32_16x16x32_bf16 v[204:207], v[84:87], v[60:63], v[204:207]
    v_cvt_pk_bf16_f32 v0, v176, v177
    v_cvt_pk_bf16_f32 v1, v178, v179
    ds_write_b64 v251, v[0:1] offset:14208
    v_mfma_f32_16x16x32_bf16 v[208:211], v[88:91], v[60:63], v[208:211]
    v_cvt_pk_bf16_f32 v2, v180, v181
    v_cvt_pk_bf16_f32 v3, v182, v183
    ds_write_b64 v251, v[2:3] offset:14240
    v_mfma_f32_16x16x32_bf16 v[212:215], v[92:95], v[60:63], v[212:215]
    v_cvt_pk_bf16_f32 v4, v188, v189
    v_cvt_pk_bf16_f32 v5, v190, v191
    ds_write_b64 v251, v[4:5] offset:21120
    v_cvt_pk_bf16_f32 v6, v192, v193
    v_cvt_pk_bf16_f32 v7, v194, v195
    ds_write_b64 v251, v[6:7] offset:21152
    v_cvt_pk_bf16_f32 v0, v196, v197
    v_cvt_pk_bf16_f32 v1, v198, v199
    ds_write_b64 v251, v[0:1] offset:21184
    v_cvt_pk_bf16_f32 v2, v200, v201
    v_cvt_pk_bf16_f32 v3, v202, v203
    ds_write_b64 v251, v[2:3] offset:21216
    v_cvt_pk_bf16_f32 v4, v204, v205
    v_cvt_pk_bf16_f32 v5, v206, v207
    ds_write_b64 v251, v[4:5] offset:21248
    v_cvt_pk_bf16_f32 v6, v208, v209
    v_cvt_pk_bf16_f32 v7, v210, v211
    ds_write_b64 v251, v[6:7] offset:21280
    s_cbranch_vccz parallel_sum__sliding_local_dilated__mixer_gmlp__prompt_kernel_sk77
    v_cvt_pk_bf16_f32 v0, v216, v217
    v_cvt_pk_bf16_f32 v1, v218, v219
    ds_write_b64 v251, v[0:1] offset:28160
    v_cvt_pk_bf16_f32 v2, v220, v221
    v_cvt_pk_bf16_f32 v3, v222, v223
    ds_write_b64 v251, v[2:3] offset:28192
    v_cvt_pk_bf16_f32 v4, v224, v225
    v_cvt_pk_bf16_f32 v5, v226, v227
    ds_write_b64 v251, v[4:5] offset:28224
    v_cvt_pk_bf16_f32 v6, v228, v229
    v_cvt_pk_bf16_f32 v7, v230, v231
    ds_write_b64 v251, v[6:7] offset:28256
    v_cvt_pk_bf16_f32 v0, v232, v233
    v_cvt_pk_bf16_f32 v1, v234, v235
    ds_write_b64 v251, v[0:1] offset:28288
    v_cvt_pk_bf16_f32 v2, v236, v237
    v_cvt_pk_bf16_f32 v3, v238, v239
    ds_write_b64 v251, v[2:3] offset:28320
    s_mov_b32 exec_hi, s54
    v_cvt_pk_bf16_f32 v4, v240, v241
    v_cvt_pk_bf16_f32 v5, v242, v243
    ds_write_b64 v251, v[4:5] offset:28352
parallel_sum__sliding_local_dilated__mixer_gmlp__prompt_kernel_sk77:
    s_mov_b32 exec_hi, s54
    v_cvt_pk_bf16_f32 v6, v128, v129
    v_cvt_pk_bf16_f32 v7, v130, v131
    ds_write_b64 v251, v[6:7] offset:192
    v_cvt_pk_bf16_f32 v0, v156, v157
    v_cvt_pk_bf16_f32 v1, v158, v159
    ds_write_b64 v251, v[0:1] offset:7232
    v_cvt_pk_bf16_f32 v2, v184, v185
    v_cvt_pk_bf16_f32 v3, v186, v187
    ds_write_b64 v251, v[2:3] offset:14272
    v_cvt_pk_bf16_f32 v4, v212, v213
    v_cvt_pk_bf16_f32 v5, v214, v215
    ds_write_b64 v251, v[4:5] offset:21312
    s_mov_b32 exec_hi, -1
    s_waitcnt lgkmcnt(0)
    v_mbcnt_lo_u32_b32 v0, -1, 0
    v_mbcnt_hi_u32_b32 v0, -1, v0
parallel_sum__sliding_local_dilated__mixer_gmlp__prompt_kernel_att4:
    s_and_b32 s55, s33, 3
    s_lshr_b32 s41, s33, 2
    s_and_b32 s42, s55, 1
    s_lshl_b32 s43, s41, 6
    s_add_u32 s44, s43, 2
    v_add_u32 v2, s44, v0
    v_mul_u32_u24 v2, 440, v2
    s_mul_i32 s44, s55, 36
    s_add_u32 s44, s44, 69632
    s_lshl_b32 s45, s42, 2
    s_add_u32 s45, s45, s44
    v_add_u32 v3, s45, v2
    s_xor_b32 s45, s42, 1
    s_lshl_b32 s45, s45, 5
    s_add_u32 s45, s45, s44
    v_add_u32 v2, s45, v2
    s_lshl_b32 s46, s38, 7
    s_add_u32 s46, s46, s43
    v_add_u32 v4, s46, v0
    s_mov_b32 s21, 0x05040100
    s_mov_b32 s22, 0x07060302
    v_and_b32 v11, 15, v0
    v_lshrrev_b32 v12, 4, v0
    s_lshl_b32 s46, s33, 4
    s_add_u32 s46, s46, 16
    v_add_u32 v13, s46, v11
    v_mul_u32_u24 v13, 440, v13
    v_lshl_add_u32 v13, v12, 4, v13
    v_add_u32 v13, 69632, v13
    s_mul_i32 s46, s39, 9
    v_add_u32 v12, s46, v12
    v_lshlrev_b32 v12, 8, v12
    v_lshl_add_u32 v12, v11, 4, v12
    s_lshl_b32 s46, s38, 3
    s_add_u32 s46, s46, s33
    s_mul_i32 s20, s46, 92160
    s_cmp_lt_u32 s33, 4
    s_cbranch_scc1 parallel_sum__sliding_local_dilated__mixer_gmlp__prompt_kernel_ac78
    s_mov_b32 s8, s66
    s_mov_b32 s9, s67
    s_mov_b32 s10, 0x800000
    s_mov_b32 s11, 0x20000
    s_add_u32 s12, s4, 0x400000
    s_addc_u32 s13, s5, 0
    s_mov_b32 s14, 0x900000
    s_mov_b32 s15, 0x20000
    v_lshlrev_b32 v244, 4, v0
    v_lshrrev_b32 v245, 2, v0
    v_lshlrev_b32 v245, 7, v245
    v_and_b32 v246, 3, v0
    v_lshl_add_u32 v245, v246, 2, v245
    v_lshrrev_b32 v247, 4, v0
    v_and_b32 v246, 7, v0
    v_xor_b32 v246, v246, v247
    v_lshrrev_b32 v247, 3, v0
    v_lshlrev_b32 v247, 12, v247
    v_lshl_add_u32 v246, v246, 4, v247
    v_xor_b32 v247, 64, v246
    s_lshl_b32 s41, s40, 12
    s_lshl_b32 s42, s36, 19
    s_lshl_b32 s50, s40, 17
    s_add_u32 s42, s42, s50
    s_mul_i32 s43, s37, 18432
    s_lshl_b32 s45, s40, 9
    s_add_u32 s46, s43, s45
    s_add_u32 s46, s46, 16384
    s_add_u32 s43, s43, s41
    s_add_u32 s47, s41, 16384
    s_add_u32 s45, s45, 32768
    s_lshl_b32 s53, s37, 11
    s_add_u32 s53, s53, 65536
    s_mov_b32 s100, 0
    s_mov_b32 s49, 0
    s_movk_i32 s88, 128
    s_mov_b32 s89, 294912
    s_lshl_b32 s59, s36, 1
    s_lshl_b32 s50, s36, 8
    s_add_u32 s42, s42, s50
    s_add_u32 m0, s41, s49
    s_nop 0
    buffer_load_dwordx4 v246, s[8:11], s42 offen lds
    s_add_u32 m0, m0, 1024
    s_add_u32 s50, s42, 32768
    buffer_load_dwordx4 v247, s[8:11], s50 offen lds
    s_add_u32 m0, m0, 1024
    s_add_u32 s50, s42, 65536
    buffer_load_dwordx4 v246, s[8:11], s50 offen lds
    s_add_u32 m0, m0, 1024
    s_add_u32 s50, s42, 98304
    buffer_load_dwordx4 v247, s[8:11], s50 offen lds
    s_add_u32 s42, s42, s88
    s_mov_b32 s49, 34816
    s_add_u32 m0, s41, s49
    s_nop 0
    buffer_load_dwordx4 v246, s[8:11], s42 offen lds
    s_add_u32 m0, m0, 1024
    s_add_u32 s50, s42, 32768
    buffer_load_dwordx4 v247, s[8:11], s50 offen lds
    s_add_u32 m0, m0, 1024
    s_add_u32 s50, s42, 65536
    buffer_load_dwordx4 v246, s[8:11], s50 offen lds
    s_add_u32 m0, m0, 1024
    s_add_u32 s50, s42, 98304
    buffer_load_dwordx4 v247, s[8:11], s50 offen lds
    s_add_u32 s42, s42, s88
    s_lshl_b32 s50, s36, 8
    s_sub_u32 s42, s42, s50
    s_cmp_eq_u32 s36, 0
    s_cselect_b32 s51, 0, 256
    s_cselect_b32 s50, 589824, 0
    s_sub_u32 s42, s42, s51
    s_add_u32 s43, s43, s50
    s_add_u32 s46, s46, s50
    s_mov_b32 s49, 69632
    buffer_load_dword v248, v245, s[84:87], s53 offen sc1
parallel_sum__sliding_local_dilated__mixer_gmlp__prompt_kernel_ac78:
    s_barrier
    ds_read_b64 v[24:25], v3 offset:6160
    ds_read_b64 v[26:27], v3 offset:6168
    ds_read_b64 v[28:29], v3 offset:6176
    ds_read_b64 v[30:31], v3 offset:6184
    ds_read_b32 v32, v2 offset:6160
    ds_read_b64 v[36:37], v3 offset:6304
    ds_read_b64 v[38:39], v3 offset:6312
    ds_read_b64 v[40:41], v3 offset:6320
    ds_read_b64 v[42:43], v3 offset:6328
    ds_read_b32 v44, v2 offset:6304
    ds_read_b64 v[46:47], v3 offset:5424
    ds_read_b64 v[48:49], v3 offset:5432
    ds_read_b64 v[50:51], v3 offset:5440
    ds_read_b64 v[52:53], v3 offset:5448
    ds_read_b32 v54, v2 offset:5424
    ds_read_b64 v[56:57], v3 offset:4544
    ds_read_b64 v[58:59], v3 offset:4552
    ds_read_b64 v[60:61], v3 offset:4560
    ds_read_b64 v[62:63], v3 offset:4568
    ds_read_b32 v64, v2 offset:4544
    v_mov_b32 v200, 0
    v_mov_b32 v201, 0
    v_mov_b32 v202, 0
    v_mov_b32 v203, 0
    v_mov_b32 v204, 0
    v_mov_b32 v205, 0
    v_mov_b32 v206, 0
    v_mov_b32 v207, 0
    s_waitcnt lgkmcnt(10)
    v_dot2c_f32_bf16 v200, v24, v36
    v_dot2c_f32_bf16 v200, v25, v37
    v_dot2c_f32_bf16 v200, v26, v38
    v_dot2c_f32_bf16 v200, v27, v39
    v_dot2c_f32_bf16 v200, v28, v40
    v_dot2c_f32_bf16 v200, v29, v41
    v_dot2c_f32_bf16 v200, v30, v42
    v_dot2c_f32_bf16 v200, v31, v43
    v_dot2c_f32_bf16 v200, v32, v44
    ds_read_b64 v[66:67], v3 offset:3664
    ds_read_b64 v[68:69], v3 offset:3672
    ds_read_b64 v[70:71], v3 offset:3680
    ds_read_b64 v[72:73], v3 offset:3688
    ds_read_b32 v74, v2 offset:3664
    s_waitcnt lgkmcnt(10)
    v_dot2c_f32_bf16 v201, v24, v46
    v_dot2c_f32_bf16 v201, v25, v47
    v_dot2c_f32_bf16 v201, v26, v48
    v_dot2c_f32_bf16 v201, v27, v49
    v_dot2c_f32_bf16 v201, v28, v50
    v_dot2c_f32_bf16 v201, v29, v51
    v_dot2c_f32_bf16 v201, v30, v52
    v_dot2c_f32_bf16 v201, v31, v53
    v_dot2c_f32_bf16 v201, v32, v54
    ds_read_b64 v[76:77], v3 offset:2784
    ds_read_b64 v[78:79], v3 offset:2792
    ds_read_b64 v[80:81], v3 offset:2800
    ds_read_b64 v[82:83], v3 offset:2808
    ds_read_b32 v84, v2 offset:2784
    s_waitcnt lgkmcnt(10)
    v_dot2c_f32_bf16 v202, v24, v56
    v_dot2c_f32_bf16 v202, v25, v57
    v_dot2c_f32_bf16 v202, v26, v58
    v_dot2c_f32_bf16 v202, v27, v59
    v_dot2c_f32_bf16 v202, v28, v60
    v_dot2c_f32_bf16 v202, v29, v61
    v_dot2c_f32_bf16 v202, v30, v62
    v_dot2c_f32_bf16 v202, v31, v63
    v_dot2c_f32_bf16 v202, v32, v64
    ds_read_b64 v[86:87], v3 offset:1904
    ds_read_b64 v[88:89], v3 offset:1912
    ds_read_b64 v[90:91], v3 offset:1920
    ds_read_b64 v[92:93], v3 offset:1928
    ds_read_b32 v94, v2 offset:1904
    s_waitcnt lgkmcnt(10)
    v_dot2c_f32_bf16 v203, v24, v66
    v_dot2c_f32_bf16 v203, v25, v67
    v_dot2c_f32_bf16 v203, v26, v68
    v_dot2c_f32_bf16 v203, v27, v69
    v_dot2c_f32_bf16 v203, v28, v70
    v_dot2c_f32_bf16 v203, v29, v71
    v_dot2c_f32_bf16 v203, v30, v72
    v_dot2c_f32_bf16 v203, v31, v73
    v_dot2c_f32_bf16 v203, v32, v74
    ds_read_b64 v[96:97], v3 offset:1024
    ds_read_b64 v[98:99], v3 offset:1032
    ds_read_b64 v[100:101], v3 offset:1040
    ds_read_b64 v[102:103], v3 offset:1048
    ds_read_b32 v104, v2 offset:1024
    s_waitcnt lgkmcnt(10)
    v_dot2c_f32_bf16 v204, v24, v76
    v_dot2c_f32_bf16 v204, v25, v77
    v_dot2c_f32_bf16 v204, v26, v78
    v_dot2c_f32_bf16 v204, v27, v79
    v_dot2c_f32_bf16 v204, v28, v80
    v_dot2c_f32_bf16 v204, v29, v81
    v_dot2c_f32_bf16 v204, v30, v82
    v_dot2c_f32_bf16 v204, v31, v83
    v_dot2c_f32_bf16 v204, v32, v84
    ds_read_b64 v[106:107], v3 offset:144
    ds_read_b64 v[108:109], v3 offset:152
    ds_read_b64 v[110:111], v3 offset:160
    ds_read_b64 v[112:113], v3 offset:168
    ds_read_b32 v114, v2 offset:144
    s_waitcnt lgkmcnt(10)
    v_dot2c_f32_bf16 v205, v24, v86
    v_dot2c_f32_bf16 v205, v25, v87
    v_dot2c_f32_bf16 v205, v26, v88
    v_dot2c_f32_bf16 v205, v27, v89
    v_dot2c_f32_bf16 v205, v28, v90
    v_dot2c_f32_bf16 v205, v29, v91
    v_dot2c_f32_bf16 v205, v30, v92
    v_dot2c_f32_bf16 v205, v31, v93
    v_dot2c_f32_bf16 v205, v32, v94
    ds_read_b64 v[116:117], v3 offset:6448
    ds_read_b64 v[118:119], v3 offset:6456
    ds_read_b64 v[120:121], v3 offset:6464
    ds_read_b64 v[122:123], v3 offset:6472
    ds_read_b32 v124, v2 offset:6448
    s_waitcnt lgkmcnt(10)
    v_dot2c_f32_bf16 v206, v24, v96
    v_dot2c_f32_bf16 v206, v25, v97
    v_dot2c_f32_bf16 v206, v26, v98
    v_dot2c_f32_bf16 v206, v27, v99
    v_dot2c_f32_bf16 v206, v28, v100
    v_dot2c_f32_bf16 v206, v29, v101
    v_dot2c_f32_bf16 v206, v30, v102
    v_dot2c_f32_bf16 v206, v31, v103
    v_dot2c_f32_bf16 v206, v32, v104
    ds_read_b64 v[126:127], v3 offset:5568
    ds_read_b64 v[128:129], v3 offset:5576
    ds_read_b64 v[130:131], v3 offset:5584
    ds_read_b64 v[132:133], v3 offset:5592
    ds_read_b32 v134, v2 offset:5568
    s_waitcnt lgkmcnt(10)
    v_dot2c_f32_bf16 v207, v24, v106
    v_dot2c_f32_bf16 v207, v25, v107
    v_dot2c_f32_bf16 v207, v26, v108
    v_dot2c_f32_bf16 v207, v27, v109
    v_dot2c_f32_bf16 v207, v28, v110
    v_dot2c_f32_bf16 v207, v29, v111
    v_dot2c_f32_bf16 v207, v30, v112
    v_dot2c_f32_bf16 v207, v31, v113
    v_dot2c_f32_bf16 v207, v32, v114
    ds_read_b64 v[136:137], v3 offset:4688
    ds_read_b64 v[138:139], v3 offset:4696
    ds_read_b64 v[140:141], v3 offset:4704
    ds_read_b64 v[142:143], v3 offset:4712
    ds_read_b32 v144, v2 offset:4688
    ds_read_b64 v[146:147], v3 offset:3808
    ds_read_b64 v[148:149], v3 offset:3816
    ds_read_b64 v[150:151], v3 offset:3824
    ds_read_b64 v[152:153], v3 offset:3832
    ds_read_b32 v154, v2 offset:3808
    ds_read_b64 v[156:157], v3 offset:2928
    ds_read_b64 v[158:159], v3 offset:2936
    ds_read_b64 v[160:161], v3 offset:2944
    ds_read_b64 v[162:163], v3 offset:2952
    ds_read_b32 v164, v2 offset:2928
    ds_read_b64 v[166:167], v3 offset:2048
    ds_read_b64 v[168:169], v3 offset:2056
    ds_read_b64 v[170:171], v3 offset:2064
    ds_read_b64 v[172:173], v3 offset:2072
    ds_read_b32 v174, v2 offset:2048
    ds_read_b64 v[176:177], v3 offset:1168
    ds_read_b64 v[178:179], v3 offset:1176
    ds_read_b64 v[180:181], v3 offset:1184
    ds_read_b64 v[182:183], v3 offset:1192
    ds_read_b32 v184, v2 offset:1168
    ds_read_b64 v[186:187], v3 offset:288
    ds_read_b64 v[188:189], v3 offset:296
    ds_read_b64 v[190:191], v3 offset:304
    ds_read_b64 v[192:193], v3 offset:312
    ds_read_b32 v194, v2 offset:288
    v_cvt_pk_bf16_f32 v210, v200, v201
    v_cvt_pk_bf16_f32 v211, v202, v203
    v_cvt_pk_bf16_f32 v212, v204, v205
    v_cvt_pk_bf16_f32 v213, v206, v207
    v_lshlrev_b32 v200, 16, v210
    v_and_b32 v201, 0xffff0000, v210
    v_lshlrev_b32 v202, 16, v211
    v_and_b32 v203, 0xffff0000, v211
    v_lshlrev_b32 v204, 16, v212
    v_and_b32 v205, 0xffff0000, v212
    v_lshlrev_b32 v206, 16, v213
    v_and_b32 v207, 0xffff0000, v213
    v_mul_f32 v200, 0x3e715bef, v200
    v_mul_f32 v201, 0x3e715bef, v201
    v_mul_f32 v202, 0x3e715bef, v202
    v_mul_f32 v203, 0x3e715bef, v203
    v_mul_f32 v204, 0x3e715bef, v204
    v_mul_f32 v205, 0x3e715bef, v205
    v_mul_f32 v206, 0x3e715bef, v206
    v_mul_f32 v207, 0x3e715bef, v207
    v_cvt_pk_bf16_f32 v210, v200, v201
    v_cvt_pk_bf16_f32 v211, v202, v203
    v_cvt_pk_bf16_f32 v212, v204, v205
    v_cvt_pk_bf16_f32 v213, v206, v207
    v_lshlrev_b32 v200, 16, v210
    v_and_b32 v201, 0xffff0000, v210
    v_lshlrev_b32 v202, 16, v211
    v_and_b32 v203, 0xffff0000, v211
    v_lshlrev_b32 v204, 16, v212
    v_and_b32 v205, 0xffff0000, v212
    v_lshlrev_b32 v206, 16, v213
    v_and_b32 v207, 0xffff0000, v213
    v_mov_b32 v6, 0xce6e6b28
    v_cmp_le_u32 s[26:27], 2, v4
    v_cmp_le_u32 s[24:25], 4, v4
    s_nop 0
    v_cndmask_b32 v201, v6, v201, s[26:27]
    v_cmp_le_u32 s[26:27], 6, v4
    v_cndmask_b32 v202, v6, v202, s[24:25]
    v_cmp_le_u32 s[24:25], 8, v4
    v_cndmask_b32 v203, v6, v203, s[26:27]
    v_cmp_le_u32 s[26:27], 10, v4
    v_cndmask_b32 v204, v6, v204, s[24:25]
    v_cmp_le_u32 s[24:25], 12, v4
    v_cndmask_b32 v205, v6, v205, s[26:27]
    v_cmp_le_u32 s[26:27], 14, v4
    v_cndmask_b32 v206, v6, v206, s[24:25]
    s_nop 0
    v_cndmask_b32 v207, v6, v207, s[26:27]
    v_max3_f32 v7, v200, v201, v202
    v_max3_f32 v8, v203, v204, v205
    v_max3_f32 v7, v7, v206, v207
    v_max_f32 v7, v7, v8
    v_sub_f32 v200, v200, v7
    v_sub_f32 v201, v201, v7
    v_sub_f32 v202, v202, v7
    v_sub_f32 v203, v203, v7
    v_sub_f32 v204, v204, v7
    v_sub_f32 v205, v205, v7
    v_sub_f32 v206, v206, v7
    v_sub_f32 v207, v207, v7
    v_mul_f32 v200, 0x3fb8aa3b, v200
    v_mul_f32 v201, 0x3fb8aa3b, v201
    v_mul_f32 v202, 0x3fb8aa3b, v202
    v_mul_f32 v203, 0x3fb8aa3b, v203
    v_mul_f32 v204, 0x3fb8aa3b, v204
    v_mul_f32 v205, 0x3fb8aa3b, v205
    v_mul_f32 v206, 0x3fb8aa3b, v206
    v_mul_f32 v207, 0x3fb8aa3b, v207
    v_exp_f32 v200, v200
    v_exp_f32 v201, v201
    v_exp_f32 v202, v202
    v_exp_f32 v203, v203
    v_exp_f32 v204, v204
    v_exp_f32 v205, v205
    v_exp_f32 v206, v206
    v_exp_f32 v207, v207
    v_add_f32 v7, v200, v201
    v_add_f32 v8, v202, v203
    v_add_f32 v9, v204, v205
    v_add_f32 v10, v206, v207
    v_add_f32 v7, v7, v8
    v_add_f32 v9, v9, v10
    v_add_f32 v7, v7, v9
    v_rcp_f32 v7, v7
    s_nop 0
    v_mul_f32 v200, v200, v7
    v_mul_f32 v201, v201, v7
    v_mul_f32 v202, v202, v7
    v_mul_f32 v203, v203, v7
    v_mul_f32 v204, v204, v7
    v_mul_f32 v205, v205, v7
    v_mul_f32 v206, v206, v7
    v_mul_f32 v207, v207, v7
    v_cvt_pk_bf16_f32 v210, v200, v201
    v_cvt_pk_bf16_f32 v211, v202, v203
    v_cvt_pk_bf16_f32 v212, v204, v205
    v_cvt_pk_bf16_f32 v213, v206, v207
    v_mov_b32 v216, 0
    v_mov_b32 v217, 0
    v_mov_b32 v218, 0
    v_mov_b32 v219, 0
    v_mov_b32 v220, 0
    v_mov_b32 v221, 0
    v_mov_b32 v222, 0
    v_mov_b32 v223, 0
    v_mov_b32 v224, 0
    v_mov_b32 v225, 0
    v_mov_b32 v226, 0
    v_mov_b32 v227, 0
    v_mov_b32 v228, 0
    v_mov_b32 v229, 0
    v_mov_b32 v230, 0
    v_mov_b32 v231, 0
    v_mov_b32 v232, 0
    v_mov_b32 v233, 0
    s_waitcnt lgkmcnt(0)
    v_perm_b32 v36, v126, v116, s21
    v_perm_b32 v37, v126, v116, s22
    v_perm_b32 v38, v127, v117, s21
    v_perm_b32 v39, v127, v117, s22
    v_perm_b32 v40, v128, v118, s21
    v_perm_b32 v41, v128, v118, s22
    v_perm_b32 v42, v129, v119, s21
    v_perm_b32 v43, v129, v119, s22
    v_perm_b32 v44, v130, v120, s21
    v_perm_b32 v45, v130, v120, s22
    v_perm_b32 v46, v131, v121, s21
    v_perm_b32 v47, v131, v121, s22
    v_perm_b32 v48, v132, v122, s21
    v_perm_b32 v49, v132, v122, s22
    v_perm_b32 v50, v133, v123, s21
    v_perm_b32 v51, v133, v123, s22
    v_perm_b32 v52, v134, v124, s21
    v_perm_b32 v53, v134, v124, s22
    v_dot2c_f32_bf16 v216, v36, v210
    v_dot2c_f32_bf16 v217, v37, v210
    v_dot2c_f32_bf16 v218, v38, v210
    v_dot2c_f32_bf16 v219, v39, v210
    v_dot2c_f32_bf16 v220, v40, v210
    v_dot2c_f32_bf16 v221, v41, v210
    v_dot2c_f32_bf16 v222, v42, v210
    v_dot2c_f32_bf16 v223, v43, v210
    v_dot2c_f32_bf16 v224, v44, v210
    v_dot2c_f32_bf16 v225, v45, v210
    v_dot2c_f32_bf16 v226, v46, v210
    v_dot2c_f32_bf16 v227, v47, v210
    v_dot2c_f32_bf16 v228, v48, v210
    v_dot2c_f32_bf16 v229, v49, v210
    v_dot2c_f32_bf16 v230, v50, v210
    v_dot2c_f32_bf16 v231, v51, v210
    v_dot2c_f32_bf16 v232, v52, v210
    v_dot2c_f32_bf16 v233, v53, v210
    v_perm_b32 v36, v146, v136, s21
    v_perm_b32 v37, v146, v136, s22
    v_perm_b32 v38, v147, v137, s21
    v_perm_b32 v39, v147, v137, s22
    v_perm_b32 v40, v148, v138, s21
    v_perm_b32 v41, v148, v138, s22
    v_perm_b32 v42, v149, v139, s21
    v_perm_b32 v43, v149, v139, s22
    v_perm_b32 v44, v150, v140, s21
    v_perm_b32 v45, v150, v140, s22
    v_perm_b32 v46, v151, v141, s21
    v_perm_b32 v47, v151, v141, s22
    v_perm_b32 v48, v152, v142, s21
    v_perm_b32 v49, v152, v142, s22
    v_perm_b32 v50, v153, v143, s21
    v_perm_b32 v51, v153, v143, s22
    v_perm_b32 v52, v154, v144, s21
    v_perm_b32 v53, v154, v144, s22
    v_dot2c_f32_bf16 v216, v36, v211
    v_dot2c_f32_bf16 v217, v37, v211
    v_dot2c_f32_bf16 v218, v38, v211
    v_dot2c_f32_bf16 v219, v39, v211
    v_dot2c_f32_bf16 v220, v40, v211
    v_dot2c_f32_bf16 v221, v41, v211
    v_dot2c_f32_bf16 v222, v42, v211
    v_dot2c_f32_bf16 v223, v43, v211
    v_dot2c_f32_bf16 v224, v44, v211
    v_dot2c_f32_bf16 v225, v45, v211
    v_dot2c_f32_bf16 v226, v46, v211
    v_dot2c_f32_bf16 v227, v47, v211
    v_dot2c_f32_bf16 v228, v48, v211
    v_dot2c_f32_bf16 v229, v49, v211
    v_dot2c_f32_bf16 v230, v50, v211
    v_dot2c_f32_bf16 v231, v51, v211
    v_dot2c_f32_bf16 v232, v52, v211
    v_dot2c_f32_bf16 v233, v53, v211
    v_perm_b32 v36, v166, v156, s21
    v_perm_b32 v37, v166, v156, s22
    v_perm_b32 v38, v167, v157, s21
    v_perm_b32 v39, v167, v157, s22
    v_perm_b32 v40, v168, v158, s21
    v_perm_b32 v41, v168, v158, s22
    v_perm_b32 v42, v169, v159, s21
    v_perm_b32 v43, v169, v159, s22
    v_perm_b32 v44, v170, v160, s21
    v_perm_b32 v45, v170, v160, s22
    v_perm_b32 v46, v171, v161, s21
    v_perm_b32 v47, v171, v161, s22
    v_perm_b32 v48, v172, v162, s21
    v_perm_b32 v49, v172, v162, s22
    v_perm_b32 v50, v173, v163, s21
    v_perm_b32 v51, v173, v163, s22
    v_perm_b32 v52, v174, v164, s21
    v_perm_b32 v53, v174, v164, s22
    v_dot2c_f32_bf16 v216, v36, v212
    v_dot2c_f32_bf16 v217, v37, v212
    v_dot2c_f32_bf16 v218, v38, v212
    v_dot2c_f32_bf16 v219, v39, v212
    v_dot2c_f32_bf16 v220, v40, v212
    v_dot2c_f32_bf16 v221, v41, v212
    v_dot2c_f32_bf16 v222, v42, v212
    v_dot2c_f32_bf16 v223, v43, v212
    v_dot2c_f32_bf16 v224, v44, v212
    v_dot2c_f32_bf16 v225, v45, v212
    v_dot2c_f32_bf16 v226, v46, v212
    v_dot2c_f32_bf16 v227, v47, v212
    v_dot2c_f32_bf16 v228, v48, v212
    v_dot2c_f32_bf16 v229, v49, v212
    v_dot2c_f32_bf16 v230, v50, v212
    v_dot2c_f32_bf16 v231, v51, v212
    v_dot2c_f32_bf16 v232, v52, v212
    v_dot2c_f32_bf16 v233, v53, v212
    v_perm_b32 v36, v186, v176, s21
    v_perm_b32 v37, v186, v176, s22
    v_perm_b32 v38, v187, v177, s21
    v_perm_b32 v39, v187, v177, s22
    v_perm_b32 v40, v188, v178, s21
    v_perm_b32 v41, v188, v178, s22
    v_perm_b32 v42, v189, v179, s21
    v_perm_b32 v43, v189, v179, s22
    v_perm_b32 v44, v190, v180, s21
    v_perm_b32 v45, v190, v180, s22
    v_perm_b32 v46, v191, v181, s21
    v_perm_b32 v47, v191, v181, s22
    v_perm_b32 v48, v192, v182, s21
    v_perm_b32 v49, v192, v182, s22
    v_perm_b32 v50, v193, v183, s21
    v_perm_b32 v51, v193, v183, s22
    v_perm_b32 v52, v194, v184, s21
    v_perm_b32 v53, v194, v184, s22
    v_dot2c_f32_bf16 v216, v36, v213
    v_dot2c_f32_bf16 v217, v37, v213
    v_dot2c_f32_bf16 v218, v38, v213
    v_dot2c_f32_bf16 v219, v39, v213
    v_dot2c_f32_bf16 v220, v40, v213
    v_dot2c_f32_bf16 v221, v41, v213
    v_dot2c_f32_bf16 v222, v42, v213
    v_dot2c_f32_bf16 v223, v43, v213
    v_dot2c_f32_bf16 v224, v44, v213
    v_dot2c_f32_bf16 v225, v45, v213
    v_dot2c_f32_bf16 v226, v46, v213
    v_dot2c_f32_bf16 v227, v47, v213
    v_dot2c_f32_bf16 v228, v48, v213
    v_dot2c_f32_bf16 v229, v49, v213
    v_dot2c_f32_bf16 v230, v50, v213
    v_dot2c_f32_bf16 v231, v51, v213
    v_dot2c_f32_bf16 v232, v52, v213
    v_dot2c_f32_bf16 v233, v53, v213
    v_cvt_pk_bf16_f32 v24, v216, v217
    v_cvt_pk_bf16_f32 v25, v218, v219
    v_cvt_pk_bf16_f32 v26, v220, v221
    v_cvt_pk_bf16_f32 v27, v222, v223
    v_cvt_pk_bf16_f32 v28, v224, v225
    v_cvt_pk_bf16_f32 v29, v226, v227
    v_cvt_pk_bf16_f32 v30, v228, v229
    v_cvt_pk_bf16_f32 v31, v230, v231
    v_cvt_pk_bf16_f32 v32, v232, v233
    ds_write_b64 v3, v[24:25] offset:6160
    ds_write_b64 v3, v[26:27] offset:6168
    ds_write_b64 v3, v[28:29] offset:6176
    ds_write_b64 v3, v[30:31] offset:6184
    ds_write_b32 v2, v32 offset:6160
    s_waitcnt lgkmcnt(0)
    s_barrier
    ds_read_b64 v[36:37], v13 offset:0
    ds_read_b64 v[38:39], v13 offset:8
    ds_read_b64 v[40:41], v13 offset:64
    ds_read_b64 v[42:43], v13 offset:72
    ds_read_b64 v[44:45], v13 offset:128
    ds_read_b64 v[46:47], v13 offset:136
    s_waitcnt lgkmcnt(4)
    buffer_store_dwordx4 v[36:39], v12, s[16:19], s20 offen offset:0 sc1
    s_waitcnt lgkmcnt(2)
    buffer_store_dwordx4 v[40:43], v12, s[16:19], s20 offen offset:1024 sc1
    s_waitcnt lgkmcnt(0)
    s_mov_b64 exec, 0xffff
    buffer_store_dwordx4 v[44:47], v12, s[16:19], s20 offen offset:2048 sc1
    s_mov_b64 exec, -1
    s_branch parallel_sum__sliding_local_dilated__mixer_gmlp__prompt_kernel_g2X8
parallel_sum__sliding_local_dilated__mixer_gmlp__prompt_kernel_g2X8:
    s_cmp_ge_u32 s33, 4
    s_cbranch_scc1 parallel_sum__sliding_local_dilated__mixer_gmlp__prompt_kernel_g2D27
parallel_sum__sliding_local_dilated__mixer_gmlp__prompt_kernel_g2C5:
    s_load_dwordx2 s[66:67], s[0:1], 64
    v_mbcnt_lo_u32_b32 v251, -1, 0
    v_mbcnt_hi_u32_b32 v251, -1, v251
    v_lshlrev_b32 v251, 4, v251
    s_and_b32 s40, s33, 1
    s_lshr_b32 s41, s33, 1
    v_bfe_u32 v238, v251, 4, 4
    v_lshrrev_b32 v239, 8, v251
    v_lshrrev_b32 v248, 1, v238
    v_xor_b32 v248, v239, v248
    v_lshlrev_b32 v248, 4, v248
    v_lshl_add_u32 v248, v238, 7, v248
    s_lshl_b32 s42, s40, 13
    v_add_u32 v248, s42, v248
    v_xor_b32 v249, 64, v248
    s_lshl_b32 s43, s41, 13
    s_add_u32 s43, s43, 16384
    v_add_u32 v250, s43, v251
    s_cmp_eq_u32 s41, 0
    s_cselect_b64 vcc, -1, 0
    s_mov_b32 s59, 0
    s_mov_b32 s57, 34816
    s_mov_b32 s56, 0xfffef000
    s_barrier
    ds_read_b128 v[0:3], v248 offset:0
    ds_read_b128 v[4:7], v248 offset:2048
    ds_read_b128 v[8:11], v248 offset:4096
    ds_read_b128 v[12:15], v248 offset:6144
    ds_read_b128 v[16:19], v250 offset:0
    ds_read_b128 v[20:23], v250 offset:2048
    ds_read_b128 v[24:27], v250 offset:4096
    ds_read_b128 v[28:31], v250 offset:6144
    ds_read_b128 v[32:35], v250 offset:16384
    ds_read_b128 v[36:39], v249 offset:0
    ds_read_b128 v[40:43], v249 offset:2048
    ds_read_b128 v[44:47], v249 offset:4096
    ds_read_b128 v[48:51], v249 offset:6144
    ds_read_b128 v[52:55], v250 offset:1024
    ds_read_b128 v[56:59], v250 offset:3072
    ds_read_b128 v[60:63], v250 offset:5120
    ds_read_b128 v[64:67], v250 offset:7168
    ds_read_b128 v[68:71], v250 offset:17408
    s_add_u32 s59, s59, 1
    s_cmp_eq_u32 s59, 3
    s_cselect_b32 s59, 0, s59
    s_cselect_b32 s55, s56, s57
    v_add_u32 v248, s55, v248
    v_add_u32 v249, s55, v249
    v_add_u32 v250, s55, v250
    s_and_b32 s38, s34, 3
    s_lshl_b32 s38, s38, 3
    s_and_b32 s39, s35, 7
    s_add_u32 s38, s38, s39
    s_lshr_b32 s39, s34, 2
    s_lshl_b32 s39, s39, 2
    s_lshr_b32 s50, s35, 3
    s_add_u32 s39, s39, s50
    s_lshl_b32 s46, s36, 3
    s_lshl_b32 s47, s40, 2
    s_add_u32 s46, s46, s47
    s_mul_i32 s60, s46, 92160
    s_bfe_u32 s47, s37, 0x10001
    s_lshl_b32 s47, s47, 2
    s_lshr_b32 s48, s37, 2
    s_add_u32 s47, s47, s48
    s_mul_i32 s47, s47, 9216
    s_add_u32 s60, s60, s47
    s_and_b32 s47, s37, 1
    s_lshl_b32 s62, s47, 9
    s_add_u32 s62, s62, s60
    s_add_u32 s62, s62, 26624
    s_lshl_b32 s47, s47, 12
    s_add_u32 s60, s60, s47
    s_lshl_b32 s47, s41, 11
    s_add_u32 s60, s60, s47
    s_add_u32 s60, s60, 18432
    s_mul_i32 s48, s40, 18432
    s_add_u32 s48, s48, 104448
    s_waitcnt lgkmcnt(0)
    s_add_u32 s16, s4, 0x2300000
    s_addc_u32 s17, s5, 0
    s_mov_b32 s18, 0xb40000
    s_mov_b32 s19, 0x20000
    s_mov_b32 s76, s66
    s_mov_b32 s77, s67
    s_mov_b32 s78, 0x240000
    s_mov_b32 s79, 0x20000
    s_add_u32 s84, s4, 0x3450000
    s_addc_u32 s85, s5, 0
    s_mov_b32 s86, 0x24000
    s_mov_b32 s87, 0x20000
    s_lshl_b32 s47, s40, 6
    v_add_lshl_u32 v241, s47, v238, 1
    v_add_u32 v241, 162816, v241
    s_lshl_b32 s47, s40, 5
    s_lshl_b32 s50, s41, 4
    s_add_u32 s47, s47, s50
    v_add_u32 v243, s47, v238
    v_mul_u32_u24 v243, 144, v243
    v_lshl_add_u32 v243, v239, 3, v243
    v_add_u32 v243, 153600, v243
    v_mul_u32_u24 v240, 1152, v238
    v_lshl_add_u32 v240, v239, 3, v240
    s_lshl_b32 s52, s38, 2
    s_lshl_b32 s47, s40, 1
    s_add_u32 s52, s52, s47
    s_add_u32 s52, s52, s41
    s_mul_i32 s47, s52, 18432
    s_mul_i32 s50, s39, 144
    s_add_u32 s47, s47, s50
    v_lshrrev_b32 v242, 1, v239
    v_lshlrev_b32 v242, 8, v242
    v_lshl_add_u32 v242, v238, 4, v242
    v_and_b32 v252, 1, v239
    v_lshl_add_u32 v252, v252, 3, v242
    ds_read_u16 v234, v241 offset:0
    ds_read_u16 v235, v241 offset:32
    ds_read_u16 v236, v241 offset:64
    ds_read_u16 v237, v241 offset:96
    ds_read_b64 v[224:225], v243 offset:0
    ds_read_b64 v[226:227], v243 offset:32
    ds_read_b64 v[228:229], v243 offset:64
    ds_read_b64 v[230:231], v243 offset:96
    ds_read_b64 v[232:233], v243 offset:128
    s_waitcnt lgkmcnt(0)
    s_barrier
    v_mfma_f32_16x16x32_bf16 v[144:147], v[16:19], v[0:3], 0
    ds_read_b128 v[72:75], v248 offset:0
    v_mfma_f32_16x16x32_bf16 v[148:151], v[20:23], v[0:3], 0
    ds_read_b128 v[76:79], v248 offset:2048
    v_mfma_f32_16x16x32_bf16 v[152:155], v[24:27], v[0:3], 0
    ds_read_b128 v[80:83], v248 offset:4096
    v_mfma_f32_16x16x32_bf16 v[156:159], v[28:31], v[0:3], 0
    ds_read_b128 v[84:87], v248 offset:6144
    v_mfma_f32_16x16x32_bf16 v[176:179], v[28:31], v[4:7], 0
    ds_read_b128 v[88:91], v250 offset:0
    v_mfma_f32_16x16x32_bf16 v[172:175], v[24:27], v[4:7], 0
    ds_read_b128 v[92:95], v250 offset:2048
    v_mfma_f32_16x16x32_bf16 v[168:171], v[20:23], v[4:7], 0
    ds_read_b128 v[96:99], v250 offset:4096
    v_mfma_f32_16x16x32_bf16 v[164:167], v[16:19], v[4:7], 0
    ds_read_b128 v[100:103], v250 offset:6144
    v_mfma_f32_16x16x32_bf16 v[184:187], v[16:19], v[8:11], 0
    ds_read_b128 v[104:107], v250 offset:16384
    v_mfma_f32_16x16x32_bf16 v[188:191], v[20:23], v[8:11], 0
    ds_read_b128 v[108:111], v249 offset:0
    v_mfma_f32_16x16x32_bf16 v[192:195], v[24:27], v[8:11], 0
    ds_read_b128 v[112:115], v249 offset:2048
    v_mfma_f32_16x16x32_bf16 v[196:199], v[28:31], v[8:11], 0
    ds_read_b128 v[116:119], v249 offset:4096
    v_mfma_f32_16x16x32_bf16 v[216:219], v[28:31], v[12:15], 0
    ds_read_b128 v[120:123], v249 offset:6144
    v_mfma_f32_16x16x32_bf16 v[212:215], v[24:27], v[12:15], 0
    ds_read_b128 v[124:127], v250 offset:1024
    v_mfma_f32_16x16x32_bf16 v[208:211], v[20:23], v[12:15], 0
    ds_read_b128 v[128:131], v250 offset:3072
    v_mfma_f32_16x16x32_bf16 v[204:207], v[16:19], v[12:15], 0
    ds_read_b128 v[132:135], v250 offset:5120
    s_cbranch_vccz parallel_sum__sliding_local_dilated__mixer_gmlp__prompt_kernel_sk79
    v_mfma_f32_16x16x32_bf16 v[220:223], v[32:35], v[12:15], 0
    v_mfma_f32_16x16x32_bf16 v[200:203], v[32:35], v[8:11], 0
    v_mfma_f32_16x16x32_bf16 v[180:183], v[32:35], v[4:7], 0
    v_mfma_f32_16x16x32_bf16 v[160:163], v[32:35], v[0:3], 0
parallel_sum__sliding_local_dilated__mixer_gmlp__prompt_kernel_sk79:
    v_mfma_f32_16x16x32_bf16 v[144:147], v[52:55], v[36:39], v[144:147]
    ds_read_b128 v[136:139], v250 offset:7168
    v_mfma_f32_16x16x32_bf16 v[148:151], v[56:59], v[36:39], v[148:151]
    ds_read_b128 v[140:143], v250 offset:17408
    v_mfma_f32_16x16x32_bf16 v[152:155], v[60:63], v[36:39], v[152:155]
    s_add_u32 s59, s59, 1
    v_mfma_f32_16x16x32_bf16 v[156:159], v[64:67], v[36:39], v[156:159]
    s_cmp_eq_u32 s59, 3
    v_mfma_f32_16x16x32_bf16 v[176:179], v[64:67], v[40:43], v[176:179]
    s_cselect_b32 s59, 0, s59
    v_mfma_f32_16x16x32_bf16 v[172:175], v[60:63], v[40:43], v[172:175]
    s_cselect_b32 s55, s56, s57
    v_mfma_f32_16x16x32_bf16 v[168:171], v[56:59], v[40:43], v[168:171]
    v_add_u32 v248, s55, v248
    v_mfma_f32_16x16x32_bf16 v[164:167], v[52:55], v[40:43], v[164:167]
    v_add_u32 v249, s55, v249
    v_mfma_f32_16x16x32_bf16 v[184:187], v[52:55], v[44:47], v[184:187]
    v_add_u32 v250, s55, v250
    v_mfma_f32_16x16x32_bf16 v[188:191], v[56:59], v[44:47], v[188:191]
    v_mfma_f32_16x16x32_bf16 v[192:195], v[60:63], v[44:47], v[192:195]
    v_mfma_f32_16x16x32_bf16 v[196:199], v[64:67], v[44:47], v[196:199]
    v_mfma_f32_16x16x32_bf16 v[216:219], v[64:67], v[48:51], v[216:219]
    v_mfma_f32_16x16x32_bf16 v[212:215], v[60:63], v[48:51], v[212:215]
    v_mfma_f32_16x16x32_bf16 v[208:211], v[56:59], v[48:51], v[208:211]
    v_mfma_f32_16x16x32_bf16 v[204:207], v[52:55], v[48:51], v[204:207]
    s_cbranch_vccz parallel_sum__sliding_local_dilated__mixer_gmlp__prompt_kernel_sk80
    v_mfma_f32_16x16x32_bf16 v[220:223], v[68:71], v[48:51], v[220:223]
    v_mfma_f32_16x16x32_bf16 v[200:203], v[68:71], v[44:47], v[200:203]
    v_mfma_f32_16x16x32_bf16 v[180:183], v[68:71], v[40:43], v[180:183]
    v_mfma_f32_16x16x32_bf16 v[160:163], v[68:71], v[36:39], v[160:163]
parallel_sum__sliding_local_dilated__mixer_gmlp__prompt_kernel_sk80:
    s_mov_b32 s58, 15
    s_waitcnt lgkmcnt(0)
parallel_sum__sliding_local_dilated__mixer_gmlp__prompt_kernel_top81:
    s_barrier
    v_mfma_f32_16x16x32_bf16 v[144:147], v[88:91], v[72:75], v[144:147]
    ds_read_b128 v[0:3], v248 offset:0
    v_mfma_f32_16x16x32_bf16 v[148:151], v[92:95], v[72:75], v[148:151]
    ds_read_b128 v[4:7], v248 offset:2048
    v_mfma_f32_16x16x32_bf16 v[152:155], v[96:99], v[72:75], v[152:155]
    ds_read_b128 v[8:11], v248 offset:4096
    v_mfma_f32_16x16x32_bf16 v[156:159], v[100:103], v[72:75], v[156:159]
    ds_read_b128 v[12:15], v248 offset:6144
    v_mfma_f32_16x16x32_bf16 v[176:179], v[100:103], v[76:79], v[176:179]
    ds_read_b128 v[16:19], v250 offset:0
    v_mfma_f32_16x16x32_bf16 v[172:175], v[96:99], v[76:79], v[172:175]
    ds_read_b128 v[20:23], v250 offset:2048
    v_mfma_f32_16x16x32_bf16 v[168:171], v[92:95], v[76:79], v[168:171]
    ds_read_b128 v[24:27], v250 offset:4096
    v_mfma_f32_16x16x32_bf16 v[164:167], v[88:91], v[76:79], v[164:167]
    ds_read_b128 v[28:31], v250 offset:6144
    v_mfma_f32_16x16x32_bf16 v[184:187], v[88:91], v[80:83], v[184:187]
    ds_read_b128 v[32:35], v250 offset:16384
    v_mfma_f32_16x16x32_bf16 v[188:191], v[92:95], v[80:83], v[188:191]
    ds_read_b128 v[36:39], v249 offset:0
    v_mfma_f32_16x16x32_bf16 v[192:195], v[96:99], v[80:83], v[192:195]
    ds_read_b128 v[40:43], v249 offset:2048
    v_mfma_f32_16x16x32_bf16 v[196:199], v[100:103], v[80:83], v[196:199]
    ds_read_b128 v[44:47], v249 offset:4096
    v_mfma_f32_16x16x32_bf16 v[216:219], v[100:103], v[84:87], v[216:219]
    ds_read_b128 v[48:51], v249 offset:6144
    v_mfma_f32_16x16x32_bf16 v[212:215], v[96:99], v[84:87], v[212:215]
    ds_read_b128 v[52:55], v250 offset:1024
    v_mfma_f32_16x16x32_bf16 v[208:211], v[92:95], v[84:87], v[208:211]
    ds_read_b128 v[56:59], v250 offset:3072
    v_mfma_f32_16x16x32_bf16 v[204:207], v[88:91], v[84:87], v[204:207]
    ds_read_b128 v[60:63], v250 offset:5120
    s_cbranch_vccz parallel_sum__sliding_local_dilated__mixer_gmlp__prompt_kernel_sk83
    v_mfma_f32_16x16x32_bf16 v[220:223], v[104:107], v[84:87], v[220:223]
    v_mfma_f32_16x16x32_bf16 v[200:203], v[104:107], v[80:83], v[200:203]
    v_mfma_f32_16x16x32_bf16 v[180:183], v[104:107], v[76:79], v[180:183]
    v_mfma_f32_16x16x32_bf16 v[160:163], v[104:107], v[72:75], v[160:163]
parallel_sum__sliding_local_dilated__mixer_gmlp__prompt_kernel_sk83:
    v_mfma_f32_16x16x32_bf16 v[144:147], v[124:127], v[108:111], v[144:147]
    ds_read_b128 v[64:67], v250 offset:7168
    v_mfma_f32_16x16x32_bf16 v[148:151], v[128:131], v[108:111], v[148:151]
    ds_read_b128 v[68:71], v250 offset:17408
    v_mfma_f32_16x16x32_bf16 v[152:155], v[132:135], v[108:111], v[152:155]
    s_add_u32 s59, s59, 1
    v_mfma_f32_16x16x32_bf16 v[156:159], v[136:139], v[108:111], v[156:159]
    s_cmp_eq_u32 s59, 3
    v_mfma_f32_16x16x32_bf16 v[176:179], v[136:139], v[112:115], v[176:179]
    s_cselect_b32 s59, 0, s59
    v_mfma_f32_16x16x32_bf16 v[172:175], v[132:135], v[112:115], v[172:175]
    s_cselect_b32 s55, s56, s57
    v_mfma_f32_16x16x32_bf16 v[168:171], v[128:131], v[112:115], v[168:171]
    v_add_u32 v248, s55, v248
    v_mfma_f32_16x16x32_bf16 v[164:167], v[124:127], v[112:115], v[164:167]
    v_add_u32 v249, s55, v249
    v_mfma_f32_16x16x32_bf16 v[184:187], v[124:127], v[116:119], v[184:187]
    v_add_u32 v250, s55, v250
    v_mfma_f32_16x16x32_bf16 v[188:191], v[128:131], v[116:119], v[188:191]
    v_mfma_f32_16x16x32_bf16 v[192:195], v[132:135], v[116:119], v[192:195]
    v_mfma_f32_16x16x32_bf16 v[196:199], v[136:139], v[116:119], v[196:199]
    v_mfma_f32_16x16x32_bf16 v[216:219], v[136:139], v[120:123], v[216:219]
    v_mfma_f32_16x16x32_bf16 v[212:215], v[132:135], v[120:123], v[212:215]
    v_mfma_f32_16x16x32_bf16 v[208:211], v[128:131], v[120:123], v[208:211]
    v_mfma_f32_16x16x32_bf16 v[204:207], v[124:127], v[120:123], v[204:207]
    s_cbranch_vccz parallel_sum__sliding_local_dilated__mixer_gmlp__prompt_kernel_sk84
    v_mfma_f32_16x16x32_bf16 v[220:223], v[140:143], v[120:123], v[220:223]
    v_mfma_f32_16x16x32_bf16 v[200:203], v[140:143], v[116:119], v[200:203]
    v_mfma_f32_16x16x32_bf16 v[180:183], v[140:143], v[112:115], v[180:183]
    v_mfma_f32_16x16x32_bf16 v[160:163], v[140:143], v[108:111], v[160:163]
parallel_sum__sliding_local_dilated__mixer_gmlp__prompt_kernel_sk84:
    s_waitcnt lgkmcnt(0)
    s_barrier
    v_mfma_f32_16x16x32_bf16 v[144:147], v[16:19], v[0:3], v[144:147]
    ds_read_b128 v[72:75], v248 offset:0
    v_mfma_f32_16x16x32_bf16 v[148:151], v[20:23], v[0:3], v[148:151]
    ds_read_b128 v[76:79], v248 offset:2048
    v_mfma_f32_16x16x32_bf16 v[152:155], v[24:27], v[0:3], v[152:155]
    ds_read_b128 v[80:83], v248 offset:4096
    v_mfma_f32_16x16x32_bf16 v[156:159], v[28:31], v[0:3], v[156:159]
    ds_read_b128 v[84:87], v248 offset:6144
    v_mfma_f32_16x16x32_bf16 v[176:179], v[28:31], v[4:7], v[176:179]
    ds_read_b128 v[88:91], v250 offset:0
    v_mfma_f32_16x16x32_bf16 v[172:175], v[24:27], v[4:7], v[172:175]
    ds_read_b128 v[92:95], v250 offset:2048
    v_mfma_f32_16x16x32_bf16 v[168:171], v[20:23], v[4:7], v[168:171]
    ds_read_b128 v[96:99], v250 offset:4096
    v_mfma_f32_16x16x32_bf16 v[164:167], v[16:19], v[4:7], v[164:167]
    ds_read_b128 v[100:103], v250 offset:6144
    v_mfma_f32_16x16x32_bf16 v[184:187], v[16:19], v[8:11], v[184:187]
    ds_read_b128 v[104:107], v250 offset:16384
    v_mfma_f32_16x16x32_bf16 v[188:191], v[20:23], v[8:11], v[188:191]
    ds_read_b128 v[108:111], v249 offset:0
    v_mfma_f32_16x16x32_bf16 v[192:195], v[24:27], v[8:11], v[192:195]
    ds_read_b128 v[112:115], v249 offset:2048
    v_mfma_f32_16x16x32_bf16 v[196:199], v[28:31], v[8:11], v[196:199]
    ds_read_b128 v[116:119], v249 offset:4096
    v_mfma_f32_16x16x32_bf16 v[216:219], v[28:31], v[12:15], v[216:219]
    ds_read_b128 v[120:123], v249 offset:6144
    v_mfma_f32_16x16x32_bf16 v[212:215], v[24:27], v[12:15], v[212:215]
    ds_read_b128 v[124:127], v250 offset:1024
    v_mfma_f32_16x16x32_bf16 v[208:211], v[20:23], v[12:15], v[208:211]
    ds_read_b128 v[128:131], v250 offset:3072
    v_mfma_f32_16x16x32_bf16 v[204:207], v[16:19], v[12:15], v[204:207]
    ds_read_b128 v[132:135], v250 offset:5120
    s_cbranch_vccz parallel_sum__sliding_local_dilated__mixer_gmlp__prompt_kernel_sk85
    v_mfma_f32_16x16x32_bf16 v[220:223], v[32:35], v[12:15], v[220:223]
    v_mfma_f32_16x16x32_bf16 v[200:203], v[32:35], v[8:11], v[200:203]
    v_mfma_f32_16x16x32_bf16 v[180:183], v[32:35], v[4:7], v[180:183]
    v_mfma_f32_16x16x32_bf16 v[160:163], v[32:35], v[0:3], v[160:163]
parallel_sum__sliding_local_dilated__mixer_gmlp__prompt_kernel_sk85:
    v_mfma_f32_16x16x32_bf16 v[144:147], v[52:55], v[36:39], v[144:147]
    ds_read_b128 v[136:139], v250 offset:7168
    v_mfma_f32_16x16x32_bf16 v[148:151], v[56:59], v[36:39], v[148:151]
    ds_read_b128 v[140:143], v250 offset:17408
    v_mfma_f32_16x16x32_bf16 v[152:155], v[60:63], v[36:39], v[152:155]
    s_add_u32 s59, s59, 1
    v_mfma_f32_16x16x32_bf16 v[156:159], v[64:67], v[36:39], v[156:159]
    s_cmp_eq_u32 s59, 3
    v_mfma_f32_16x16x32_bf16 v[176:179], v[64:67], v[40:43], v[176:179]
    s_cselect_b32 s59, 0, s59
    v_mfma_f32_16x16x32_bf16 v[172:175], v[60:63], v[40:43], v[172:175]
    s_cselect_b32 s55, s56, s57
    v_mfma_f32_16x16x32_bf16 v[168:171], v[56:59], v[40:43], v[168:171]
    v_add_u32 v248, s55, v248
    v_mfma_f32_16x16x32_bf16 v[164:167], v[52:55], v[40:43], v[164:167]
    v_add_u32 v249, s55, v249
    v_mfma_f32_16x16x32_bf16 v[184:187], v[52:55], v[44:47], v[184:187]
    v_add_u32 v250, s55, v250
    v_mfma_f32_16x16x32_bf16 v[188:191], v[56:59], v[44:47], v[188:191]
    s_sub_u32 s58, s58, 1
    v_mfma_f32_16x16x32_bf16 v[192:195], v[60:63], v[44:47], v[192:195]
    s_cmp_lg_u32 s58, 0
    v_mfma_f32_16x16x32_bf16 v[196:199], v[64:67], v[44:47], v[196:199]
    v_mfma_f32_16x16x32_bf16 v[216:219], v[64:67], v[48:51], v[216:219]
    v_mfma_f32_16x16x32_bf16 v[212:215], v[60:63], v[48:51], v[212:215]
    v_mfma_f32_16x16x32_bf16 v[208:211], v[56:59], v[48:51], v[208:211]
    v_mfma_f32_16x16x32_bf16 v[204:207], v[52:55], v[48:51], v[204:207]
    s_cbranch_vccz parallel_sum__sliding_local_dilated__mixer_gmlp__prompt_kernel_sk86
    v_mfma_f32_16x16x32_bf16 v[220:223], v[68:71], v[48:51], v[220:223]
    v_mfma_f32_16x16x32_bf16 v[200:203], v[68:71], v[44:47], v[200:203]
    v_mfma_f32_16x16x32_bf16 v[180:183], v[68:71], v[40:43], v[180:183]
    v_mfma_f32_16x16x32_bf16 v[160:163], v[68:71], v[36:39], v[160:163]
parallel_sum__sliding_local_dilated__mixer_gmlp__prompt_kernel_sk86:
    s_waitcnt vmcnt(0) lgkmcnt(0)
    s_cbranch_scc1 parallel_sum__sliding_local_dilated__mixer_gmlp__prompt_kernel_top81
parallel_sum__sliding_local_dilated__mixer_gmlp__prompt_kernel_ex82:
    s_barrier
    s_lshl_b32 s50, s41, 11
    s_add_u32 s50, s50, s48
    v_add_u32 v248, s50, v251
    v_add_u32 v249, s48, v252
    v_mfma_f32_16x16x32_bf16 v[144:147], v[88:91], v[72:75], v[144:147]
    ds_read_b128 v[0:3], v248 offset:0
    v_mfma_f32_16x16x32_bf16 v[148:151], v[92:95], v[72:75], v[148:151]
    ds_read_b128 v[4:7], v248 offset:1024
    v_mfma_f32_16x16x32_bf16 v[152:155], v[96:99], v[72:75], v[152:155]
    ds_read_b64 v[8:9], v249 offset:4096
    v_mfma_f32_16x16x32_bf16 v[156:159], v[100:103], v[72:75], v[156:159]
    ds_read_b128 v[10:13], v248 offset:4608
    v_mfma_f32_16x16x32_bf16 v[176:179], v[100:103], v[76:79], v[176:179]
    ds_read_b128 v[14:17], v248 offset:5632
    v_mfma_f32_16x16x32_bf16 v[172:175], v[96:99], v[76:79], v[172:175]
    ds_read_b64 v[18:19], v249 offset:8704
    v_mfma_f32_16x16x32_bf16 v[168:171], v[92:95], v[76:79], v[168:171]
    ds_read_b128 v[20:23], v248 offset:9216
    v_mfma_f32_16x16x32_bf16 v[164:167], v[88:91], v[76:79], v[164:167]
    ds_read_b128 v[24:27], v248 offset:10240
    v_mfma_f32_16x16x32_bf16 v[184:187], v[88:91], v[80:83], v[184:187]
    ds_read_b64 v[28:29], v249 offset:13312
    v_mfma_f32_16x16x32_bf16 v[188:191], v[92:95], v[80:83], v[188:191]
    ds_read_b128 v[30:33], v248 offset:13824
    v_mfma_f32_16x16x32_bf16 v[192:195], v[96:99], v[80:83], v[192:195]
    ds_read_b128 v[34:37], v248 offset:14848
    v_mfma_f32_16x16x32_bf16 v[196:199], v[100:103], v[80:83], v[196:199]
    ds_read_b64 v[38:39], v249 offset:17920
    v_mfma_f32_16x16x32_bf16 v[216:219], v[100:103], v[84:87], v[216:219]
    v_mfma_f32_16x16x32_bf16 v[212:215], v[96:99], v[84:87], v[212:215]
    v_mfma_f32_16x16x32_bf16 v[208:211], v[92:95], v[84:87], v[208:211]
    v_mfma_f32_16x16x32_bf16 v[204:207], v[88:91], v[84:87], v[204:207]
    s_cbranch_vccz parallel_sum__sliding_local_dilated__mixer_gmlp__prompt_kernel_sk87
    v_mfma_f32_16x16x32_bf16 v[220:223], v[104:107], v[84:87], v[220:223]
    v_mfma_f32_16x16x32_bf16 v[200:203], v[104:107], v[80:83], v[200:203]
    v_mfma_f32_16x16x32_bf16 v[180:183], v[104:107], v[76:79], v[180:183]
    v_mfma_f32_16x16x32_bf16 v[160:163], v[104:107], v[72:75], v[160:163]
parallel_sum__sliding_local_dilated__mixer_gmlp__prompt_kernel_sk87:
    v_mfma_f32_16x16x32_bf16 v[144:147], v[124:127], v[108:111], v[144:147]
    v_lshlrev_b32 v40, 16, v234
    v_mfma_f32_16x16x32_bf16 v[148:151], v[128:131], v[108:111], v[148:151]
    v_lshlrev_b32 v41, 16, v234
    v_mfma_f32_16x16x32_bf16 v[152:155], v[132:135], v[108:111], v[152:155]
    v_lshlrev_b32 v42, 16, v235
    v_mfma_f32_16x16x32_bf16 v[156:159], v[136:139], v[108:111], v[156:159]
    v_lshlrev_b32 v43, 16, v235
    v_mfma_f32_16x16x32_bf16 v[176:179], v[136:139], v[112:115], v[176:179]
    v_lshlrev_b32 v44, 16, v236
    v_mfma_f32_16x16x32_bf16 v[172:175], v[132:135], v[112:115], v[172:175]
    v_lshlrev_b32 v45, 16, v236
    v_mfma_f32_16x16x32_bf16 v[168:171], v[128:131], v[112:115], v[168:171]
    v_lshlrev_b32 v46, 16, v237
    v_mfma_f32_16x16x32_bf16 v[164:167], v[124:127], v[112:115], v[164:167]
    v_lshlrev_b32 v47, 16, v237
    v_mfma_f32_16x16x32_bf16 v[184:187], v[124:127], v[116:119], v[184:187]
    v_mfma_f32_16x16x32_bf16 v[188:191], v[128:131], v[116:119], v[188:191]
    v_mfma_f32_16x16x32_bf16 v[192:195], v[132:135], v[116:119], v[192:195]
    v_mfma_f32_16x16x32_bf16 v[196:199], v[136:139], v[116:119], v[196:199]
    v_mfma_f32_16x16x32_bf16 v[216:219], v[136:139], v[120:123], v[216:219]
    v_mfma_f32_16x16x32_bf16 v[212:215], v[132:135], v[120:123], v[212:215]
    v_mfma_f32_16x16x32_bf16 v[208:211], v[128:131], v[120:123], v[208:211]
    v_mfma_f32_16x16x32_bf16 v[204:207], v[124:127], v[120:123], v[204:207]
    s_cbranch_vccz parallel_sum__sliding_local_dilated__mixer_gmlp__prompt_kernel_sk88
    v_mfma_f32_16x16x32_bf16 v[220:223], v[140:143], v[120:123], v[220:223]
    v_mfma_f32_16x16x32_bf16 v[200:203], v[140:143], v[116:119], v[200:203]
    v_mfma_f32_16x16x32_bf16 v[180:183], v[140:143], v[112:115], v[180:183]
    v_mfma_f32_16x16x32_bf16 v[160:163], v[140:143], v[108:111], v[160:163]
parallel_sum__sliding_local_dilated__mixer_gmlp__prompt_kernel_sk88:
    s_lshl_b32 s42, s40, 12
    s_lshl_b32 s43, s41, 10
    s_add_u32 s42, s42, s43
    s_add_u32 s42, s42, 69632
    s_lshl_b32 s44, s41, 11
    s_add_u32 s45, s42, s44
    v_add_u32 v241, s45, v251
    s_xor_b32 s44, s44, 2048
    s_add_u32 s45, s42, s44
    v_add_u32 v242, s45, v251
    s_add_u32 s45, s43, 77824
    v_add_u32 v243, s45, v251
    v_and_b32 v238, 7, v238
    v_lshl_add_u32 v238, v239, 3, v238
    v_lshlrev_b32 v238, 4, v238
    s_lshl_b32 s45, s41, 9
    s_add_u32 s45, s45, 86016
    v_add_u32 v244, s45, v238
    s_waitcnt lgkmcnt(0)
    v_pk_add_f32 v[144:145], v[144:145], v[40:41]
    v_pk_add_f32 v[146:147], v[146:147], v[40:41]
    v_lshlrev_b32 v48, 16, v0
    v_and_b32 v49, 0xffff0000, v0
    v_lshlrev_b32 v50, 16, v1
    v_and_b32 v51, 0xffff0000, v1
    v_pk_mul_f32 v[144:145], v[144:145], v[48:49]
    v_pk_mul_f32 v[146:147], v[146:147], v[50:51]
    v_cvt_pk_bf16_f32 v0, v144, v145
    v_cvt_pk_bf16_f32 v1, v146, v147
    v_pk_add_f32 v[148:149], v[148:149], v[40:41]
    v_pk_add_f32 v[150:151], v[150:151], v[40:41]
    v_lshlrev_b32 v52, 16, v2
    v_and_b32 v53, 0xffff0000, v2
    v_lshlrev_b32 v54, 16, v3
    v_and_b32 v55, 0xffff0000, v3
    v_pk_mul_f32 v[148:149], v[148:149], v[52:53]
    v_pk_mul_f32 v[150:151], v[150:151], v[54:55]
    v_cvt_pk_bf16_f32 v2, v148, v149
    v_cvt_pk_bf16_f32 v3, v150, v151
    buffer_store_dwordx4 v[0:3], v251, s[16:19], s60 offen offset:0 sc1
    v_pk_add_f32 v[152:153], v[152:153], v[40:41]
    v_pk_add_f32 v[154:155], v[154:155], v[40:41]
    v_lshlrev_b32 v48, 16, v4
    v_and_b32 v49, 0xffff0000, v4
    v_lshlrev_b32 v50, 16, v5
    v_and_b32 v51, 0xffff0000, v5
    v_pk_mul_f32 v[152:153], v[152:153], v[48:49]
    v_pk_mul_f32 v[154:155], v[154:155], v[50:51]
    v_cvt_pk_bf16_f32 v4, v152, v153
    v_cvt_pk_bf16_f32 v5, v154, v155
    v_pk_add_f32 v[156:157], v[156:157], v[40:41]
    v_pk_add_f32 v[158:159], v[158:159], v[40:41]
    v_lshlrev_b32 v52, 16, v6
    v_and_b32 v53, 0xffff0000, v6
    v_lshlrev_b32 v54, 16, v7
    v_and_b32 v55, 0xffff0000, v7
    v_pk_mul_f32 v[156:157], v[156:157], v[52:53]
    v_pk_mul_f32 v[158:159], v[158:159], v[54:55]
    v_cvt_pk_bf16_f32 v6, v156, v157
    v_cvt_pk_bf16_f32 v7, v158, v159
    buffer_store_dwordx4 v[4:7], v251, s[16:19], s60 offen offset:1024 sc1
    s_add_u32 s60, s60, 92160
    v_pk_add_f32 v[164:165], v[164:165], v[42:43]
    v_pk_add_f32 v[166:167], v[166:167], v[42:43]
    v_lshlrev_b32 v48, 16, v10
    v_and_b32 v49, 0xffff0000, v10
    v_lshlrev_b32 v50, 16, v11
    v_and_b32 v51, 0xffff0000, v11
    v_pk_mul_f32 v[164:165], v[164:165], v[48:49]
    v_pk_mul_f32 v[166:167], v[166:167], v[50:51]
    v_cvt_pk_bf16_f32 v10, v164, v165
    v_cvt_pk_bf16_f32 v11, v166, v167
    v_pk_add_f32 v[168:169], v[168:169], v[42:43]
    v_pk_add_f32 v[170:171], v[170:171], v[42:43]
    v_lshlrev_b32 v52, 16, v12
    v_and_b32 v53, 0xffff0000, v12
    v_lshlrev_b32 v54, 16, v13
    v_and_b32 v55, 0xffff0000, v13
    v_pk_mul_f32 v[168:169], v[168:169], v[52:53]
    v_pk_mul_f32 v[170:171], v[170:171], v[54:55]
    v_cvt_pk_bf16_f32 v12, v168, v169
    v_cvt_pk_bf16_f32 v13, v170, v171
    buffer_store_dwordx4 v[10:13], v251, s[16:19], s60 offen offset:0 sc1
    v_pk_add_f32 v[172:173], v[172:173], v[42:43]
    v_pk_add_f32 v[174:175], v[174:175], v[42:43]
    v_lshlrev_b32 v48, 16, v14
    v_and_b32 v49, 0xffff0000, v14
    v_lshlrev_b32 v50, 16, v15
    v_and_b32 v51, 0xffff0000, v15
    v_pk_mul_f32 v[172:173], v[172:173], v[48:49]
    v_pk_mul_f32 v[174:175], v[174:175], v[50:51]
    v_cvt_pk_bf16_f32 v14, v172, v173
    v_cvt_pk_bf16_f32 v15, v174, v175
    v_pk_add_f32 v[176:177], v[176:177], v[42:43]
    v_pk_add_f32 v[178:179], v[178:179], v[42:43]
    v_lshlrev_b32 v52, 16, v16
    v_and_b32 v53, 0xffff0000, v16
    v_lshlrev_b32 v54, 16, v17
    v_and_b32 v55, 0xffff0000, v17
    v_pk_mul_f32 v[176:177], v[176:177], v[52:53]
    v_pk_mul_f32 v[178:179], v[178:179], v[54:55]
    v_cvt_pk_bf16_f32 v16, v176, v177
    v_cvt_pk_bf16_f32 v17, v178, v179
    buffer_store_dwordx4 v[14:17], v251, s[16:19], s60 offen offset:1024 sc1
    s_add_u32 s60, s60, 92160
    v_pk_add_f32 v[184:185], v[184:185], v[44:45]
    v_pk_add_f32 v[186:187], v[186:187], v[44:45]
    v_lshlrev_b32 v48, 16, v20
    v_and_b32 v49, 0xffff0000, v20
    v_lshlrev_b32 v50, 16, v21
    v_and_b32 v51, 0xffff0000, v21
    v_pk_mul_f32 v[184:185], v[184:185], v[48:49]
    v_pk_mul_f32 v[186:187], v[186:187], v[50:51]
    v_cvt_pk_bf16_f32 v20, v184, v185
    v_cvt_pk_bf16_f32 v21, v186, v187
    v_pk_add_f32 v[188:189], v[188:189], v[44:45]
    v_pk_add_f32 v[190:191], v[190:191], v[44:45]
    v_lshlrev_b32 v52, 16, v22
    v_and_b32 v53, 0xffff0000, v22
    v_lshlrev_b32 v54, 16, v23
    v_and_b32 v55, 0xffff0000, v23
    v_pk_mul_f32 v[188:189], v[188:189], v[52:53]
    v_pk_mul_f32 v[190:191], v[190:191], v[54:55]
    v_cvt_pk_bf16_f32 v22, v188, v189
    v_cvt_pk_bf16_f32 v23, v190, v191
    buffer_store_dwordx4 v[20:23], v251, s[16:19], s60 offen offset:0 sc1
    v_pk_add_f32 v[192:193], v[192:193], v[44:45]
    v_pk_add_f32 v[194:195], v[194:195], v[44:45]
    v_lshlrev_b32 v48, 16, v24
    v_and_b32 v49, 0xffff0000, v24
    v_lshlrev_b32 v50, 16, v25
    v_and_b32 v51, 0xffff0000, v25
    v_pk_mul_f32 v[192:193], v[192:193], v[48:49]
    v_pk_mul_f32 v[194:195], v[194:195], v[50:51]
    v_cvt_pk_bf16_f32 v24, v192, v193
    v_cvt_pk_bf16_f32 v25, v194, v195
    v_pk_add_f32 v[196:197], v[196:197], v[44:45]
    v_pk_add_f32 v[198:199], v[198:199], v[44:45]
    v_lshlrev_b32 v52, 16, v26
    v_and_b32 v53, 0xffff0000, v26
    v_lshlrev_b32 v54, 16, v27
    v_and_b32 v55, 0xffff0000, v27
    v_pk_mul_f32 v[196:197], v[196:197], v[52:53]
    v_pk_mul_f32 v[198:199], v[198:199], v[54:55]
    v_cvt_pk_bf16_f32 v26, v196, v197
    v_cvt_pk_bf16_f32 v27, v198, v199
    buffer_store_dwordx4 v[24:27], v251, s[16:19], s60 offen offset:1024 sc1
    s_add_u32 s60, s60, 92160
    v_pk_add_f32 v[204:205], v[204:205], v[46:47]
    v_pk_add_f32 v[206:207], v[206:207], v[46:47]
    v_lshlrev_b32 v48, 16, v30
    v_and_b32 v49, 0xffff0000, v30
    v_lshlrev_b32 v50, 16, v31
    v_and_b32 v51, 0xffff0000, v31
    v_pk_mul_f32 v[204:205], v[204:205], v[48:49]
    v_pk_mul_f32 v[206:207], v[206:207], v[50:51]
    v_cvt_pk_bf16_f32 v30, v204, v205
    v_cvt_pk_bf16_f32 v31, v206, v207
    v_pk_add_f32 v[208:209], v[208:209], v[46:47]
    v_pk_add_f32 v[210:211], v[210:211], v[46:47]
    v_lshlrev_b32 v52, 16, v32
    v_and_b32 v53, 0xffff0000, v32
    v_lshlrev_b32 v54, 16, v33
    v_and_b32 v55, 0xffff0000, v33
    v_pk_mul_f32 v[208:209], v[208:209], v[52:53]
    v_pk_mul_f32 v[210:211], v[210:211], v[54:55]
    v_cvt_pk_bf16_f32 v32, v208, v209
    v_cvt_pk_bf16_f32 v33, v210, v211
    buffer_store_dwordx4 v[30:33], v251, s[16:19], s60 offen offset:0 sc1
    v_pk_add_f32 v[212:213], v[212:213], v[46:47]
    v_pk_add_f32 v[214:215], v[214:215], v[46:47]
    v_lshlrev_b32 v48, 16, v34
    v_and_b32 v49, 0xffff0000, v34
    v_lshlrev_b32 v50, 16, v35
    v_and_b32 v51, 0xffff0000, v35
    v_pk_mul_f32 v[212:213], v[212:213], v[48:49]
    v_pk_mul_f32 v[214:215], v[214:215], v[50:51]
    v_cvt_pk_bf16_f32 v34, v212, v213
    v_cvt_pk_bf16_f32 v35, v214, v215
    v_pk_add_f32 v[216:217], v[216:217], v[46:47]
    v_pk_add_f32 v[218:219], v[218:219], v[46:47]
    v_lshlrev_b32 v52, 16, v36
    v_and_b32 v53, 0xffff0000, v36
    v_lshlrev_b32 v54, 16, v37
    v_and_b32 v55, 0xffff0000, v37
    v_pk_mul_f32 v[216:217], v[216:217], v[52:53]
    v_pk_mul_f32 v[218:219], v[218:219], v[54:55]
    v_cvt_pk_bf16_f32 v36, v216, v217
    v_cvt_pk_bf16_f32 v37, v218, v219
    buffer_store_dwordx4 v[34:37], v251, s[16:19], s60 offen offset:1024 sc1
    s_cbranch_vccz parallel_sum__sliding_local_dilated__mixer_gmlp__prompt_kernel_es89
    v_pk_add_f32 v[160:161], v[160:161], v[40:41]
    v_pk_add_f32 v[162:163], v[162:163], v[40:41]
    v_lshlrev_b32 v48, 16, v8
    v_and_b32 v49, 0xffff0000, v8
    v_lshlrev_b32 v50, 16, v9
    v_and_b32 v51, 0xffff0000, v9
    v_pk_mul_f32 v[160:161], v[160:161], v[48:49]
    v_pk_mul_f32 v[162:163], v[162:163], v[50:51]
    v_cvt_pk_bf16_f32 v8, v160, v161
    v_cvt_pk_bf16_f32 v9, v162, v163
    buffer_store_dwordx2 v[8:9], v252, s[16:19], s62 offen sc1
    s_add_u32 s62, s62, 92160
    v_pk_add_f32 v[180:181], v[180:181], v[42:43]
    v_pk_add_f32 v[182:183], v[182:183], v[42:43]
    v_lshlrev_b32 v52, 16, v18
    v_and_b32 v53, 0xffff0000, v18
    v_lshlrev_b32 v54, 16, v19
    v_and_b32 v55, 0xffff0000, v19
    v_pk_mul_f32 v[180:181], v[180:181], v[52:53]
    v_pk_mul_f32 v[182:183], v[182:183], v[54:55]
    v_cvt_pk_bf16_f32 v18, v180, v181
    v_cvt_pk_bf16_f32 v19, v182, v183
    buffer_store_dwordx2 v[18:19], v252, s[16:19], s62 offen sc1
    s_add_u32 s62, s62, 92160
    v_pk_add_f32 v[200:201], v[200:201], v[44:45]
    v_pk_add_f32 v[202:203], v[202:203], v[44:45]
    v_lshlrev_b32 v48, 16, v28
    v_and_b32 v49, 0xffff0000, v28
    v_lshlrev_b32 v50, 16, v29
    v_and_b32 v51, 0xffff0000, v29
    v_pk_mul_f32 v[200:201], v[200:201], v[48:49]
    v_pk_mul_f32 v[202:203], v[202:203], v[50:51]
    v_cvt_pk_bf16_f32 v28, v200, v201
    v_cvt_pk_bf16_f32 v29, v202, v203
    buffer_store_dwordx2 v[28:29], v252, s[16:19], s62 offen sc1
    s_add_u32 s62, s62, 92160
    v_pk_add_f32 v[220:221], v[220:221], v[46:47]
    v_pk_add_f32 v[222:223], v[222:223], v[46:47]
    v_lshlrev_b32 v52, 16, v38
    v_and_b32 v53, 0xffff0000, v38
    v_lshlrev_b32 v54, 16, v39
    v_and_b32 v55, 0xffff0000, v39
    v_pk_mul_f32 v[220:221], v[220:221], v[52:53]
    v_pk_mul_f32 v[222:223], v[222:223], v[54:55]
    v_cvt_pk_bf16_f32 v38, v220, v221
    v_cvt_pk_bf16_f32 v39, v222, v223
    buffer_store_dwordx2 v[38:39], v252, s[16:19], s62 offen sc1
parallel_sum__sliding_local_dilated__mixer_gmlp__prompt_kernel_es89:
    v_lshlrev_b32 v144, 16, v224
    v_and_b32 v145, 0xffff0000, v224
    v_lshlrev_b32 v146, 16, v225
    v_and_b32 v147, 0xffff0000, v225
    v_lshlrev_b32 v148, 16, v226
    v_and_b32 v149, 0xffff0000, v226
    v_lshlrev_b32 v150, 16, v227
    v_and_b32 v151, 0xffff0000, v227
    v_lshlrev_b32 v152, 16, v228
    v_and_b32 v153, 0xffff0000, v228
    v_lshlrev_b32 v154, 16, v229
    v_and_b32 v155, 0xffff0000, v229
    v_lshlrev_b32 v156, 16, v230
    v_and_b32 v157, 0xffff0000, v230
    v_lshlrev_b32 v158, 16, v231
    v_and_b32 v159, 0xffff0000, v231
    v_lshlrev_b32 v160, 16, v232
    v_and_b32 v161, 0xffff0000, v232
    v_lshlrev_b32 v162, 16, v233
    v_and_b32 v163, 0xffff0000, v233
    v_mov_b32 v164, 0
    v_mov_b32 v165, 0
    v_mov_b32 v166, 0
    v_mov_b32 v167, 0
    v_mov_b32 v168, 0
    v_mov_b32 v169, 0
    v_mov_b32 v170, 0
    v_mov_b32 v171, 0
    v_mov_b32 v172, 0
    v_mov_b32 v173, 0
    v_mov_b32 v174, 0
    v_mov_b32 v175, 0
    v_mov_b32 v176, 0
    v_mov_b32 v177, 0
    v_mov_b32 v178, 0
    v_mov_b32 v179, 0
    v_mov_b32 v180, 0
    v_mov_b32 v181, 0
    v_mov_b32 v182, 0
    v_mov_b32 v183, 0
    s_mov_b32 s59, 0
    s_mov_b32 s57, 17408
    s_mov_b32 s56, 0xfffeac00
    s_mov_b32 s59, 4
    s_waitcnt vmcnt(0)
    s_lshl_b32 s50, s36, 11
    s_lshl_b32 s51, s37, 7
    s_add_u32 s50, s50, s51
    s_lshl_b32 s51, s33, 2
    s_add_u32 s50, s50, s51
    s_add_u32 s50, s50, 98304
    v_mov_b32 v60, s101
    v_mov_b32 v61, 0
    s_mov_b64 exec, 1
    buffer_store_dword v60, v61, s[84:87], s50 offen sc1
    s_mov_b64 exec, -1
    s_barrier
    ds_read_b128 v[0:3], v241
    ds_read_b128 v[4:7], v242
    ds_read_b128 v[8:11], v243 offset:0
    ds_read_b128 v[12:15], v243 offset:2048
    ds_read_b128 v[16:19], v243 offset:4096
    ds_read_b128 v[20:23], v243 offset:6144
    ds_read_b128 v[24:27], v244
    s_add_u32 s59, s59, 1
    s_cmp_eq_u32 s59, 6
    s_cselect_b32 s59, 0, s59
    s_cselect_b32 s55, s56, s57
    v_add_u32 v241, s55, v241
    v_add_u32 v242, s55, v242
    v_add_u32 v243, s55, v243
    v_add_u32 v244, s55, v244
    s_waitcnt lgkmcnt(0)
    s_mov_b32 s58, 22
parallel_sum__sliding_local_dilated__mixer_gmlp__prompt_kernel_top90:
    s_barrier
    v_mfma_f32_16x16x32_bf16 v[144:147], v[8:11], v[0:3], v[144:147]
    ds_read_b128 v[28:31], v241
    v_mfma_f32_16x16x32_bf16 v[148:151], v[12:15], v[0:3], v[148:151]
    ds_read_b128 v[32:35], v242
    v_mfma_f32_16x16x32_bf16 v[152:155], v[16:19], v[0:3], v[152:155]
    ds_read_b128 v[36:39], v243 offset:0
    v_mfma_f32_16x16x32_bf16 v[156:159], v[20:23], v[0:3], v[156:159]
    ds_read_b128 v[40:43], v243 offset:2048
    v_mfma_f32_16x16x32_bf16 v[160:163], v[24:27], v[0:3], v[160:163]
    ds_read_b128 v[44:47], v243 offset:4096
    v_mfma_f32_16x16x32_bf16 v[180:183], v[24:27], v[4:7], v[180:183]
    ds_read_b128 v[48:51], v243 offset:6144
    v_mfma_f32_16x16x32_bf16 v[176:179], v[20:23], v[4:7], v[176:179]
    ds_read_b128 v[52:55], v244
    v_mfma_f32_16x16x32_bf16 v[172:175], v[16:19], v[4:7], v[172:175]
    s_add_u32 s59, s59, 1
    v_mfma_f32_16x16x32_bf16 v[168:171], v[12:15], v[4:7], v[168:171]
    s_cmp_eq_u32 s59, 6
    v_mfma_f32_16x16x32_bf16 v[164:167], v[8:11], v[4:7], v[164:167]
    s_cselect_b32 s59, 0, s59
    s_cselect_b32 s55, s56, s57
    v_add_u32 v241, s55, v241
    v_add_u32 v242, s55, v242
    v_add_u32 v243, s55, v243
    v_add_u32 v244, s55, v244
    s_waitcnt lgkmcnt(0)
    s_barrier
    v_mfma_f32_16x16x32_bf16 v[144:147], v[36:39], v[28:31], v[144:147]
    ds_read_b128 v[0:3], v241
    v_mfma_f32_16x16x32_bf16 v[148:151], v[40:43], v[28:31], v[148:151]
    ds_read_b128 v[4:7], v242
    v_mfma_f32_16x16x32_bf16 v[152:155], v[44:47], v[28:31], v[152:155]
    ds_read_b128 v[8:11], v243 offset:0
    v_mfma_f32_16x16x32_bf16 v[156:159], v[48:51], v[28:31], v[156:159]
    ds_read_b128 v[12:15], v243 offset:2048
    v_mfma_f32_16x16x32_bf16 v[160:163], v[52:55], v[28:31], v[160:163]
    ds_read_b128 v[16:19], v243 offset:4096
    v_mfma_f32_16x16x32_bf16 v[180:183], v[52:55], v[32:35], v[180:183]
    ds_read_b128 v[20:23], v243 offset:6144
    v_mfma_f32_16x16x32_bf16 v[176:179], v[48:51], v[32:35], v[176:179]
    ds_read_b128 v[24:27], v244
    v_mfma_f32_16x16x32_bf16 v[172:175], v[44:47], v[32:35], v[172:175]
    s_add_u32 s59, s59, 1
    v_mfma_f32_16x16x32_bf16 v[168:171], v[40:43], v[32:35], v[168:171]
    s_cmp_eq_u32 s59, 6
    v_mfma_f32_16x16x32_bf16 v[164:167], v[36:39], v[32:35], v[164:167]
    s_cselect_b32 s59, 0, s59
    s_cselect_b32 s55, s56, s57
    v_add_u32 v241, s55, v241
    v_add_u32 v242, s55, v242
    v_add_u32 v243, s55, v243
    v_add_u32 v244, s55, v244
    s_sub_u32 s58, s58, 1
    s_cmp_lg_u32 s58, 0
    s_waitcnt lgkmcnt(0)
    s_cbranch_scc1 parallel_sum__sliding_local_dilated__mixer_gmlp__prompt_kernel_top90
    s_barrier
    v_mfma_f32_16x16x32_bf16 v[144:147], v[8:11], v[0:3], v[144:147]
    v_mfma_f32_16x16x32_bf16 v[148:151], v[12:15], v[0:3], v[148:151]
    v_mfma_f32_16x16x32_bf16 v[152:155], v[16:19], v[0:3], v[152:155]
    v_mfma_f32_16x16x32_bf16 v[156:159], v[20:23], v[0:3], v[156:159]
    v_mfma_f32_16x16x32_bf16 v[160:163], v[24:27], v[0:3], v[160:163]
    v_mfma_f32_16x16x32_bf16 v[180:183], v[24:27], v[4:7], v[180:183]
    v_mfma_f32_16x16x32_bf16 v[176:179], v[20:23], v[4:7], v[176:179]
    v_mfma_f32_16x16x32_bf16 v[172:175], v[16:19], v[4:7], v[172:175]
    v_mfma_f32_16x16x32_bf16 v[168:171], v[12:15], v[4:7], v[168:171]
    v_mfma_f32_16x16x32_bf16 v[164:167], v[8:11], v[4:7], v[164:167]
    s_lshl_b32 s42, s40, 1
    s_add_u32 s43, s42, s41
    s_mul_i32 s43, s43, 5120
    s_xor_b32 s44, s41, 1
    s_add_u32 s44, s44, s42
    s_mul_i32 s44, s44, 5120
    s_add_u32 s43, s43, 0
    s_add_u32 s44, s44, 0
    v_add_u32 v241, s43, v251
    v_add_u32 v242, s44, v251
    ds_write_b128 v241, v[164:167] offset:0
    ds_write_b128 v241, v[168:171] offset:1024
    ds_write_b128 v241, v[172:175] offset:2048
    ds_write_b128 v241, v[176:179] offset:3072
    ds_write_b128 v241, v[180:183] offset:4096
    s_waitcnt lgkmcnt(0)
    s_barrier
    ds_read_b128 v[164:167], v242 offset:0
    ds_read_b128 v[168:171], v242 offset:1024
    ds_read_b128 v[172:175], v242 offset:2048
    ds_read_b128 v[176:179], v242 offset:3072
    ds_read_b128 v[180:183], v242 offset:4096
    s_waitcnt lgkmcnt(4)
    v_pk_add_f32 v[144:145], v[144:145], v[164:165]
    v_pk_add_f32 v[146:147], v[146:147], v[166:167]
    v_cvt_pk_bf16_f32 v0, v144, v145
    v_cvt_pk_bf16_f32 v1, v146, v147
    buffer_store_dwordx2 v[0:1], v240, s[76:79], s47 offen offset:0
    s_waitcnt lgkmcnt(3)
    v_pk_add_f32 v[148:149], v[148:149], v[168:169]
    v_pk_add_f32 v[150:151], v[150:151], v[170:171]
    v_cvt_pk_bf16_f32 v2, v148, v149
    v_cvt_pk_bf16_f32 v3, v150, v151
    buffer_store_dwordx2 v[2:3], v240, s[76:79], s47 offen offset:32
    s_waitcnt lgkmcnt(2)
    v_pk_add_f32 v[152:153], v[152:153], v[172:173]
    v_pk_add_f32 v[154:155], v[154:155], v[174:175]
    v_cvt_pk_bf16_f32 v4, v152, v153
    v_cvt_pk_bf16_f32 v5, v154, v155
    buffer_store_dwordx2 v[4:5], v240, s[76:79], s47 offen offset:64
    s_waitcnt lgkmcnt(1)
    v_pk_add_f32 v[156:157], v[156:157], v[176:177]
    v_pk_add_f32 v[158:159], v[158:159], v[178:179]
    v_cvt_pk_bf16_f32 v6, v156, v157
    v_cvt_pk_bf16_f32 v7, v158, v159
    buffer_store_dwordx2 v[6:7], v240, s[76:79], s47 offen offset:96
    s_waitcnt lgkmcnt(0)
    v_pk_add_f32 v[160:161], v[160:161], v[180:181]
    v_pk_add_f32 v[162:163], v[162:163], v[182:183]
    v_cvt_pk_bf16_f32 v8, v160, v161
    v_cvt_pk_bf16_f32 v9, v162, v163
    s_mov_b32 exec_hi, 0
    buffer_store_dwordx2 v[8:9], v240, s[76:79], s47 offen offset:128
    s_endpgm
parallel_sum__sliding_local_dilated__mixer_gmlp__prompt_kernel_g2D6:
    s_mov_b32 s8, s66
    s_mov_b32 s9, s67
    s_mov_b32 s10, 0x800000
    s_mov_b32 s11, 0x20000
    s_add_u32 s12, s4, 0x400000
    s_addc_u32 s13, s5, 0
    s_mov_b32 s14, 0x900000
    s_mov_b32 s15, 0x20000
    v_lshlrev_b32 v244, 4, v0
    v_lshrrev_b32 v245, 2, v0
    v_lshlrev_b32 v245, 7, v245
    v_and_b32 v246, 3, v0
    v_lshl_add_u32 v245, v246, 2, v245
    v_lshrrev_b32 v247, 4, v0
    v_and_b32 v246, 7, v0
    v_xor_b32 v246, v246, v247
    v_lshrrev_b32 v247, 3, v0
    v_lshlrev_b32 v247, 12, v247
    v_lshl_add_u32 v246, v246, 4, v247
    v_xor_b32 v247, 64, v246
    s_lshl_b32 s41, s40, 12
    s_lshl_b32 s42, s36, 19
    s_lshl_b32 s50, s40, 17
    s_add_u32 s42, s42, s50
    s_mul_i32 s43, s37, 18432
    s_lshl_b32 s45, s40, 9
    s_add_u32 s46, s43, s45
    s_add_u32 s46, s46, 16384
    s_add_u32 s43, s43, s41
    s_add_u32 s47, s41, 16384
    s_add_u32 s45, s45, 32768
    s_lshl_b32 s53, s37, 11
    s_add_u32 s53, s53, 65536
    s_mov_b32 s100, 0
    s_mov_b32 s49, 0
    s_movk_i32 s88, 128
    s_mov_b32 s89, 294912
    s_lshl_b32 s59, s36, 1
    s_lshl_b32 s50, s36, 8
    s_add_u32 s42, s42, s50
    s_add_u32 m0, s41, s49
    s_nop 0
    buffer_load_dwordx4 v246, s[8:11], s42 offen lds
    s_add_u32 m0, m0, 1024
    s_add_u32 s50, s42, 32768
    buffer_load_dwordx4 v247, s[8:11], s50 offen lds
    s_add_u32 m0, m0, 1024
    s_add_u32 s50, s42, 65536
    buffer_load_dwordx4 v246, s[8:11], s50 offen lds
    s_add_u32 m0, m0, 1024
    s_add_u32 s50, s42, 98304
    buffer_load_dwordx4 v247, s[8:11], s50 offen lds
    s_add_u32 s42, s42, s88
    s_mov_b32 s49, 34816
    s_add_u32 m0, s41, s49
    s_nop 0
    buffer_load_dwordx4 v246, s[8:11], s42 offen lds
    s_add_u32 m0, m0, 1024
    s_add_u32 s50, s42, 32768
    buffer_load_dwordx4 v247, s[8:11], s50 offen lds
    s_add_u32 m0, m0, 1024
    s_add_u32 s50, s42, 65536
    buffer_load_dwordx4 v246, s[8:11], s50 offen lds
    s_add_u32 m0, m0, 1024
    s_add_u32 s50, s42, 98304
    buffer_load_dwordx4 v247, s[8:11], s50 offen lds
    s_add_u32 s42, s42, s88
    s_lshl_b32 s50, s36, 8
    s_sub_u32 s42, s42, s50
    s_cmp_eq_u32 s36, 0
    s_cselect_b32 s51, 0, 256
    s_cselect_b32 s50, 589824, 0
    s_sub_u32 s42, s42, s51
    s_add_u32 s43, s43, s50
    s_add_u32 s46, s46, s50
    s_mov_b32 s49, 69632
    buffer_load_dword v248, v245, s[84:87], s53 offen sc1
    s_add_u32 s68, s4, 0x3000000
    s_addc_u32 s69, s5, 0
    s_mov_b32 s70, 0x32a000
    s_mov_b32 s71, 0x20000
    s_cmp_eq_u32 s40, 3
    s_cbranch_scc1 parallel_sum__sliding_local_dilated__mixer_gmlp__prompt_kernel_nw91
    s_mul_i32 s20, s3, 3
    s_add_u32 s20, s20, s40
    s_cmp_lt_u32 s40, 3
    s_cselect_b32 s20, s20, 360
    s_lshr_b32 s21, s20, 2
    s_and_b32 s22, s20, 3
    s_lshl_b32 s22, s22, 1
    s_cmp_lt_u32 s21, 18
    s_cselect_b32 s24, s28, s30
    s_cselect_b32 s25, s29, s31
    s_mov_b32 s26, 2654208
    s_cselect_b32 s26, 663552, s26
    s_mov_b32 s27, 0x20000
    s_cbranch_scc1 parallel_sum__sliding_local_dilated__mixer_gmlp__prompt_kernel_nat92
    s_sub_u32 s50, s21, 18
    s_mul_i32 s55, s50, 57
    s_lshr_b32 s55, s55, 9
    s_mul_i32 s56, s55, 9
    s_sub_u32 s56, s50, s56
    s_and_b32 s57, s55, 3
    s_lshl_b32 s57, s57, 1
    s_lshr_b32 s55, s55, 2
    s_add_u32 s55, s55, s57
    s_mul_i32 s55, s55, 288
    s_lshr_b32 s57, s56, 2
    s_mul_i32 s57, s57, 144
    s_and_b32 s50, s56, 3
    s_lshl_b32 s50, s50, 5
    s_add_u32 s57, s57, s50
    s_cmp_eq_u32 s56, 8
    s_cselect_b32 s57, 128, s57
    s_cselect_b32 s28, 4, 16
    s_cselect_b32 s29, 8, 4
    s_cselect_b32 s30, 144, 8
    s_add_u32 s23, s55, s57
    s_branch parallel_sum__sliding_local_dilated__mixer_gmlp__prompt_kernel_go93
parallel_sum__sliding_local_dilated__mixer_gmlp__prompt_kernel_nat92:
    s_lshl_b32 s23, s21, 5
    s_mov_b32 s28, 4
    s_mov_b32 s29, 8
    s_mov_b32 s30, 16
parallel_sum__sliding_local_dilated__mixer_gmlp__prompt_kernel_go93:
    s_mul_i32 s23, s23, 1152
    s_mul_i32 s50, s22, 144
    s_add_u32 s23, s23, s50
    s_cmp_lt_u32 s20, 360
    s_cselect_b32 s23, s23, 0x7fffffff
    s_mul_i32 s31, s40, 9216
    s_add_u32 s31, s31, 69632
    s_mov_b32 m0, s31
    v_add_u32 v12, 0, v0
    v_mul_u32_u24 v13, 3641, v12
    v_lshrrev_b32 v13, 16, v13
    v_mul_u32_u24 v14, 18, v13
    v_sub_u32 v12, v12, v14
    v_bfe_u32 v15, v13, 2, 1
    v_mul_u32_u24 v15, s28, v15
    v_bfe_u32 v14, v13, 3, 1
    v_mad_u32_u24 v15, v14, s29, v15
    v_bfe_u32 v14, v13, 4, 1
    v_mad_u32_u24 v15, v14, s30, v15
    v_and_b32 v14, 3, v13
    v_add_u32 v15, v15, v14
    v_mul_u32_u24 v15, 1152, v15
    v_lshl_add_u32 v15, v12, 4, v15
    buffer_load_dwordx4 v15, s[24:27], s23 offen lds
    s_add_u32 m0, m0, 1024
    v_add_u32 v12, 64, v0
    v_mul_u32_u24 v13, 3641, v12
    v_lshrrev_b32 v13, 16, v13
    v_mul_u32_u24 v14, 18, v13
    v_sub_u32 v12, v12, v14
    v_bfe_u32 v15, v13, 2, 1
    v_mul_u32_u24 v15, s28, v15
    v_bfe_u32 v14, v13, 3, 1
    v_mad_u32_u24 v15, v14, s29, v15
    v_bfe_u32 v14, v13, 4, 1
    v_mad_u32_u24 v15, v14, s30, v15
    v_and_b32 v14, 3, v13
    v_add_u32 v15, v15, v14
    v_mul_u32_u24 v15, 1152, v15
    v_lshl_add_u32 v15, v12, 4, v15
    buffer_load_dwordx4 v15, s[24:27], s23 offen lds
    s_add_u32 m0, m0, 1024
    v_add_u32 v12, 128, v0
    v_mul_u32_u24 v13, 3641, v12
    v_lshrrev_b32 v13, 16, v13
    v_mul_u32_u24 v14, 18, v13
    v_sub_u32 v12, v12, v14
    v_bfe_u32 v15, v13, 2, 1
    v_mul_u32_u24 v15, s28, v15
    v_bfe_u32 v14, v13, 3, 1
    v_mad_u32_u24 v15, v14, s29, v15
    v_bfe_u32 v14, v13, 4, 1
    v_mad_u32_u24 v15, v14, s30, v15
    v_and_b32 v14, 3, v13
    v_add_u32 v15, v15, v14
    v_mul_u32_u24 v15, 1152, v15
    v_lshl_add_u32 v15, v12, 4, v15
    buffer_load_dwordx4 v15, s[24:27], s23 offen lds
    s_add_u32 m0, m0, 1024
    v_add_u32 v12, 192, v0
    v_mul_u32_u24 v13, 3641, v12
    v_lshrrev_b32 v13, 16, v13
    v_mul_u32_u24 v14, 18, v13
    v_sub_u32 v12, v12, v14
    v_bfe_u32 v15, v13, 2, 1
    v_mul_u32_u24 v15, s28, v15
    v_bfe_u32 v14, v13, 3, 1
    v_mad_u32_u24 v15, v14, s29, v15
    v_bfe_u32 v14, v13, 4, 1
    v_mad_u32_u24 v15, v14, s30, v15
    v_and_b32 v14, 3, v13
    v_add_u32 v15, v15, v14
    v_mul_u32_u24 v15, 1152, v15
    v_lshl_add_u32 v15, v12, 4, v15
    buffer_load_dwordx4 v15, s[24:27], s23 offen lds
    s_add_u32 m0, m0, 1024
    v_add_u32 v12, 256, v0
    v_mul_u32_u24 v13, 3641, v12
    v_lshrrev_b32 v13, 16, v13
    v_mul_u32_u24 v14, 18, v13
    v_sub_u32 v12, v12, v14
    v_bfe_u32 v15, v13, 2, 1
    v_mul_u32_u24 v15, s28, v15
    v_bfe_u32 v14, v13, 3, 1
    v_mad_u32_u24 v15, v14, s29, v15
    v_bfe_u32 v14, v13, 4, 1
    v_mad_u32_u24 v15, v14, s30, v15
    v_and_b32 v14, 3, v13
    v_add_u32 v15, v15, v14
    v_mul_u32_u24 v15, 1152, v15
    v_lshl_add_u32 v15, v12, 4, v15
    buffer_load_dwordx4 v15, s[24:27], s23 offen lds
    s_add_u32 m0, m0, 1024
    v_add_u32 v12, 320, v0
    v_mul_u32_u24 v13, 3641, v12
    v_lshrrev_b32 v13, 16, v13
    v_mul_u32_u24 v14, 18, v13
    v_sub_u32 v12, v12, v14
    v_bfe_u32 v15, v13, 2, 1
    v_mul_u32_u24 v15, s28, v15
    v_bfe_u32 v14, v13, 3, 1
    v_mad_u32_u24 v15, v14, s29, v15
    v_bfe_u32 v14, v13, 4, 1
    v_mad_u32_u24 v15, v14, s30, v15
    v_and_b32 v14, 3, v13
    v_add_u32 v15, v15, v14
    v_mul_u32_u24 v15, 1152, v15
    v_lshl_add_u32 v15, v12, 4, v15
    buffer_load_dwordx4 v15, s[24:27], s23 offen lds
    s_add_u32 m0, m0, 1024
    v_add_u32 v12, 384, v0
    v_mul_u32_u24 v13, 3641, v12
    v_lshrrev_b32 v13, 16, v13
    v_mul_u32_u24 v14, 18, v13
    v_sub_u32 v12, v12, v14
    v_bfe_u32 v15, v13, 2, 1
    v_mul_u32_u24 v15, s28, v15
    v_bfe_u32 v14, v13, 3, 1
    v_mad_u32_u24 v15, v14, s29, v15
    v_bfe_u32 v14, v13, 4, 1
    v_mad_u32_u24 v15, v14, s30, v15
    v_and_b32 v14, 3, v13
    v_add_u32 v15, v15, v14
    v_mul_u32_u24 v15, 1152, v15
    v_lshl_add_u32 v15, v12, 4, v15
    buffer_load_dwordx4 v15, s[24:27], s23 offen lds
    s_add_u32 m0, m0, 1024
    v_add_u32 v12, 448, v0
    v_mul_u32_u24 v13, 3641, v12
    v_lshrrev_b32 v13, 16, v13
    v_mul_u32_u24 v14, 18, v13
    v_sub_u32 v12, v12, v14
    v_bfe_u32 v15, v13, 2, 1
    v_mul_u32_u24 v15, s28, v15
    v_bfe_u32 v14, v13, 3, 1
    v_mad_u32_u24 v15, v14, s29, v15
    v_bfe_u32 v14, v13, 4, 1
    v_mad_u32_u24 v15, v14, s30, v15
    v_and_b32 v14, 3, v13
    v_add_u32 v15, v15, v14
    v_mul_u32_u24 v15, 1152, v15
    v_lshl_add_u32 v15, v12, 4, v15
    buffer_load_dwordx4 v15, s[24:27], s23 offen lds
    s_add_u32 m0, m0, 1024
    v_add_u32 v12, 512, v0
    v_mul_u32_u24 v13, 3641, v12
    v_lshrrev_b32 v13, 16, v13
    v_mul_u32_u24 v14, 18, v13
    v_sub_u32 v12, v12, v14
    v_bfe_u32 v15, v13, 2, 1
    v_mul_u32_u24 v15, s28, v15
    v_bfe_u32 v14, v13, 3, 1
    v_mad_u32_u24 v15, v14, s29, v15
    v_bfe_u32 v14, v13, 4, 1
    v_mad_u32_u24 v15, v14, s30, v15
    v_and_b32 v14, 3, v13
    v_add_u32 v15, v15, v14
    v_mul_u32_u24 v15, 1152, v15
    v_lshl_add_u32 v15, v12, 4, v15
    buffer_load_dwordx4 v15, s[24:27], s23 offen lds
    s_add_u32 m0, m0, 1024
    v_lshrrev_b32 v12, 4, v0
    v_bfe_u32 v13, v0, 2, 2
    v_and_b32 v14, 3, v0
    v_lshl_add_u32 v15, v12, 3, v13
    v_mul_u32_u24 v15, 288, v15
    v_lshl_add_u32 v15, v14, 3, v15
    v_add_u32 v15, s31, v15
    v_and_b32 v12, 1, v12
    v_lshrrev_b32 v16, 1, v14
    v_lshl_add_u32 v12, v12, 1, v16
    v_lshl_add_u32 v12, v12, 3, v13
    v_mul_u32_u24 v12, 288, v12
    v_and_b32 v14, 1, v14
    v_lshl_add_u32 v12, v14, 3, v12
    v_add_u32 v12, s31, v12
    s_lshr_b32 s55, s21, 1
    s_lshl_b32 s55, s55, 3
    s_add_u32 s55, s55, s22
    s_mul_i32 s55, s55, 9216
    s_and_b32 s56, s21, 1
    s_lshl_b32 s57, s56, 9
    s_add_u32 s57, s57, s55
    s_add_u32 s57, s57, 8192
    s_lshl_b32 s56, s56, 10
    s_add_u32 s55, s55, s56
    s_add_u32 s56, s55, 4096
    s_waitcnt vmcnt(0)
    ds_read_b64_tr_b16 v[100:101], v15 offset:0
    ds_read_b64_tr_b16 v[102:103], v15 offset:1152
    ds_read_b64_tr_b16 v[104:105], v15 offset:32
    ds_read_b64_tr_b16 v[106:107], v15 offset:1184
    ds_read_b64_tr_b16 v[108:109], v15 offset:64
    ds_read_b64_tr_b16 v[110:111], v15 offset:1216
    ds_read_b64_tr_b16 v[112:113], v15 offset:96
    ds_read_b64_tr_b16 v[114:115], v15 offset:1248
    ds_read_b64_tr_b16 v[116:117], v12 offset:128
    ds_read_b64_tr_b16 v[118:119], v12 offset:1280
    ds_read_b64_tr_b16 v[120:121], v15 offset:144
    ds_read_b64_tr_b16 v[122:123], v15 offset:1296
    ds_read_b64_tr_b16 v[124:125], v15 offset:176
    ds_read_b64_tr_b16 v[126:127], v15 offset:1328
    ds_read_b64_tr_b16 v[128:129], v15 offset:208
    ds_read_b64_tr_b16 v[130:131], v15 offset:1360
    ds_read_b64_tr_b16 v[132:133], v15 offset:240
    ds_read_b64_tr_b16 v[134:135], v15 offset:1392
    ds_read_b64_tr_b16 v[136:137], v12 offset:272
    ds_read_b64_tr_b16 v[138:139], v12 offset:1424
    s_waitcnt lgkmcnt(10)
    buffer_store_dwordx4 v[100:103], v1, s[68:71], s55 offen offset:0 sc1
    buffer_store_dwordx4 v[104:107], v1, s[68:71], s55 offen offset:2048 sc1
    buffer_store_dwordx4 v[108:111], v1, s[68:71], s56 offen offset:0 sc1
    buffer_store_dwordx4 v[112:115], v1, s[68:71], s56 offen offset:2048 sc1
    s_mov_b32 exec_hi, 0
    buffer_store_dwordx4 v[116:119], v1, s[68:71], s57 offen sc1
    s_mov_b32 exec_hi, -1
    s_add_u32 s55, s55, 9216
    s_add_u32 s56, s56, 9216
    s_add_u32 s57, s57, 9216
    s_waitcnt lgkmcnt(0)
    buffer_store_dwordx4 v[120:123], v1, s[68:71], s55 offen offset:0 sc1
    buffer_store_dwordx4 v[124:127], v1, s[68:71], s55 offen offset:2048 sc1
    buffer_store_dwordx4 v[128:131], v1, s[68:71], s56 offen offset:0 sc1
    buffer_store_dwordx4 v[132:135], v1, s[68:71], s56 offen offset:2048 sc1
    s_mov_b32 exec_hi, 0
    buffer_store_dwordx4 v[136:139], v1, s[68:71], s57 offen sc1
    s_mov_b32 exec_hi, -1
parallel_sum__sliding_local_dilated__mixer_gmlp__prompt_kernel_nw91:
    s_waitcnt vmcnt(0)
parallel_sum__sliding_local_dilated__mixer_gmlp__prompt_kernel_g2D27:
    s_setprio 3
    s_waitcnt vmcnt(3)
    v_cmp_ne_u32 vcc, s101, v248
    s_cbranch_vccz parallel_sum__sliding_local_dilated__mixer_gmlp__prompt_kernel_sd95
    s_mov_b32 s50, 0x20000
parallel_sum__sliding_local_dilated__mixer_gmlp__prompt_kernel_sp94:
    s_sleep 2
    buffer_load_dword v248, v245, s[84:87], s53 offen sc1
    s_waitcnt vmcnt(0)
    s_sub_u32 s50, s50, 1
    v_cmp_ne_u32 vcc, s101, v248
    s_cmp_eq_u32 s50, 0
    s_cselect_b64 vcc, 0, vcc
    s_cbranch_vccnz parallel_sum__sliding_local_dilated__mixer_gmlp__prompt_kernel_sp94
parallel_sum__sliding_local_dilated__mixer_gmlp__prompt_kernel_sd95:
    s_movk_i32 s23, 128
    s_mov_b32 s30, 294912
    s_and_b32 s38, s34, 3
    s_lshl_b32 s38, s38, 3
    s_and_b32 s39, s35, 7
    s_add_u32 s38, s38, s39
    s_lshr_b32 s39, s34, 2
    s_lshl_b32 s39, s39, 2
    s_lshr_b32 s50, s35, 3
    s_add_u32 s39, s39, s50
    s_add_u32 s68, s4, 0x3000000
    s_addc_u32 s69, s5, 0
    s_mov_b32 s70, 0x32a000
    s_mov_b32 s71, 0x20000
    v_mov_b32 v1, v244
    s_lshl_b32 s60, s40, 11
    s_lshl_b32 s61, s38, 2
    s_add_u32 s61, s61, s40
    s_mul_i32 s61, s61, 92160
    s_mul_i32 s62, s39, 9216
    s_lshl_b32 s63, s40, 8
    s_add_u32 s48, s62, s63
    s_add_u32 s48, s48, 8192
    s_add_u32 s62, s62, s60
    s_add_u32 s65, s60, 8192
    s_add_u32 s66, s63, 16384
    s_mov_b32 s67, 69632
    s_lshl_b32 s51, s36, 3
    s_lshl_b32 s52, s40, 1
    s_add_u32 s51, s51, s52
    s_mul_i32 s51, s51, 92160
    s_bfe_u32 s50, s37, 0x10001
    s_lshl_b32 s50, s50, 2
    s_lshr_b32 s44, s37, 2
    s_add_u32 s50, s50, s44
    s_mul_i32 s50, s50, 9216
    s_add_u32 s51, s51, s50
    s_and_b32 s50, s37, 1
    s_lshl_b32 s44, s50, 9
    s_add_u32 s44, s44, s51
    s_add_u32 s44, s44, 26624
    s_lshl_b32 s50, s50, 12
    s_add_u32 s51, s51, s50
    s_add_u32 s51, s51, 18432
    s_mul_i32 s52, s52, 4608
    s_add_u32 s52, s52, 104448
    s_lshr_b32 s53, s38, 1
    s_lshl_b32 s53, s53, 11
    s_add_u32 s53, s53, 98304
    s_movk_i32 s54, 12288
    s_movk_i32 s20, 2048
    s_mov_b32 s21, 73728
    s_lshr_b32 s22, s35, 3
    s_add_u32 s22, s22, s35
    s_and_b32 s22, s22, 0
    s_mov_b32 s58, 5
parallel_sum__sliding_local_dilated__mixer_gmlp__prompt_kernel_pl96:
    s_waitcnt vmcnt(9)
    s_barrier
    s_sub_u32 s59, s59, 1
    s_cmp_eq_u32 s59, 0
    s_cselect_b32 s88, 384, s23
    s_cselect_b32 s89, 884736, s30
    s_add_u32 m0, s41, s49
    s_nop 0
    buffer_load_dwordx4 v246, s[8:11], s42 offen lds
    s_add_u32 m0, m0, 1024
    s_add_u32 s50, s42, 32768
    buffer_load_dwordx4 v247, s[8:11], s50 offen lds
    s_add_u32 m0, m0, 1024
    s_add_u32 s50, s42, 65536
    buffer_load_dwordx4 v246, s[8:11], s50 offen lds
    s_add_u32 m0, m0, 1024
    s_add_u32 s50, s42, 98304
    buffer_load_dwordx4 v247, s[8:11], s50 offen lds
    s_add_u32 s42, s42, s88
    s_add_u32 m0, s47, s49
    s_nop 0
    buffer_load_dwordx4 v244, s[12:15], s43 offen offset:0 sc1 lds
    buffer_load_dwordx4 v244, s[12:15], s43 offen offset:1024 sc1 lds
    buffer_load_dwordx4 v244, s[12:15], s43 offen offset:2048 sc1 lds
    buffer_load_dwordx4 v244, s[12:15], s43 offen offset:3072 sc1 lds
    s_add_u32 m0, s45, s49
    s_mov_b32 exec_hi, 0
    buffer_load_dwordx4 v244, s[12:15], s46 offen sc1 lds
    s_mov_b32 exec_hi, -1
    s_add_u32 s43, s43, s89
    s_add_u32 s46, s46, s89
    s_add_u32 s49, s49, 34816
    s_cmp_eq_u32 s49, 104448
    s_cselect_b32 s49, 0, s49
    s_sub_u32 s58, s58, 1
    s_cmp_lg_u32 s58, 0
    s_cbranch_scc1 parallel_sum__sliding_local_dilated__mixer_gmlp__prompt_kernel_pl96
    s_cmp_lg_u32 s40, 0
    s_cbranch_scc1 parallel_sum__sliding_local_dilated__mixer_gmlp__prompt_kernel_f397
    s_lshl_b32 s50, s2, 2
    s_add_u32 s50, s50, 12288
    v_mov_b32 v8, s101
    v_mov_b32 v9, 0
    s_mov_b64 exec, 1
    buffer_store_dword v8, v9, s[84:87], s50 offen sc1
    s_mov_b64 exec, -1
parallel_sum__sliding_local_dilated__mixer_gmlp__prompt_kernel_f397:
    s_mov_b32 s58, 9
parallel_sum__sliding_local_dilated__mixer_gmlp__prompt_kernel_pl98:
    s_waitcnt vmcnt(9)
    s_barrier
    s_sub_u32 s59, s59, 1
    s_cmp_eq_u32 s59, 0
    s_cselect_b32 s88, 384, s23
    s_cselect_b32 s89, 884736, s30
    s_add_u32 m0, s41, s49
    s_nop 0
    buffer_load_dwordx4 v246, s[8:11], s42 offen lds
    s_add_u32 m0, m0, 1024
    s_add_u32 s50, s42, 32768
    buffer_load_dwordx4 v247, s[8:11], s50 offen lds
    s_add_u32 m0, m0, 1024
    s_add_u32 s50, s42, 65536
    buffer_load_dwordx4 v246, s[8:11], s50 offen lds
    s_add_u32 m0, m0, 1024
    s_add_u32 s50, s42, 98304
    buffer_load_dwordx4 v247, s[8:11], s50 offen lds
    s_add_u32 s42, s42, s88
    s_add_u32 m0, s47, s49
    s_nop 0
    buffer_load_dwordx4 v244, s[12:15], s43 offen offset:0 sc1 lds
    buffer_load_dwordx4 v244, s[12:15], s43 offen offset:1024 sc1 lds
    buffer_load_dwordx4 v244, s[12:15], s43 offen offset:2048 sc1 lds
    buffer_load_dwordx4 v244, s[12:15], s43 offen offset:3072 sc1 lds
    s_add_u32 m0, s45, s49
    s_mov_b32 exec_hi, 0
    buffer_load_dwordx4 v244, s[12:15], s46 offen sc1 lds
    s_mov_b32 exec_hi, -1
    s_add_u32 s43, s43, s89
    s_add_u32 s46, s46, s89
    s_add_u32 s49, s49, 34816
    s_cmp_eq_u32 s49, 104448
    s_cselect_b32 s49, 0, s49
    s_sub_u32 s58, s58, 1
    s_cmp_lg_u32 s58, 0
    s_cbranch_scc1 parallel_sum__sliding_local_dilated__mixer_gmlp__prompt_kernel_pl98
    s_mov_b32 s58, 6
parallel_sum__sliding_local_dilated__mixer_gmlp__prompt_kernel_pl99:
    s_waitcnt vmcnt(9)
    s_barrier
    s_sub_u32 s59, s59, 1
    s_cmp_eq_u32 s59, 0
    s_cselect_b32 s88, 384, s23
    s_cselect_b32 s89, 884736, s30
    s_add_u32 m0, s41, s49
    s_nop 0
    buffer_load_dwordx4 v246, s[8:11], s42 offen lds
    s_add_u32 m0, m0, 1024
    s_add_u32 s50, s42, 32768
    buffer_load_dwordx4 v247, s[8:11], s50 offen lds
    s_add_u32 m0, m0, 1024
    s_add_u32 s50, s42, 65536
    buffer_load_dwordx4 v246, s[8:11], s50 offen lds
    s_add_u32 m0, m0, 1024
    s_add_u32 s50, s42, 98304
    buffer_load_dwordx4 v247, s[8:11], s50 offen lds
    s_add_u32 s42, s42, s88
    s_add_u32 m0, s47, s49
    s_nop 0
    buffer_load_dwordx4 v244, s[12:15], s43 offen offset:0 sc1 lds
    buffer_load_dwordx4 v244, s[12:15], s43 offen offset:1024 sc1 lds
    buffer_load_dwordx4 v244, s[12:15], s43 offen offset:2048 sc1 lds
    buffer_load_dwordx4 v244, s[12:15], s43 offen offset:3072 sc1 lds
    s_add_u32 m0, s45, s49
    s_mov_b32 exec_hi, 0
    buffer_load_dwordx4 v244, s[12:15], s46 offen sc1 lds
    s_mov_b32 exec_hi, -1
    s_add_u32 s43, s43, s89
    s_add_u32 s46, s46, s89
    s_add_u32 s49, s49, 34816
    s_cmp_eq_u32 s49, 104448
    s_cselect_b32 s49, 0, s49
    s_sub_u32 s58, s58, 1
    s_cmp_lg_u32 s58, 0
    s_cbranch_scc1 parallel_sum__sliding_local_dilated__mixer_gmlp__prompt_kernel_pl99
    s_cmp_lg_u32 s40, 2
    s_cbranch_scc1 parallel_sum__sliding_local_dilated__mixer_gmlp__prompt_kernel_ow100
    buffer_load_dwordx4 v[8:11], v1, s[84:87], s54 offen sc1
parallel_sum__sliding_local_dilated__mixer_gmlp__prompt_kernel_ow100:
    s_mov_b32 s58, 1
parallel_sum__sliding_local_dilated__mixer_gmlp__prompt_kernel_pl101:
    s_waitcnt vmcnt(9)
    s_barrier
    s_sub_u32 s59, s59, 1
    s_cmp_eq_u32 s59, 0
    s_cselect_b32 s88, 384, s23
    s_cselect_b32 s89, 884736, s30
    s_add_u32 m0, s41, s49
    s_nop 0
    buffer_load_dwordx4 v246, s[8:11], s42 offen lds
    s_add_u32 m0, m0, 1024
    s_add_u32 s50, s42, 32768
    buffer_load_dwordx4 v247, s[8:11], s50 offen lds
    s_add_u32 m0, m0, 1024
    s_add_u32 s50, s42, 65536
    buffer_load_dwordx4 v246, s[8:11], s50 offen lds
    s_add_u32 m0, m0, 1024
    s_add_u32 s50, s42, 98304
    buffer_load_dwordx4 v247, s[8:11], s50 offen lds
    s_add_u32 s42, s42, s88
    s_add_u32 m0, s47, s49
    s_nop 0
    buffer_load_dwordx4 v244, s[12:15], s43 offen offset:0 sc1 lds
    buffer_load_dwordx4 v244, s[12:15], s43 offen offset:1024 sc1 lds
    buffer_load_dwordx4 v244, s[12:15], s43 offen offset:2048 sc1 lds
    buffer_load_dwordx4 v244, s[12:15], s43 offen offset:3072 sc1 lds
    s_add_u32 m0, s45, s49
    s_mov_b32 exec_hi, 0
    buffer_load_dwordx4 v244, s[12:15], s46 offen sc1 lds
    s_mov_b32 exec_hi, -1
    s_add_u32 s43, s43, s89
    s_add_u32 s46, s46, s89
    s_add_u32 s49, s49, 34816
    s_cmp_eq_u32 s49, 104448
    s_cselect_b32 s49, 0, s49
    s_sub_u32 s58, s58, 1
    s_cmp_lg_u32 s58, 0
    s_cbranch_scc1 parallel_sum__sliding_local_dilated__mixer_gmlp__prompt_kernel_pl101
    s_waitcnt vmcnt(9)
    s_cmp_lg_u32 s40, 2
    s_cbranch_scc1 parallel_sum__sliding_local_dilated__mixer_gmlp__prompt_kernel_ow102
    v_xor_b32 v8, s101, v8
    v_xor_b32 v9, s101, v9
    v_xor_b32 v10, s101, v10
    v_xor_b32 v11, s101, v11
    v_or3_b32 v8, v8, v9, v10
    v_or_b32 v8, v8, v11
    v_cmp_ne_u32 vcc, 0, v8
    s_cbranch_vccz parallel_sum__sliding_local_dilated__mixer_gmlp__prompt_kernel_sd104
    s_mov_b32 s50, 0x20000
parallel_sum__sliding_local_dilated__mixer_gmlp__prompt_kernel_sp103:
    s_sleep 2
    buffer_load_dwordx4 v[8:11], v1, s[84:87], s54 offen sc1
    s_waitcnt vmcnt(0)
    s_sub_u32 s50, s50, 1
    v_xor_b32 v8, s101, v8
    v_xor_b32 v9, s101, v9
    v_xor_b32 v10, s101, v10
    v_xor_b32 v11, s101, v11
    v_or3_b32 v8, v8, v9, v10
    v_or_b32 v8, v8, v11
    v_cmp_ne_u32 vcc, 0, v8
    s_cmp_eq_u32 s50, 0
    s_cselect_b64 vcc, 0, vcc
    s_cbranch_vccnz parallel_sum__sliding_local_dilated__mixer_gmlp__prompt_kernel_sp103
parallel_sum__sliding_local_dilated__mixer_gmlp__prompt_kernel_sd104:
parallel_sum__sliding_local_dilated__mixer_gmlp__prompt_kernel_ow102:
    s_mov_b32 s58, 9
parallel_sum__sliding_local_dilated__mixer_gmlp__prompt_kernel_pl105:
    s_waitcnt vmcnt(9)
    s_barrier
    s_sub_u32 s59, s59, 1
    s_cmp_eq_u32 s59, 0
    s_cselect_b32 s88, 384, s23
    s_cselect_b32 s89, 884736, s30
    s_add_u32 m0, s41, s49
    s_nop 0
    buffer_load_dwordx4 v246, s[8:11], s42 offen lds
    s_add_u32 m0, m0, 1024
    s_add_u32 s50, s42, 32768
    buffer_load_dwordx4 v247, s[8:11], s50 offen lds
    s_add_u32 m0, m0, 1024
    s_add_u32 s50, s42, 65536
    buffer_load_dwordx4 v246, s[8:11], s50 offen lds
    s_add_u32 m0, m0, 1024
    s_add_u32 s50, s42, 98304
    buffer_load_dwordx4 v247, s[8:11], s50 offen lds
    s_add_u32 s42, s42, s88
    s_add_u32 m0, s47, s49
    s_nop 0
    buffer_load_dwordx4 v244, s[12:15], s43 offen offset:0 sc1 lds
    buffer_load_dwordx4 v244, s[12:15], s43 offen offset:1024 sc1 lds
    buffer_load_dwordx4 v244, s[12:15], s43 offen offset:2048 sc1 lds
    buffer_load_dwordx4 v244, s[12:15], s43 offen offset:3072 sc1 lds
    s_add_u32 m0, s45, s49
    s_mov_b32 exec_hi, 0
    buffer_load_dwordx4 v244, s[12:15], s46 offen sc1 lds
    s_mov_b32 exec_hi, -1
    s_add_u32 s43, s43, s89
    s_add_u32 s46, s46, s89
    s_add_u32 s49, s49, 34816
    s_cmp_eq_u32 s49, 104448
    s_cselect_b32 s49, 0, s49
    s_sub_u32 s58, s58, 1
    s_cmp_lg_u32 s58, 0
    s_cbranch_scc1 parallel_sum__sliding_local_dilated__mixer_gmlp__prompt_kernel_pl105
    s_add_u32 m0, s52, 0
    s_nop 0
    buffer_load_dwordx4 v1, s[16:19], s51 offen offset:0 sc1 lds
    buffer_load_dwordx4 v1, s[16:19], s51 offen offset:1024 sc1 lds
    buffer_load_dwordx4 v1, s[16:19], s51 offen offset:2048 sc1 lds
    buffer_load_dwordx4 v1, s[16:19], s51 offen offset:3072 sc1 lds
    s_add_u32 m0, s52, 4096
    s_mov_b32 exec_hi, 0
    buffer_load_dwordx4 v1, s[16:19], s44 offen sc1 lds
    s_mov_b32 exec_hi, -1
    s_add_u32 s51, s51, 92160
    s_add_u32 s44, s44, 92160
    s_add_u32 m0, s52, 4608
    s_nop 0
    buffer_load_dwordx4 v1, s[16:19], s51 offen offset:0 sc1 lds
    buffer_load_dwordx4 v1, s[16:19], s51 offen offset:1024 sc1 lds
    buffer_load_dwordx4 v1, s[16:19], s51 offen offset:2048 sc1 lds
    buffer_load_dwordx4 v1, s[16:19], s51 offen offset:3072 sc1 lds
    s_add_u32 m0, s52, 8704
    s_mov_b32 exec_hi, 0
    buffer_load_dwordx4 v1, s[16:19], s44 offen sc1 lds
    s_mov_b32 exec_hi, -1
    s_add_u32 s51, s51, 92160
    s_add_u32 s44, s44, 92160
    s_waitcnt vmcnt(19)
    s_barrier
    s_add_u32 m0, s60, s67
    s_nop 0
    buffer_load_dwordx4 v1, s[16:19], s61 offen offset:0 sc1 lds
    buffer_load_dwordx4 v1, s[16:19], s61 offen offset:1024 sc1 lds
    s_add_u32 m0, s65, s67
    s_nop 0
    buffer_load_dwordx4 v1, s[68:71], s62 offen offset:0 sc1 lds
    buffer_load_dwordx4 v1, s[68:71], s62 offen offset:1024 sc1 lds
    s_add_u32 m0, s66, s67
    s_mov_b64 exec, 0xffff
    buffer_load_dwordx4 v1, s[68:71], s48 offen sc1 lds
    s_mov_b64 exec, -1
    s_add_u32 s61, s61, s20
    s_add_u32 s62, s62, s21
    s_add_u32 s48, s48, s21
    s_add_u32 s67, s67, 17408
    s_cmp_eq_u32 s67, 104448
    s_cselect_b32 s67, 0, s67
    s_add_u32 m0, s60, s67
    s_nop 0
    buffer_load_dwordx4 v1, s[16:19], s61 offen offset:0 sc1 lds
    buffer_load_dwordx4 v1, s[16:19], s61 offen offset:1024 sc1 lds
    s_add_u32 m0, s65, s67
    s_nop 0
    buffer_load_dwordx4 v1, s[68:71], s62 offen offset:0 sc1 lds
    buffer_load_dwordx4 v1, s[68:71], s62 offen offset:1024 sc1 lds
    s_add_u32 m0, s66, s67
    s_mov_b64 exec, 0xffff
    buffer_load_dwordx4 v1, s[68:71], s48 offen sc1 lds
    s_mov_b64 exec, -1
    s_add_u32 s61, s61, s20
    s_add_u32 s62, s62, s21
    s_add_u32 s48, s48, s21
    s_add_u32 s67, s67, 17408
    s_cmp_eq_u32 s67, 104448
    s_cselect_b32 s67, 0, s67
    s_waitcnt vmcnt(20)
    s_barrier
    s_waitcnt vmcnt(10)
    s_barrier
    s_add_u32 m0, s60, s67
    s_nop 0
    buffer_load_dwordx4 v1, s[16:19], s61 offen offset:0 sc1 lds
    buffer_load_dwordx4 v1, s[16:19], s61 offen offset:1024 sc1 lds
    s_add_u32 m0, s65, s67
    s_nop 0
    buffer_load_dwordx4 v1, s[68:71], s62 offen offset:0 sc1 lds
    buffer_load_dwordx4 v1, s[68:71], s62 offen offset:1024 sc1 lds
    s_add_u32 m0, s66, s67
    s_mov_b64 exec, 0xffff
    buffer_load_dwordx4 v1, s[68:71], s48 offen sc1 lds
    s_mov_b64 exec, -1
    s_add_u32 s61, s61, s20
    s_add_u32 s62, s62, s21
    s_add_u32 s48, s48, s21
    s_add_u32 s67, s67, 17408
    s_cmp_eq_u32 s67, 104448
    s_cselect_b32 s67, 0, s67
    s_add_u32 m0, s60, s67
    s_nop 0
    buffer_load_dwordx4 v1, s[16:19], s61 offen offset:0 sc1 lds
    buffer_load_dwordx4 v1, s[16:19], s61 offen offset:1024 sc1 lds
    s_add_u32 m0, s65, s67
    s_nop 0
    buffer_load_dwordx4 v1, s[68:71], s62 offen offset:0 sc1 lds
    buffer_load_dwordx4 v1, s[68:71], s62 offen offset:1024 sc1 lds
    s_add_u32 m0, s66, s67
    s_mov_b64 exec, 0xffff
    buffer_load_dwordx4 v1, s[68:71], s48 offen sc1 lds
    s_mov_b64 exec, -1
    s_add_u32 s61, s61, s20
    s_add_u32 s62, s62, s21
    s_add_u32 s48, s48, s21
    s_add_u32 s67, s67, 17408
    s_cmp_eq_u32 s67, 104448
    s_cselect_b32 s67, 0, s67
    s_mov_b32 s58, 3
parallel_sum__sliding_local_dilated__mixer_gmlp__prompt_kernel_pl106:
    s_waitcnt vmcnt(15)
    s_barrier
    s_add_u32 m0, s60, s67
    s_nop 0
    buffer_load_dwordx4 v1, s[16:19], s61 offen offset:0 sc1 lds
    buffer_load_dwordx4 v1, s[16:19], s61 offen offset:1024 sc1 lds
    s_add_u32 m0, s65, s67
    s_nop 0
    buffer_load_dwordx4 v1, s[68:71], s62 offen offset:0 sc1 lds
    buffer_load_dwordx4 v1, s[68:71], s62 offen offset:1024 sc1 lds
    s_add_u32 m0, s66, s67
    s_mov_b64 exec, 0xffff
    buffer_load_dwordx4 v1, s[68:71], s48 offen sc1 lds
    s_mov_b64 exec, -1
    s_add_u32 s61, s61, s20
    s_add_u32 s62, s62, s21
    s_add_u32 s48, s48, s21
    s_add_u32 s67, s67, 17408
    s_cmp_eq_u32 s67, 104448
    s_cselect_b32 s67, 0, s67
    s_sub_u32 s58, s58, 1
    s_cmp_lg_u32 s58, 0
    s_cbranch_scc1 parallel_sum__sliding_local_dilated__mixer_gmlp__prompt_kernel_pl106
    s_mov_b32 s58, 1
parallel_sum__sliding_local_dilated__mixer_gmlp__prompt_kernel_pl107:
    s_waitcnt vmcnt(15)
    s_barrier
    s_add_u32 m0, s60, s67
    s_nop 0
    buffer_load_dwordx4 v1, s[16:19], s61 offen offset:0 sc1 lds
    buffer_load_dwordx4 v1, s[16:19], s61 offen offset:1024 sc1 lds
    s_add_u32 m0, s65, s67
    s_nop 0
    buffer_load_dwordx4 v1, s[68:71], s62 offen offset:0 sc1 lds
    buffer_load_dwordx4 v1, s[68:71], s62 offen offset:1024 sc1 lds
    s_add_u32 m0, s66, s67
    s_mov_b64 exec, 0xffff
    buffer_load_dwordx4 v1, s[68:71], s48 offen sc1 lds
    s_mov_b64 exec, -1
    s_add_u32 s61, s61, s20
    s_add_u32 s62, s62, s21
    s_add_u32 s48, s48, s21
    s_add_u32 s67, s67, 17408
    s_cmp_eq_u32 s67, 104448
    s_cselect_b32 s67, 0, s67
    s_sub_u32 s58, s58, 1
    s_cmp_lg_u32 s58, 0
    s_cbranch_scc1 parallel_sum__sliding_local_dilated__mixer_gmlp__prompt_kernel_pl107
    s_cmp_lg_u32 s40, 0
    s_cbranch_scc1 parallel_sum__sliding_local_dilated__mixer_gmlp__prompt_kernel_ow108
    s_mov_b32 exec_lo, 0x00ff00ff
    s_mov_b32 exec_hi, 0x00ff00ff
    buffer_load_dword v4, v245, s[84:87], s53 offen sc1
    s_mov_b64 exec, -1
parallel_sum__sliding_local_dilated__mixer_gmlp__prompt_kernel_ow108:
    s_waitcnt vmcnt(15)
    s_barrier
    s_add_u32 m0, s60, s67
    s_nop 0
    buffer_load_dwordx4 v1, s[16:19], s61 offen offset:0 sc1 lds
    buffer_load_dwordx4 v1, s[16:19], s61 offen offset:1024 sc1 lds
    s_add_u32 m0, s65, s67
    s_nop 0
    buffer_load_dwordx4 v1, s[68:71], s62 offen offset:0 sc1 lds
    buffer_load_dwordx4 v1, s[68:71], s62 offen offset:1024 sc1 lds
    s_add_u32 m0, s66, s67
    s_mov_b64 exec, 0xffff
    buffer_load_dwordx4 v1, s[68:71], s48 offen sc1 lds
    s_mov_b64 exec, -1
    s_add_u32 s61, s61, s20
    s_add_u32 s62, s62, s21
    s_add_u32 s48, s48, s21
    s_add_u32 s67, s67, 17408
    s_cmp_eq_u32 s67, 104448
    s_cselect_b32 s67, 0, s67
    s_waitcnt vmcnt(15)
    s_cmp_lg_u32 s40, 0
    s_cbranch_scc1 parallel_sum__sliding_local_dilated__mixer_gmlp__prompt_kernel_ow109
    s_waitcnt vmcnt(5)
    s_mov_b32 exec_lo, 0x00ff00ff
    s_mov_b32 exec_hi, 0x00ff00ff
    v_cmp_ne_u32 vcc, s101, v4
    s_cbranch_vccz parallel_sum__sliding_local_dilated__mixer_gmlp__prompt_kernel_sd111
    s_mov_b32 s50, 0x20000
parallel_sum__sliding_local_dilated__mixer_gmlp__prompt_kernel_sp110:
    s_sleep 2
    buffer_load_dword v4, v245, s[84:87], s53 offen sc1
    s_waitcnt vmcnt(0)
    s_sub_u32 s50, s50, 1
    v_cmp_ne_u32 vcc, s101, v4
    s_cmp_eq_u32 s50, 0
    s_cselect_b64 vcc, 0, vcc
    s_cbranch_vccnz parallel_sum__sliding_local_dilated__mixer_gmlp__prompt_kernel_sp110
parallel_sum__sliding_local_dilated__mixer_gmlp__prompt_kernel_sd111:
    s_mov_b64 exec, -1
parallel_sum__sliding_local_dilated__mixer_gmlp__prompt_kernel_ow109:
    s_barrier
    s_mul_i32 s50, s22, 18
    s_mul_i32 s55, s50, 2048
    s_add_u32 s61, s61, s55
    s_mul_i32 s55, s50, 73728
    s_add_u32 s62, s62, s55
    s_add_u32 s48, s48, s55
    s_add_u32 m0, s60, s67
    s_nop 0
    buffer_load_dwordx4 v1, s[16:19], s61 offen offset:0 sc1 lds
    buffer_load_dwordx4 v1, s[16:19], s61 offen offset:1024 sc1 lds
    s_add_u32 m0, s65, s67
    s_nop 0
    buffer_load_dwordx4 v1, s[68:71], s62 offen offset:0 sc1 lds
    buffer_load_dwordx4 v1, s[68:71], s62 offen offset:1024 sc1 lds
    s_add_u32 m0, s66, s67
    s_mov_b64 exec, 0xffff
    buffer_load_dwordx4 v1, s[68:71], s48 offen sc1 lds
    s_mov_b64 exec, -1
    s_add_u32 s61, s61, s20
    s_add_u32 s62, s62, s21
    s_add_u32 s48, s48, s21
    s_add_u32 s67, s67, 17408
    s_cmp_eq_u32 s67, 104448
    s_cselect_b32 s67, 0, s67
    s_mov_b32 s58, 12
parallel_sum__sliding_local_dilated__mixer_gmlp__prompt_kernel_pl112:
    s_waitcnt vmcnt(15)
    s_barrier
    s_add_u32 m0, s60, s67
    s_nop 0
    buffer_load_dwordx4 v1, s[16:19], s61 offen offset:0 sc1 lds
    buffer_load_dwordx4 v1, s[16:19], s61 offen offset:1024 sc1 lds
    s_add_u32 m0, s65, s67
    s_nop 0
    buffer_load_dwordx4 v1, s[68:71], s62 offen offset:0 sc1 lds
    buffer_load_dwordx4 v1, s[68:71], s62 offen offset:1024 sc1 lds
    s_add_u32 m0, s66, s67
    s_mov_b64 exec, 0xffff
    buffer_load_dwordx4 v1, s[68:71], s48 offen sc1 lds
    s_mov_b64 exec, -1
    s_add_u32 s61, s61, s20
    s_add_u32 s62, s62, s21
    s_add_u32 s48, s48, s21
    s_add_u32 s67, s67, 17408
    s_cmp_eq_u32 s67, 104448
    s_cselect_b32 s67, 0, s67
    s_sub_u32 s58, s58, 1
    s_cmp_lg_u32 s58, 0
    s_cbranch_scc1 parallel_sum__sliding_local_dilated__mixer_gmlp__prompt_kernel_pl112
    s_cmp_lg_u32 s40, 3
    s_cbranch_scc1 parallel_sum__sliding_local_dilated__mixer_gmlp__prompt_kernel_ow113
    s_mov_b32 exec_lo, 0xff00ff00
    s_mov_b32 exec_hi, 0xff00ff00
    buffer_load_dword v4, v245, s[84:87], s53 offen sc1
    s_mov_b64 exec, -1
parallel_sum__sliding_local_dilated__mixer_gmlp__prompt_kernel_ow113:
    s_mov_b32 s58, 4
parallel_sum__sliding_local_dilated__mixer_gmlp__prompt_kernel_pl114:
    s_waitcnt vmcnt(15)
    s_barrier
    s_add_u32 m0, s60, s67
    s_nop 0
    buffer_load_dwordx4 v1, s[16:19], s61 offen offset:0 sc1 lds
    buffer_load_dwordx4 v1, s[16:19], s61 offen offset:1024 sc1 lds
    s_add_u32 m0, s65, s67
    s_nop 0
    buffer_load_dwordx4 v1, s[68:71], s62 offen offset:0 sc1 lds
    buffer_load_dwordx4 v1, s[68:71], s62 offen offset:1024 sc1 lds
    s_add_u32 m0, s66, s67
    s_mov_b64 exec, 0xffff
    buffer_load_dwordx4 v1, s[68:71], s48 offen sc1 lds
    s_mov_b64 exec, -1
    s_add_u32 s61, s61, s20
    s_add_u32 s62, s62, s21
    s_add_u32 s48, s48, s21
    s_add_u32 s67, s67, 17408
    s_cmp_eq_u32 s67, 104448
    s_cselect_b32 s67, 0, s67
    s_sub_u32 s58, s58, 1
    s_cmp_lg_u32 s58, 0
    s_cbranch_scc1 parallel_sum__sliding_local_dilated__mixer_gmlp__prompt_kernel_pl114
    s_cmp_lg_u32 s40, 3
    s_cbranch_scc1 parallel_sum__sliding_local_dilated__mixer_gmlp__prompt_kernel_ow115
    s_mov_b32 exec_lo, 0xff00ff00
    s_mov_b32 exec_hi, 0xff00ff00
    v_cmp_ne_u32 vcc, s101, v4
    s_cbranch_vccz parallel_sum__sliding_local_dilated__mixer_gmlp__prompt_kernel_sd117
    s_mov_b32 s50, 0x20000
parallel_sum__sliding_local_dilated__mixer_gmlp__prompt_kernel_sp116:
    s_sleep 2
    buffer_load_dword v4, v245, s[84:87], s53 offen sc1
    s_waitcnt vmcnt(0)
    s_sub_u32 s50, s50, 1
    v_cmp_ne_u32 vcc, s101, v4
    s_cmp_eq_u32 s50, 0
    s_cselect_b64 vcc, 0, vcc
    s_cbranch_vccnz parallel_sum__sliding_local_dilated__mixer_gmlp__prompt_kernel_sp116
parallel_sum__sliding_local_dilated__mixer_gmlp__prompt_kernel_sd117:
    s_mov_b64 exec, -1
parallel_sum__sliding_local_dilated__mixer_gmlp__prompt_kernel_ow115:
    s_mov_b32 s58, 1
parallel_sum__sliding_local_dilated__mixer_gmlp__prompt_kernel_pl118:
    s_waitcnt vmcnt(15)
    s_barrier
    s_add_u32 m0, s60, s67
    s_nop 0
    buffer_load_dwordx4 v1, s[16:19], s61 offen offset:0 sc1 lds
    buffer_load_dwordx4 v1, s[16:19], s61 offen offset:1024 sc1 lds
    s_add_u32 m0, s65, s67
    s_nop 0
    buffer_load_dwordx4 v1, s[68:71], s62 offen offset:0 sc1 lds
    buffer_load_dwordx4 v1, s[68:71], s62 offen offset:1024 sc1 lds
    s_add_u32 m0, s66, s67
    s_mov_b64 exec, 0xffff
    buffer_load_dwordx4 v1, s[68:71], s48 offen sc1 lds
    s_mov_b64 exec, -1
    s_add_u32 s61, s61, s20
    s_add_u32 s62, s62, s21
    s_add_u32 s48, s48, s21
    s_add_u32 s67, s67, 17408
    s_cmp_eq_u32 s67, 104448
    s_cselect_b32 s67, 0, s67
    s_sub_u32 s58, s58, 1
    s_cmp_lg_u32 s58, 0
    s_cbranch_scc1 parallel_sum__sliding_local_dilated__mixer_gmlp__prompt_kernel_pl118
    s_mov_b32 s58, 18
parallel_sum__sliding_local_dilated__mixer_gmlp__prompt_kernel_pl119:
    s_waitcnt vmcnt(15)
    s_barrier
    s_add_u32 m0, s60, s67
    s_nop 0
    buffer_load_dwordx4 v1, s[16:19], s61 offen offset:0 sc1 lds
    buffer_load_dwordx4 v1, s[16:19], s61 offen offset:1024 sc1 lds
    s_add_u32 m0, s65, s67
    s_nop 0
    buffer_load_dwordx4 v1, s[68:71], s62 offen offset:0 sc1 lds
    buffer_load_dwordx4 v1, s[68:71], s62 offen offset:1024 sc1 lds
    s_add_u32 m0, s66, s67
    s_mov_b64 exec, 0xffff
    buffer_load_dwordx4 v1, s[68:71], s48 offen sc1 lds
    s_mov_b64 exec, -1
    s_add_u32 s61, s61, s20
    s_add_u32 s62, s62, s21
    s_add_u32 s48, s48, s21
    s_add_u32 s67, s67, 17408
    s_cmp_eq_u32 s67, 104448
    s_cselect_b32 s67, 0, s67
    s_sub_u32 s58, s58, 1
    s_cmp_lg_u32 s58, 0
    s_cbranch_scc1 parallel_sum__sliding_local_dilated__mixer_gmlp__prompt_kernel_pl119
    s_waitcnt vmcnt(15)
    s_barrier
    s_waitcnt vmcnt(10)
    s_barrier
    s_waitcnt vmcnt(5)
    s_barrier
    s_waitcnt vmcnt(0)
    s_barrier
    s_endpgm
parallel_sum__sliding_local_dilated__mixer_gmlp__prompt_kernel_end1:
    s_endpgm
.section .rodata,"a"
.p2align 6
.amdhsa_kernel parallel_sum__sliding_local_dilated__mixer_gmlp__prompt_kernel
  .amdhsa_next_free_vgpr 256
  .amdhsa_next_free_sgpr 102
  .amdhsa_accum_offset 256
  .amdhsa_group_segment_fixed_size 0
  .amdhsa_kernarg_size 88
  .amdhsa_user_sgpr_count 2
  .amdhsa_user_sgpr_kernarg_segment_ptr 1
  .amdhsa_system_sgpr_workgroup_id_x 1
  .amdhsa_float_denorm_mode_32 3
.end_amdhsa_kernel
```
